```python
import torch

def _softmax(x, axis=-1):
    return torch.softmax(x, dim=axis)
def _gelu(x):
    return torch.nn.functional.gelu(x, approximate="tanh")
def _silu(x):
    return torch.nn.functional.silu(x)
def _sigmoid(x):
    return torch.sigmoid(x)
def _layernorm(x, axis=-1, eps=1e-5):
    m = x.mean(dim=axis, keepdim=True)
    v = x.var(dim=axis, keepdim=True, unbiased=False)
    return (x - m) / torch.sqrt(v + eps)
def _scatter_add(tgt, idx, src, axis=0):
    return tgt.clone().index_add_(axis, idx, src)
def _segment_sum(src, seg, n):
    out = torch.zeros((n,) + src.shape[1:], dtype=src.dtype)
    return out.index_add_(0, seg, src)
def _pad(x, pw):
    flat = tuple(v for pair in reversed(pw) for v in pair)
    return torch.nn.functional.pad(x, flat)

kernel_name = 'gated_mix__linear_attn_block__swiglu_ffn__prompt'

def setup_inputs():

    _w = (lambda a: (lambda t: t.to(torch.bfloat16) if t.is_floating_point() else t)(torch.as_tensor(a)))
    def _A_setup():
        B, S, D = 1, 2048, 576
        return {
            "x": _w((lambda *s: torch.randn(*s, dtype=torch.bfloat16) * 0.05)(B, S, D)),
            "wqkv": _w((lambda *s: torch.randn(*s, dtype=torch.bfloat16) * 0.8)(D, 3 * D)),
            "wo": _w((lambda *s: torch.randn(*s, dtype=torch.bfloat16) * 0.05)(D, D)),
        }
    _A_in = _A_setup()

    def _B_setup():
        B, S, D, F = 1, 2048, 576, 4608
        return {
            "x": _w((lambda *s: torch.randn(*s, dtype=torch.bfloat16) * 0.05)(B, S, D)),
            "w_gate": _w((lambda *s: torch.randn(*s, dtype=torch.bfloat16) * 0.05)(D, F)),
            "w_up": _w((lambda *s: torch.randn(*s, dtype=torch.bfloat16) * 0.05)(D, F)),
            "w_down": _w((lambda *s: torch.randn(*s, dtype=torch.bfloat16) * 0.05)(F, D)),
        }
    _B_in = _B_setup()

    return {
        "A_x": _A_in["x"],
        "A_wqkv": _A_in["wqkv"],
        "A_wo": _A_in["wo"],
        "B_x": _B_in["x"],
        "B_w_gate": _B_in["w_gate"],
        "B_w_up": _B_in["w_up"],
        "B_w_down": _B_in["w_down"],
        "gate_w": _w((lambda *s: torch.randn(*s, dtype=torch.bfloat16) * 0.05)(576) * 16.0),
    }

def reference(A_x, A_wqkv, A_wo, B_x, B_w_gate, B_w_up, B_w_down, gate_w):
    def _A_ref(x, wqkv, wo):
        B, S, D = x.shape
        H = 32; Dh = D // H
        qkv = (lambda x, *d: x.permute(*d))((x @ wqkv).reshape(B, S, 3, H, Dh), 2, 0, 3, 1, 4)
        q, k, v = qkv[0], qkv[1], qkv[2]
        phi = lambda t: torch.where(t > 0, t + 1, torch.exp(t)) + 1e-6
        pq, pk = phi(q), phi(k)
        kv = torch.einsum("bhsd,bhse->bhde", pk, v)
        z = torch.einsum("bhsd->bhd", pk)
        num = torch.einsum("bhqd,bhde->bhqe", pq, kv)
        den = torch.einsum("bhqd,bhd->bhq", pq, z)[..., None] + 1e-6
        o = num / den
        return (lambda x, *d: x.permute(*d))(o, 0, 2, 1, 3).reshape(B, S, D) @ wo

    def _B_ref(x, w_gate, w_up, w_down):
        g = _silu(x @ w_gate)
        u = x @ w_up
        return (g * u) @ w_down

    x = A_x
    g = _sigmoid((x * gate_w).sum(-1, keepdims=True))
    a = _A_ref(x, A_wqkv, A_wo)
    b = _B_ref(x, B_w_gate, B_w_up, B_w_down)
    return g * a + (1 - g) * b
```

```asm
; @launch grid=(256,1,1) block=(256,1,1) lds=163840
.amdgcn_target "amdgcn-amd-amdhsa--gfx950"
.text
.globl gated_mix__linear_attn_block__swiglu_ffn__prompt_kernel
.p2align 8
.type gated_mix__linear_attn_block__swiglu_ffn__prompt_kernel,@function
gated_mix__linear_attn_block__swiglu_ffn__prompt_kernel:
  s_cmp_ge_u32 s2, 256
  s_cbranch_scc1 L_end
  s_load_dwordx16 s[64:79], s[0:1], 0
  s_load_dwordx4 s[80:83], s[0:1], 64
  s_load_dwordx2 s[84:85], s[0:1], 80
  s_getpc_b64 s[46:47]
L_pc_here:
  v_lshlrev_b32 v211, 5, v0
  v_and_b32 v211, 0x1f80, v211
  v_mov_b32 v215, s47
  v_add_co_u32 v214, vcc, s46, v211
  s_nop 1
  v_addc_co_u32 v215, vcc, 0, v215, vcc
  global_load_dword v250, v[214:215], off
  s_lshr_b32 s62, s2, 3
  s_lshl_b32 s62, s62, 12
  v_lshrrev_b32 v212, 6, v0
  v_and_b32 v211, 7, v0
  v_lshl_add_u32 v211, v212, 3, v211
  v_lshlrev_b32 v211, 7, v211
  v_add_u32 v211, s62, v211
  v_add_u32 v211, 0x2000, v211
  v_min_u32 v211, L_end-L_pc_here, v211
  v_mov_b32 v217, s47
  v_add_co_u32 v216, vcc, s46, v211
  s_nop 1
  v_addc_co_u32 v217, vcc, 0, v217, vcc
  global_load_dword v250, v[216:217], off
  v_lshrrev_b32 v208, 6, v0
  v_and_b32 v249, 63, v0
  v_readfirstlane_b32 s3, v208
  v_lshlrev_b32 v224, 4, v249
  v_mov_b32 v251, 1
  s_and_b32 s48, s2, 3
  s_lshr_b32 s62, s2, 2
  s_and_b32 s62, s62, 1
  s_lshl_b32 s62, s62, 2
  s_lshr_b32 s49, s2, 6
  s_add_u32 s49, s49, s62
  s_lshr_b32 s50, s2, 3
  s_and_b32 s50, s50, 7
  s_lshl_b32 s51, s48, 3
  s_add_u32 s51, s51, s50
  v_lshrrev_b32 v209, 3, v249
  v_and_b32 v210, 7, v249
  v_lshrrev_b32 v211, 1, v209
  v_xor_b32 v212, v210, v211
  v_xor_b32 v213, 4, v212
  v_mul_u32_u24 v214, 1152, v209
  v_lshl_add_u32 v64, v212, 4, v214
  v_lshl_add_u32 v65, v213, 4, v214
  v_and_b32 v211, 1, v211
  v_lshlrev_b32 v211, 2, v211
  v_xor_b32 v211, v211, v210
  v_mul_u32_u24 v214, 9216, v209
  v_lshl_add_u32 v225, v211, 4, v214
  s_mul_i32 s54, s49, 294912
  s_mul_i32 s62, s3, 73728
  s_add_u32 s54, s54, s62
  s_mul_i32 s55, s3, 8192
  s_add_u32 s55, s55, 65536
  s_mul_i32 s56, s3, 221184
  s_lshl_b32 s62, s51, 8
  s_add_u32 s56, s56, s62
  s_mul_i32 s57, s3, 3072
  s_lshl_b32 s59, s3, 10
  s_waitcnt lgkmcnt(0)
  s_mov_b32 s4, s64
  s_mov_b32 s5, s65
  s_mov_b32 s6, 2359296
  s_mov_b32 s7, 0x20000
  s_mov_b32 s8, s72
  s_mov_b32 s9, s73
  s_mov_b32 s10, 5308416
  s_mov_b32 s11, 0x20000
  v_min_u32 v211, 11, v249
  v_mul_u32_u24 v212, 43, v211
  v_lshrrev_b32 v212, 8, v212
  v_mul_u32_u24 v213, 6, v212
  v_sub_u32 v211, v211, v213
  v_lshlrev_b32 v211, 7, v211
  v_mul_u32_u24 v212, 1152, v212
  v_add_u32 v211, v211, v212
  s_lshl_b32 s62, s49, 8
  s_lshl_b32 s63, s51, 3
  s_add_u32 s62, s62, s63
  s_lshl_b32 s63, s3, 1
  s_add_u32 s62, s62, s63
  s_mul_i32 s62, s62, 1152
  s_add_u32 s62, s62, 384
  buffer_load_dword v250, v211, s[4:7], s62 offen
  s_add_u32 m0, s55, 0
  s_add_u32 s62, s54, 0
  buffer_load_dwordx4 v64, s[4:7], s62 offen lds
  s_add_u32 m0, s55, 1024
  s_add_u32 s62, s54, 9216
  buffer_load_dwordx4 v65, s[4:7], s62 offen lds
  s_add_u32 m0, s55, 2048
  s_add_u32 s62, s54, 18432
  buffer_load_dwordx4 v64, s[4:7], s62 offen lds
  s_add_u32 m0, s55, 3072
  s_add_u32 s62, s54, 27648
  buffer_load_dwordx4 v65, s[4:7], s62 offen lds
  s_add_u32 m0, s55, 4096
  s_add_u32 s62, s54, 36864
  buffer_load_dwordx4 v64, s[4:7], s62 offen lds
  s_add_u32 m0, s55, 5120
  s_add_u32 s62, s54, 46080
  buffer_load_dwordx4 v65, s[4:7], s62 offen lds
  s_add_u32 m0, s55, 6144
  s_add_u32 s62, s54, 55296
  buffer_load_dwordx4 v64, s[4:7], s62 offen lds
  s_add_u32 m0, s55, 7168
  s_add_u32 s62, s54, 64512
  buffer_load_dwordx4 v65, s[4:7], s62 offen lds
  s_add_u32 m0, s57, 0
  s_add_u32 s62, s56, 0
  buffer_load_dwordx4 v225, s[8:11], s62 offen lds
  s_add_u32 m0, s57, 1024
  s_add_u32 s62, s56, 73728
  buffer_load_dwordx4 v225, s[8:11], s62 offen lds
  s_add_u32 m0, s57, 2048
  s_add_u32 s62, s56, 147456
  buffer_load_dwordx4 v225, s[8:11], s62 offen lds
  s_mov_b32 s12, s74
  s_mov_b32 s13, s75
  s_mov_b32 s14, 5308416
  s_mov_b32 s15, 0x20000
  s_mul_i32 s44, s49, 72
  s_mul_i32 s62, s3, 18
  s_add_u32 s44, s44, s62
  s_mul_i32 s44, s44, 9216
  s_add_u32 m0, s55, 32768
  s_add_u32 s62, s54, 128
  buffer_load_dwordx4 v64, s[4:7], s62 offen lds
  s_add_u32 m0, s55, 33792
  s_add_u32 s62, s54, 9344
  buffer_load_dwordx4 v65, s[4:7], s62 offen lds
  s_add_u32 m0, s55, 34816
  s_add_u32 s62, s54, 18560
  buffer_load_dwordx4 v64, s[4:7], s62 offen lds
  s_add_u32 m0, s55, 35840
  s_add_u32 s62, s54, 27776
  buffer_load_dwordx4 v65, s[4:7], s62 offen lds
  s_add_u32 m0, s55, 36864
  s_add_u32 s62, s54, 36992
  buffer_load_dwordx4 v64, s[4:7], s62 offen lds
  s_add_u32 m0, s55, 37888
  s_add_u32 s62, s54, 46208
  buffer_load_dwordx4 v65, s[4:7], s62 offen lds
  s_add_u32 m0, s55, 38912
  s_add_u32 s62, s54, 55424
  buffer_load_dwordx4 v64, s[4:7], s62 offen lds
  s_add_u32 m0, s55, 39936
  s_add_u32 s62, s54, 64640
  buffer_load_dwordx4 v65, s[4:7], s62 offen lds
  s_add_u32 m0, s57, 12288
  s_add_u32 s62, s56, 884736
  buffer_load_dwordx4 v225, s[8:11], s62 offen lds
  s_add_u32 m0, s57, 13312
  s_add_u32 s62, s56, 958464
  buffer_load_dwordx4 v225, s[8:11], s62 offen lds
  s_add_u32 m0, s57, 14336
  s_add_u32 s62, s56, 1032192
  buffer_load_dwordx4 v225, s[8:11], s62 offen lds
  s_add_u32 m0, s55, 65536
  s_add_u32 s62, s54, 256
  buffer_load_dwordx4 v64, s[4:7], s62 offen lds
  s_add_u32 m0, s55, 66560
  s_add_u32 s62, s54, 9472
  buffer_load_dwordx4 v65, s[4:7], s62 offen lds
  s_add_u32 m0, s55, 67584
  s_add_u32 s62, s54, 18688
  buffer_load_dwordx4 v64, s[4:7], s62 offen lds
  s_add_u32 m0, s55, 68608
  s_add_u32 s62, s54, 27904
  buffer_load_dwordx4 v65, s[4:7], s62 offen lds
  s_add_u32 m0, s55, 69632
  s_add_u32 s62, s54, 37120
  buffer_load_dwordx4 v64, s[4:7], s62 offen lds
  s_add_u32 m0, s55, 70656
  s_add_u32 s62, s54, 46336
  buffer_load_dwordx4 v65, s[4:7], s62 offen lds
  s_add_u32 m0, s55, 71680
  s_add_u32 s62, s54, 55552
  buffer_load_dwordx4 v64, s[4:7], s62 offen lds
  s_add_u32 m0, s55, 72704
  s_add_u32 s62, s54, 64768
  buffer_load_dwordx4 v65, s[4:7], s62 offen lds
  s_mov_b32 s16, s66
  s_mov_b32 s17, s67
  s_mov_b32 s18, 1990656
  s_mov_b32 s19, 0x20000
  s_add_u32 m0, s57, 24576
  s_add_u32 s62, s56, 1769472
  buffer_load_dwordx4 v225, s[8:11], s62 offen lds
  s_add_u32 m0, s57, 25600
  s_add_u32 s62, s56, 1843200
  buffer_load_dwordx4 v225, s[8:11], s62 offen lds
  s_add_u32 m0, s57, 26624
  s_add_u32 s62, s56, 1916928
  buffer_load_dwordx4 v225, s[8:11], s62 offen lds
  s_add_u32 m0, s57, 36864
  s_add_u32 s62, s56, 2654208
  buffer_load_dwordx4 v225, s[8:11], s62 offen lds
  s_add_u32 m0, s57, 37888
  s_add_u32 s62, s56, 2727936
  buffer_load_dwordx4 v225, s[8:11], s62 offen lds
  s_add_u32 m0, s57, 38912
  s_add_u32 s62, s56, 2801664
  buffer_load_dwordx4 v225, s[8:11], s62 offen lds
  s_add_u32 m0, s57, 49152
  s_add_u32 s62, s56, 3538944
  buffer_load_dwordx4 v225, s[8:11], s62 offen lds
  s_add_u32 m0, s57, 50176
  s_add_u32 s62, s56, 3612672
  buffer_load_dwordx4 v225, s[8:11], s62 offen lds
  s_add_u32 m0, s57, 51200
  s_add_u32 s62, s56, 3686400
  buffer_load_dwordx4 v225, s[8:11], s62 offen lds
  s_mul_i32 s94, s2, 7808
  v_and_b32 v208, 31, v249
  v_lshrrev_b32 v209, 5, v249
  v_lshrrev_b32 v210, 1, v208
  v_and_b32 v210, 7, v210
  v_xor_b32 v210, v210, v209
  v_lshlrev_b32 v211, 7, v208
  v_add_u32 v211, s55, v211
  v_xor_b32 v212, 0, v210
  v_lshl_add_u32 v66, v212, 4, v211
  v_add_u32 v70, 0x10000, v66
  v_xor_b32 v212, 2, v210
  v_lshl_add_u32 v67, v212, 4, v211
  v_add_u32 v71, 0x10000, v67
  v_xor_b32 v212, 4, v210
  v_lshl_add_u32 v68, v212, 4, v211
  v_add_u32 v72, 0x10000, v68
  v_xor_b32 v212, 6, v210
  v_lshl_add_u32 v69, v212, 4, v211
  v_add_u32 v73, 0x10000, v69
  v_bfe_u32 v214, v249, 4, 1
  v_bfe_u32 v215, v249, 2, 2
  v_and_b32 v216, 3, v249
  v_lshl_add_u32 v217, v209, 3, v215
  v_and_b32 v218, 1, v216
  v_lshl_add_u32 v218, v218, 1, v214
  v_lshrrev_b32 v219, 1, v216
  v_lshlrev_b32 v219, 3, v219
  v_lshl_add_u32 v219, v218, 4, v219
  v_lshl_add_u32 v219, v217, 7, v219
  v_lshrrev_b32 v220, 1, v215
  v_lshl_add_u32 v226, v220, 6, v219
  v_xor_b32 v220, 1, v220
  v_lshl_add_u32 v227, v220, 6, v219
  s_waitcnt vmcnt(31)
  ds_read_b128 a[0:3], v66 offset:0
  ds_read_b128 a[4:7], v66 offset:4096
  ds_read_b128 a[8:11], v67 offset:0
  ds_read_b128 a[12:15], v67 offset:4096
  ds_read_b128 a[16:19], v68 offset:0
  ds_read_b128 a[20:23], v68 offset:4096
  ds_read_b128 a[24:27], v69 offset:0
  ds_read_b128 a[28:31], v69 offset:4096
  s_waitcnt vmcnt(28)
  s_barrier
  ds_read_b64_tr_b16 v[192:193], v226 offset:0
  ds_read_b64_tr_b16 v[194:195], v226 offset:512
  ds_read_b64_tr_b16 v[196:197], v227 offset:0
  ds_read_b64_tr_b16 v[198:199], v227 offset:512
  ds_read_b64_tr_b16 v[200:201], v226 offset:2048
  ds_read_b64_tr_b16 v[202:203], v226 offset:2560
  ds_read_b64_tr_b16 v[204:205], v227 offset:2048
  ds_read_b64_tr_b16 v[206:207], v227 offset:2560
  s_waitcnt lgkmcnt(6)
  v_mfma_f32_32x32x16_bf16 v[0:15], v[192:195], a[0:3], 0
  s_waitcnt vmcnt(20)
  ds_read_b128 a[32:35], v66 offset:32768
  ds_read_b128 a[36:39], v66 offset:36864
  v_mfma_f32_32x32x16_bf16 v[16:31], v[192:195], a[4:7], 0
  ds_read_b64_tr_b16 v[192:193], v226 offset:4096
  ds_read_b64_tr_b16 v[194:195], v226 offset:4608
  ds_read_b128 a[40:43], v67 offset:32768
  ds_read_b128 a[44:47], v67 offset:36864
  s_waitcnt lgkmcnt(10)
  v_mfma_f32_32x32x16_bf16 v[32:47], v[196:199], a[0:3], 0
  ds_read_b128 a[48:51], v68 offset:32768
  ds_read_b128 a[52:55], v68 offset:36864
  s_mov_b32 s20, s84
  s_mov_b32 s21, s85
  s_mov_b32 s22, 268435456
  s_mov_b32 s23, 0x20000
  v_mfma_f32_32x32x16_bf16 v[48:63], v[196:199], a[4:7], 0
  ds_read_b64_tr_b16 v[196:197], v227 offset:4096
  ds_read_b64_tr_b16 v[198:199], v227 offset:4608
  ds_read_b128 a[56:59], v69 offset:32768
  ds_read_b128 a[60:63], v69 offset:36864
  s_waitcnt lgkmcnt(14)
  v_mfma_f32_32x32x16_bf16 v[0:15], v[200:203], a[8:11], v[0:15]
  s_add_u32 m0, s55, 0
  s_add_u32 s62, s54, 384
  buffer_load_dwordx4 v64, s[4:7], s62 offen lds
  s_add_u32 m0, s55, 1024
  s_add_u32 s62, s54, 9600
  buffer_load_dwordx4 v65, s[4:7], s62 offen lds
  v_mfma_f32_32x32x16_bf16 v[16:31], v[200:203], a[12:15], v[16:31]
  ds_read_b64_tr_b16 v[200:201], v226 offset:6144
  ds_read_b64_tr_b16 v[202:203], v226 offset:6656
  s_add_u32 m0, s55, 2048
  s_add_u32 s62, s54, 18816
  buffer_load_dwordx4 v64, s[4:7], s62 offen lds
  s_add_u32 m0, s55, 3072
  s_add_u32 s62, s54, 28032
  buffer_load_dwordx4 v65, s[4:7], s62 offen lds
  s_waitcnt lgkmcnt(14)
  v_mfma_f32_32x32x16_bf16 v[32:47], v[204:207], a[8:11], v[32:47]
  s_add_u32 m0, s55, 4096
  s_add_u32 s62, s54, 37248
  buffer_load_dwordx4 v64, s[4:7], s62 offen lds
  s_add_u32 m0, s55, 5120
  s_add_u32 s62, s54, 46464
  buffer_load_dwordx4 v65, s[4:7], s62 offen lds
  v_mfma_f32_32x32x16_bf16 v[48:63], v[204:207], a[12:15], v[48:63]
  ds_read_b64_tr_b16 v[204:205], v227 offset:6144
  ds_read_b64_tr_b16 v[206:207], v227 offset:6656
  s_add_u32 m0, s55, 6144
  s_add_u32 s62, s54, 55680
  buffer_load_dwordx4 v64, s[4:7], s62 offen lds
  s_add_u32 m0, s55, 7168
  s_add_u32 s62, s54, 64896
  buffer_load_dwordx4 v65, s[4:7], s62 offen lds
  s_waitcnt lgkmcnt(12)
  v_mfma_f32_32x32x16_bf16 v[0:15], v[192:195], a[16:19], v[0:15]
  s_mov_b32 s40, s82
  s_mov_b32 s41, s83
  s_mov_b32 s42, 256
  s_mov_b32 s43, 0x20000
  v_mfma_f32_32x32x16_bf16 v[16:31], v[192:195], a[20:23], v[16:31]
  ds_read_b64_tr_b16 v[192:193], v226 offset:8192
  ds_read_b64_tr_b16 v[194:195], v226 offset:8704
  s_mov_b32 s36, s78
  s_mov_b32 s37, s79
  s_mov_b32 s38, 1152
  s_mov_b32 s39, 0x20000
  s_waitcnt lgkmcnt(8)
  v_mfma_f32_32x32x16_bf16 v[32:47], v[196:199], a[16:19], v[32:47]
  s_waitcnt lgkmcnt(6)
  s_add_u32 m0, s55, 32768
  s_add_u32 s62, s54, 512
  buffer_load_dwordx4 v64, s[4:7], s62 offen lds
  s_add_u32 m0, s55, 33792
  s_add_u32 s62, s54, 9728
  buffer_load_dwordx4 v65, s[4:7], s62 offen lds
  v_mfma_f32_32x32x16_bf16 v[48:63], v[196:199], a[20:23], v[48:63]
  ds_read_b64_tr_b16 v[196:197], v227 offset:8192
  ds_read_b64_tr_b16 v[198:199], v227 offset:8704
  s_add_u32 m0, s55, 34816
  s_add_u32 s62, s54, 18944
  buffer_load_dwordx4 v64, s[4:7], s62 offen lds
  s_add_u32 m0, s55, 35840
  s_add_u32 s62, s54, 28160
  buffer_load_dwordx4 v65, s[4:7], s62 offen lds
  s_waitcnt lgkmcnt(6)
  v_mfma_f32_32x32x16_bf16 v[0:15], v[200:203], a[24:27], v[0:15]
  s_add_u32 m0, s55, 36864
  s_add_u32 s62, s54, 37376
  buffer_load_dwordx4 v64, s[4:7], s62 offen lds
  s_add_u32 m0, s55, 37888
  s_add_u32 s62, s54, 46592
  buffer_load_dwordx4 v65, s[4:7], s62 offen lds
  v_mfma_f32_32x32x16_bf16 v[16:31], v[200:203], a[28:31], v[16:31]
  ds_read_b64_tr_b16 v[200:201], v226 offset:10240
  ds_read_b64_tr_b16 v[202:203], v226 offset:10752
  s_add_u32 m0, s55, 38912
  s_add_u32 s62, s54, 55808
  buffer_load_dwordx4 v64, s[4:7], s62 offen lds
  s_add_u32 m0, s55, 39936
  s_add_u32 s62, s54, 65024
  buffer_load_dwordx4 v65, s[4:7], s62 offen lds
  s_waitcnt lgkmcnt(6)
  v_mfma_f32_32x32x16_bf16 v[32:47], v[204:207], a[24:27], v[32:47]
  v_mfma_f32_32x32x16_bf16 v[48:63], v[204:207], a[28:31], v[48:63]
  ds_read_b64_tr_b16 v[204:205], v227 offset:10240
  ds_read_b64_tr_b16 v[206:207], v227 offset:10752
  v_and_b32 v219, 15, v249
  s_lshl_b32 s62, s3, 4
  v_add_u32 v219, s62, v219
  v_lshlrev_b32 v220, 6, v219
  v_add_u32 v235, 48, v220
  v_lshlrev_b32 v219, 1, v219
  s_waitcnt lgkmcnt(6)
  v_mfma_f32_32x32x16_bf16 v[0:15], v[192:195], a[32:35], v[0:15]
  s_waitcnt vmcnt(25)
  ds_read_b128 a[64:67], v70 offset:0
  ds_read_b128 a[68:71], v70 offset:4096
  buffer_load_ushort v236, v219, s[36:39], 0 offen offset:0
  buffer_load_ushort v237, v219, s[36:39], 0 offen offset:128
  buffer_load_ushort v238, v219, s[36:39], 0 offen offset:256
  v_mfma_f32_32x32x16_bf16 v[16:31], v[192:195], a[36:39], v[16:31]
  s_barrier
  ds_read_b64_tr_b16 v[192:193], v226 offset:12288
  ds_read_b64_tr_b16 v[194:195], v226 offset:12800
  ds_read_b128 a[72:75], v71 offset:0
  ds_read_b128 a[76:79], v71 offset:4096
  buffer_load_ushort v239, v219, s[36:39], 0 offen offset:384
  buffer_load_ushort v240, v219, s[36:39], 0 offen offset:512
  buffer_load_ushort v241, v219, s[36:39], 0 offen offset:640
  s_waitcnt lgkmcnt(10)
  v_mfma_f32_32x32x16_bf16 v[32:47], v[196:199], a[32:35], v[32:47]
  ds_read_b128 a[80:83], v72 offset:0
  ds_read_b128 a[84:87], v72 offset:4096
  buffer_load_ushort v242, v219, s[36:39], 0 offen offset:768
  buffer_load_ushort v243, v219, s[36:39], 0 offen offset:896
  buffer_load_ushort v244, v219, s[36:39], 0 offen offset:1024
  v_mfma_f32_32x32x16_bf16 v[48:63], v[196:199], a[36:39], v[48:63]
  ds_read_b64_tr_b16 v[196:197], v227 offset:12288
  ds_read_b64_tr_b16 v[198:199], v227 offset:12800
  ds_read_b128 a[88:91], v73 offset:0
  ds_read_b128 a[92:95], v73 offset:4096
  s_waitcnt lgkmcnt(14)
  v_mfma_f32_32x32x16_bf16 v[0:15], v[200:203], a[40:43], v[0:15]
  s_mov_b32 s36, s80
  s_mov_b32 s37, s81
  s_mov_b32 s38, 2359296
  s_mov_b32 s39, 0x20000
  v_mfma_f32_32x32x16_bf16 v[16:31], v[200:203], a[44:47], v[16:31]
  ds_read_b64_tr_b16 v[200:201], v226 offset:14336
  ds_read_b64_tr_b16 v[202:203], v226 offset:14848
  s_waitcnt lgkmcnt(14)
  v_mfma_f32_32x32x16_bf16 v[32:47], v[204:207], a[40:43], v[32:47]
  s_cmp_lt_u32 s3, 2
  s_cselect_b32 s24, s72, s74
  s_cselect_b32 s25, s73, s75
  s_mov_b32 s26, 5308416
  s_mov_b32 s27, 0x20000
  v_mfma_f32_32x32x16_bf16 v[48:63], v[204:207], a[44:47], v[48:63]
  ds_read_b64_tr_b16 v[204:205], v227 offset:14336
  ds_read_b64_tr_b16 v[206:207], v227 offset:14848
  s_waitcnt lgkmcnt(12)
  v_mfma_f32_32x32x16_bf16 v[0:15], v[192:195], a[48:51], v[0:15]
  s_mul_i32 s100, s2, 1561
  s_lshr_b32 s100, s100, 16
  s_mul_i32 s62, s100, 42
  s_sub_u32 s101, s2, s62
  s_cmp_ge_u32 s101, 36
  s_cselect_b32 s28, s68, s76
  s_cselect_b32 s29, s69, s77
  s_mov_b32 s30, 5308416
  s_cselect_b32 s30, 663552, s30
  s_mov_b32 s31, 0x20000
  v_mfma_f32_32x32x16_bf16 v[16:31], v[192:195], a[52:55], v[16:31]
  ds_read_b64_tr_b16 v[192:193], v226 offset:16384
  ds_read_b64_tr_b16 v[194:195], v226 offset:16896
  s_waitcnt lgkmcnt(8)
  v_mfma_f32_32x32x16_bf16 v[32:47], v[196:199], a[48:51], v[32:47]
  s_waitcnt lgkmcnt(6)
  s_add_u32 m0, s55, 65536
  s_add_u32 s62, s54, 640
  buffer_load_dwordx4 v64, s[4:7], s62 offen lds
  s_add_u32 m0, s55, 66560
  s_add_u32 s62, s54, 9856
  buffer_load_dwordx4 v65, s[4:7], s62 offen lds
  v_mfma_f32_32x32x16_bf16 v[48:63], v[196:199], a[52:55], v[48:63]
  ds_read_b64_tr_b16 v[196:197], v227 offset:16384
  ds_read_b64_tr_b16 v[198:199], v227 offset:16896
  s_add_u32 m0, s55, 67584
  s_add_u32 s62, s54, 19072
  buffer_load_dwordx4 v64, s[4:7], s62 offen lds
  s_add_u32 m0, s55, 68608
  s_add_u32 s62, s54, 28288
  buffer_load_dwordx4 v65, s[4:7], s62 offen lds
  s_waitcnt lgkmcnt(6)
  v_mfma_f32_32x32x16_bf16 v[0:15], v[200:203], a[56:59], v[0:15]
  s_add_u32 m0, s55, 69632
  s_add_u32 s62, s54, 37504
  buffer_load_dwordx4 v64, s[4:7], s62 offen lds
  s_add_u32 m0, s55, 70656
  s_add_u32 s62, s54, 46720
  buffer_load_dwordx4 v65, s[4:7], s62 offen lds
  v_mfma_f32_32x32x16_bf16 v[16:31], v[200:203], a[60:63], v[16:31]
  ds_read_b64_tr_b16 v[200:201], v226 offset:18432
  ds_read_b64_tr_b16 v[202:203], v226 offset:18944
  s_add_u32 m0, s55, 71680
  s_add_u32 s62, s54, 55936
  buffer_load_dwordx4 v64, s[4:7], s62 offen lds
  s_add_u32 m0, s55, 72704
  s_add_u32 s62, s54, 65152
  buffer_load_dwordx4 v65, s[4:7], s62 offen lds
  s_waitcnt lgkmcnt(6)
  v_mfma_f32_32x32x16_bf16 v[32:47], v[204:207], a[56:59], v[32:47]
  s_mov_b32 s32, s84
  s_mov_b32 s33, s85
  s_mov_b32 s34, 268435456
  s_mov_b32 s35, 0x20000
  s_cmp_ge_u32 s2, 168
  s_cselect_b32 s30, 0, s30
  s_cselect_b32 s34, 0, s34
  v_mfma_f32_32x32x16_bf16 v[48:63], v[204:207], a[60:63], v[48:63]
  ds_read_b64_tr_b16 v[204:205], v227 offset:18432
  ds_read_b64_tr_b16 v[206:207], v227 offset:18944
  s_waitcnt lgkmcnt(6)
  v_mfma_f32_32x32x16_bf16 v[0:15], v[192:195], a[64:67], v[0:15]
  s_waitcnt vmcnt(25)
  ds_read_b128 a[96:99], v66 offset:0
  ds_read_b128 a[100:103], v66 offset:4096
  v_mfma_f32_32x32x16_bf16 v[16:31], v[192:195], a[68:71], v[16:31]
  ds_read_b64_tr_b16 v[192:193], v226 offset:20480
  ds_read_b64_tr_b16 v[194:195], v226 offset:20992
  ds_read_b128 a[104:107], v67 offset:0
  ds_read_b128 a[108:111], v67 offset:4096
  s_waitcnt lgkmcnt(10)
  v_mfma_f32_32x32x16_bf16 v[32:47], v[196:199], a[64:67], v[32:47]
  ds_read_b128 a[112:115], v68 offset:0
  ds_read_b128 a[116:119], v68 offset:4096
  s_and_b32 s62, s101, 15
  s_lshr_b32 s62, s62, 1
  s_lshl_b32 s63, s100, 3
  s_add_u32 s62, s62, s63
  s_lshl_b32 s62, s62, 1
  s_lshr_b32 s63, s101, 4
  s_add_u32 s62, s62, s63
  s_lshl_b32 s62, s62, 6
  s_and_b32 s63, s101, 1
  s_lshl_b32 s63, s63, 5
  s_add_u32 s64, s62, s63
  v_mfma_f32_32x32x16_bf16 v[48:63], v[196:199], a[68:71], v[48:63]
  ds_read_b64_tr_b16 v[196:197], v227 offset:20480
  ds_read_b64_tr_b16 v[198:199], v227 offset:20992
  ds_read_b128 a[120:123], v69 offset:0
  ds_read_b128 a[124:127], v69 offset:4096
  s_waitcnt lgkmcnt(14)
  v_mfma_f32_32x32x16_bf16 v[0:15], v[200:203], a[72:75], v[0:15]
  v_mfma_f32_32x32x16_bf16 v[16:31], v[200:203], a[76:79], v[16:31]
  ds_read_b64_tr_b16 v[200:201], v226 offset:22528
  ds_read_b64_tr_b16 v[202:203], v226 offset:23040
  s_waitcnt lgkmcnt(14)
  v_mfma_f32_32x32x16_bf16 v[32:47], v[204:207], a[72:75], v[32:47]
  s_lshl_b32 s62, s100, 7
  s_add_u32 s62, s62, 3072
  s_lshl_b32 s63, s101, 5
  s_add_u32 s62, s62, s63
  s_cmp_ge_u32 s101, 32
  s_cselect_b32 s64, s62, s64
  s_mul_i32 s62, s100, 144
  s_cmp_ge_u32 s101, 36
  s_cselect_b32 s64, s62, s64
  s_cselect_b32 s68, 6, 0
  s_cselect_b32 s69, 18, 64
  v_mfma_f32_32x32x16_bf16 v[48:63], v[204:207], a[76:79], v[48:63]
  ds_read_b64_tr_b16 v[204:205], v227 offset:22528
  ds_read_b64_tr_b16 v[206:207], v227 offset:23040
  s_waitcnt lgkmcnt(12)
  v_mfma_f32_32x32x16_bf16 v[0:15], v[192:195], a[80:83], v[0:15]
  v_mfma_f32_32x32x16_bf16 v[16:31], v[192:195], a[84:87], v[16:31]
  s_barrier
  ds_read_b64_tr_b16 v[192:193], v226 offset:24576
  ds_read_b64_tr_b16 v[194:195], v226 offset:25088
  s_add_u32 m0, s57, 0
  s_add_u32 s62, s56, 4423680
  buffer_load_dwordx4 v225, s[8:11], s62 offen lds
  s_add_u32 m0, s57, 1024
  s_add_u32 s62, s56, 4497408
  buffer_load_dwordx4 v225, s[8:11], s62 offen lds
  s_waitcnt lgkmcnt(8)
  v_mfma_f32_32x32x16_bf16 v[32:47], v[196:199], a[80:83], v[32:47]
  s_add_u32 m0, s57, 2048
  s_add_u32 s62, s56, 4571136
  buffer_load_dwordx4 v225, s[8:11], s62 offen lds
  s_waitcnt lgkmcnt(6)
  s_add_u32 m0, s55, 0
  s_add_u32 s62, s54, 768
  buffer_load_dwordx4 v64, s[4:7], s62 offen lds
  v_mfma_f32_32x32x16_bf16 v[48:63], v[196:199], a[84:87], v[48:63]
  ds_read_b64_tr_b16 v[196:197], v227 offset:24576
  ds_read_b64_tr_b16 v[198:199], v227 offset:25088
  s_add_u32 m0, s55, 1024
  s_add_u32 s62, s54, 9984
  buffer_load_dwordx4 v65, s[4:7], s62 offen lds
  s_add_u32 m0, s55, 2048
  s_add_u32 s62, s54, 19200
  buffer_load_dwordx4 v64, s[4:7], s62 offen lds
  s_waitcnt lgkmcnt(6)
  v_mfma_f32_32x32x16_bf16 v[0:15], v[200:203], a[88:91], v[0:15]
  s_add_u32 m0, s55, 3072
  s_add_u32 s62, s54, 28416
  buffer_load_dwordx4 v65, s[4:7], s62 offen lds
  s_add_u32 m0, s55, 4096
  s_add_u32 s62, s54, 37632
  buffer_load_dwordx4 v64, s[4:7], s62 offen lds
  v_mfma_f32_32x32x16_bf16 v[16:31], v[200:203], a[92:95], v[16:31]
  ds_read_b64_tr_b16 v[200:201], v226 offset:26624
  ds_read_b64_tr_b16 v[202:203], v226 offset:27136
  s_add_u32 m0, s55, 5120
  s_add_u32 s62, s54, 46848
  buffer_load_dwordx4 v65, s[4:7], s62 offen lds
  s_add_u32 m0, s55, 6144
  s_add_u32 s62, s54, 56064
  buffer_load_dwordx4 v64, s[4:7], s62 offen lds
  s_waitcnt lgkmcnt(6)
  v_mfma_f32_32x32x16_bf16 v[32:47], v[204:207], a[88:91], v[32:47]
  s_add_u32 m0, s55, 7168
  s_add_u32 s62, s54, 65280
  buffer_load_dwordx4 v65, s[4:7], s62 offen lds
  s_sub_u32 s62, s101, 36
  s_lshl_b32 s62, s62, 5
  s_cmp_ge_u32 s101, 36
  s_cselect_b32 s67, s62, 0
  s_mul_i32 s64, s64, 1152
  s_mul_i32 s62, s100, 42
  s_add_u32 s62, s62, s101
  s_mul_i32 s65, s62, 36864
  s_add_u32 s65, s65, 22020096
  s_add_u32 s65, s65, s59
  s_mul_i32 s66, s3, 9216
  s_add_u32 s66, s66, 90112
  v_mfma_f32_32x32x16_bf16 v[48:63], v[204:207], a[92:95], v[48:63]
  ds_read_b64_tr_b16 v[204:205], v227 offset:26624
  ds_read_b64_tr_b16 v[206:207], v227 offset:27136
  s_waitcnt lgkmcnt(6)
  v_mfma_f32_32x32x16_bf16 v[0:15], v[192:195], a[96:99], v[0:15]
  s_waitcnt vmcnt(28)
  ds_read_b128 a[128:131], v66 offset:32768
  ds_read_b128 a[132:135], v66 offset:36864
  v_mfma_f32_32x32x16_bf16 v[16:31], v[192:195], a[100:103], v[16:31]
  ds_read_b64_tr_b16 v[192:193], v226 offset:28672
  ds_read_b64_tr_b16 v[194:195], v226 offset:29184
  ds_read_b128 a[136:139], v67 offset:32768
  ds_read_b128 a[140:143], v67 offset:36864
  s_waitcnt lgkmcnt(10)
  v_mfma_f32_32x32x16_bf16 v[32:47], v[196:199], a[96:99], v[32:47]
  ds_read_b128 a[144:147], v68 offset:32768
  ds_read_b128 a[148:151], v68 offset:36864
  s_lshl_b32 s62, s100, 1
  s_lshr_b32 s63, s101, 5
  s_add_u32 s62, s62, s63
  s_lshl_b32 s62, s62, 9
  s_and_b32 s63, s101, 31
  s_lshl_b32 s63, s63, 2
  s_add_u32 s62, s62, s63
  s_add_u32 s84, s62, 49283456
  v_mfma_f32_32x32x16_bf16 v[48:63], v[196:199], a[100:103], v[48:63]
  ds_read_b64_tr_b16 v[196:197], v227 offset:28672
  ds_read_b64_tr_b16 v[198:199], v227 offset:29184
  ds_read_b128 a[152:155], v69 offset:32768
  ds_read_b128 a[156:159], v69 offset:36864
  s_waitcnt lgkmcnt(14)
  v_mfma_f32_32x32x16_bf16 v[0:15], v[200:203], a[104:107], v[0:15]
  v_mfma_f32_32x32x16_bf16 v[16:31], v[200:203], a[108:111], v[16:31]
  ds_read_b64_tr_b16 v[200:201], v226 offset:30720
  ds_read_b64_tr_b16 v[202:203], v226 offset:31232
  s_lshl_b32 s62, s2, 9
  s_add_u32 s62, s62, 49283072
  v_mov_b32 v220, 0
  v_mov_b32 v221, 0
  v_mov_b32 v222, 0
  v_mov_b32 v223, 0
  s_mov_b32 exec_hi, 0
  buffer_store_dwordx4 v[220:223], v224, s[20:23], s62 offen sc1
  s_mov_b64 exec, -1
  s_waitcnt lgkmcnt(14)
  v_mfma_f32_32x32x16_bf16 v[32:47], v[204:207], a[104:107], v[32:47]
  v_mfma_f32_32x32x16_bf16 v[48:63], v[204:207], a[108:111], v[48:63]
  ds_read_b64_tr_b16 v[204:205], v227 offset:30720
  ds_read_b64_tr_b16 v[206:207], v227 offset:31232
  s_and_b32 s0, s2, 63
  s_lshl_b32 s0, s0, 2
  s_add_u32 s0, s0, 0
  s_and_b32 s62, s50, 1
  s_lshl_b32 s52, s49, 1
  s_add_u32 s52, s52, s62
  s_lshr_b32 s53, s50, 1
  s_waitcnt lgkmcnt(12)
  v_mfma_f32_32x32x16_bf16 v[0:15], v[192:195], a[112:115], v[0:15]
  v_mfma_f32_32x32x16_bf16 v[16:31], v[192:195], a[116:119], v[16:31]
  ds_read_b64_tr_b16 v[192:193], v226 offset:32768
  ds_read_b64_tr_b16 v[194:195], v226 offset:33280
  s_mul_i32 s58, s3, 55296
  s_mul_i32 s62, s51, 36
  s_add_u32 s58, s58, s62
  s_and_b32 s62, s3, 1
  s_mul_i32 s60, s62, 884736
  s_lshl_b32 s62, s51, 5
  s_add_u32 s60, s60, s62
  s_add_u32 s60, s60, 8192
  s_waitcnt lgkmcnt(8)
  v_mfma_f32_32x32x16_bf16 v[32:47], v[196:199], a[112:115], v[32:47]
  s_waitcnt lgkmcnt(6)
  s_add_u32 m0, s55, 32768
  s_add_u32 s62, s54, 896
  buffer_load_dwordx4 v64, s[4:7], s62 offen lds
  s_add_u32 m0, s55, 33792
  s_add_u32 s62, s54, 10112
  buffer_load_dwordx4 v65, s[4:7], s62 offen lds
  v_mfma_f32_32x32x16_bf16 v[48:63], v[196:199], a[116:119], v[48:63]
  ds_read_b64_tr_b16 v[196:197], v227 offset:32768
  ds_read_b64_tr_b16 v[198:199], v227 offset:33280
  s_add_u32 m0, s55, 34816
  s_add_u32 s62, s54, 19328
  buffer_load_dwordx4 v64, s[4:7], s62 offen lds
  s_add_u32 m0, s55, 35840
  s_add_u32 s62, s54, 28544
  buffer_load_dwordx4 v65, s[4:7], s62 offen lds
  s_waitcnt lgkmcnt(6)
  v_mfma_f32_32x32x16_bf16 v[0:15], v[200:203], a[120:123], v[0:15]
  s_add_u32 m0, s55, 36864
  s_add_u32 s62, s54, 37760
  buffer_load_dwordx4 v64, s[4:7], s62 offen lds
  s_add_u32 m0, s55, 37888
  s_add_u32 s62, s54, 46976
  buffer_load_dwordx4 v65, s[4:7], s62 offen lds
  v_mfma_f32_32x32x16_bf16 v[16:31], v[200:203], a[124:127], v[16:31]
  ds_read_b64_tr_b16 v[200:201], v226 offset:34816
  ds_read_b64_tr_b16 v[202:203], v226 offset:35328
  s_add_u32 m0, s55, 38912
  s_add_u32 s62, s54, 56192
  buffer_load_dwordx4 v64, s[4:7], s62 offen lds
  s_add_u32 m0, s55, 39936
  s_add_u32 s62, s54, 65408
  buffer_load_dwordx4 v65, s[4:7], s62 offen lds
  s_waitcnt lgkmcnt(6)
  v_mfma_f32_32x32x16_bf16 v[32:47], v[204:207], a[120:123], v[32:47]
  v_mfma_f32_32x32x16_bf16 v[48:63], v[204:207], a[124:127], v[48:63]
  ds_read_b64_tr_b16 v[204:205], v227 offset:34816
  ds_read_b64_tr_b16 v[206:207], v227 offset:35328
  s_waitcnt lgkmcnt(6)
  v_mfma_f32_32x32x16_bf16 v[0:15], v[192:195], a[128:131], v[0:15]
  s_waitcnt vmcnt(20)
  ds_read_b128 a[160:163], v70 offset:0
  ds_read_b128 a[164:167], v70 offset:4096
  s_lshr_b32 s62, s3, 1
  s_lshl_b32 s63, s49, 1
  s_add_u32 s62, s62, s63
  s_lshl_b32 s62, s62, 2
  s_add_u32 s62, s62, s48
  s_lshl_b32 s62, s62, 2
  s_and_b32 s63, s3, 1
  s_lshl_b32 s63, s63, 1
  s_add_u32 s62, s62, s63
  s_mul_i32 s77, s62, 86016
  v_mfma_f32_32x32x16_bf16 v[16:31], v[192:195], a[132:135], v[16:31]
  s_barrier
  ds_read_b64_tr_b16 v[192:193], v226 offset:36864
  ds_read_b64_tr_b16 v[194:195], v226 offset:37376
  ds_read_b128 a[168:171], v71 offset:0
  ds_read_b128 a[172:175], v71 offset:4096
  s_waitcnt lgkmcnt(10)
  v_mfma_f32_32x32x16_bf16 v[32:47], v[196:199], a[128:131], v[32:47]
  ds_read_b128 a[176:179], v72 offset:0
  ds_read_b128 a[180:183], v72 offset:4096
  v_mfma_f32_32x32x16_bf16 v[48:63], v[196:199], a[132:135], v[48:63]
  ds_read_b64_tr_b16 v[196:197], v227 offset:36864
  ds_read_b64_tr_b16 v[198:199], v227 offset:37376
  ds_read_b128 a[184:187], v73 offset:0
  ds_read_b128 a[188:191], v73 offset:4096
  s_waitcnt lgkmcnt(14)
  v_mfma_f32_32x32x16_bf16 v[0:15], v[200:203], a[136:139], v[0:15]
  s_add_u32 m0, s57, 12288
  s_add_u32 s62, s56, 0
  buffer_load_dwordx4 v225, s[12:15], s62 offen lds
  s_add_u32 m0, s57, 13312
  s_add_u32 s62, s56, 73728
  buffer_load_dwordx4 v225, s[12:15], s62 offen lds
  v_mfma_f32_32x32x16_bf16 v[16:31], v[200:203], a[140:143], v[16:31]
  ds_read_b64_tr_b16 v[200:201], v226 offset:38912
  ds_read_b64_tr_b16 v[202:203], v226 offset:39424
  s_add_u32 m0, s57, 14336
  s_add_u32 s62, s56, 147456
  buffer_load_dwordx4 v225, s[12:15], s62 offen lds
  s_waitcnt lgkmcnt(14)
  v_mfma_f32_32x32x16_bf16 v[32:47], v[204:207], a[136:139], v[32:47]
  s_lshl_b32 s62, s50, 12
  s_add_u32 s61, s77, s62
  s_lshr_b32 s62, s50, 1
  s_add_u32 s62, s62, 32
  s_lshl_b32 s62, s62, 11
  s_add_u32 s76, s77, s62
  s_and_b32 s62, s50, 1
  s_lshl_b32 s62, s62, 9
  s_add_u32 s76, s76, s62
  v_mfma_f32_32x32x16_bf16 v[48:63], v[204:207], a[140:143], v[48:63]
  ds_read_b64_tr_b16 v[204:205], v227 offset:38912
  ds_read_b64_tr_b16 v[206:207], v227 offset:39424
  s_waitcnt lgkmcnt(12)
  v_mfma_f32_32x32x16_bf16 v[0:15], v[192:195], a[144:147], v[0:15]
  s_lshl_b32 s62, s51, 9
  s_add_u32 s70, s62, 49283200
  s_lshl_b32 s62, s49, 2
  s_add_u32 s62, s62, s48
  s_lshl_b32 s62, s62, 9
  s_add_u32 s71, s62, 49283328
  s_lshl_b32 s62, s48, 10
  s_add_u32 s72, s62, 49283456
  v_mfma_f32_32x32x16_bf16 v[16:31], v[192:195], a[148:151], v[16:31]
  ds_read_b64_tr_b16 v[192:193], v226 offset:40960
  ds_read_b64_tr_b16 v[194:195], v226 offset:41472
  s_waitcnt lgkmcnt(8)
  v_mfma_f32_32x32x16_bf16 v[32:47], v[196:199], a[144:147], v[32:47]
  s_waitcnt lgkmcnt(6)
  s_add_u32 m0, s55, 65536
  s_add_u32 s62, s54, 1024
  buffer_load_dwordx4 v64, s[4:7], s62 offen lds
  s_add_u32 m0, s55, 66560
  s_add_u32 s62, s54, 10240
  buffer_load_dwordx4 v65, s[4:7], s62 offen lds
  v_mfma_f32_32x32x16_bf16 v[48:63], v[196:199], a[148:151], v[48:63]
  ds_read_b64_tr_b16 v[196:197], v227 offset:40960
  ds_read_b64_tr_b16 v[198:199], v227 offset:41472
  s_add_u32 m0, s55, 67584
  s_add_u32 s62, s54, 19456
  buffer_load_dwordx4 v64, s[4:7], s62 offen lds
  s_add_u32 m0, s55, 68608
  s_add_u32 s62, s54, 28672
  buffer_load_dwordx4 v65, s[4:7], s62 offen lds
  s_waitcnt lgkmcnt(6)
  v_mfma_f32_32x32x16_bf16 v[0:15], v[200:203], a[152:155], v[0:15]
  s_add_u32 m0, s55, 69632
  s_add_u32 s62, s54, 37888
  buffer_load_dwordx4 v64, s[4:7], s62 offen lds
  s_add_u32 m0, s55, 70656
  s_add_u32 s62, s54, 47104
  buffer_load_dwordx4 v65, s[4:7], s62 offen lds
  v_mfma_f32_32x32x16_bf16 v[16:31], v[200:203], a[156:159], v[16:31]
  ds_read_b64_tr_b16 v[200:201], v226 offset:43008
  ds_read_b64_tr_b16 v[202:203], v226 offset:43520
  s_add_u32 m0, s55, 71680
  s_add_u32 s62, s54, 56320
  buffer_load_dwordx4 v64, s[4:7], s62 offen lds
  s_add_u32 m0, s55, 72704
  s_add_u32 s62, s54, 65536
  buffer_load_dwordx4 v65, s[4:7], s62 offen lds
  s_waitcnt lgkmcnt(6)
  v_mfma_f32_32x32x16_bf16 v[32:47], v[204:207], a[152:155], v[32:47]
  s_lshl_b32 s62, s52, 2
  s_add_u32 s62, s62, s53
  s_lshl_b32 s62, s62, 2
  s_lshl_b32 s73, s62, 9
  s_add_u32 s73, s73, 49283072
  v_mfma_f32_32x32x16_bf16 v[48:63], v[204:207], a[156:159], v[48:63]
  ds_read_b64_tr_b16 v[204:205], v227 offset:43008
  ds_read_b64_tr_b16 v[206:207], v227 offset:43520
  s_waitcnt lgkmcnt(6)
  v_mfma_f32_32x32x16_bf16 v[0:15], v[192:195], a[160:163], v[0:15]
  s_waitcnt vmcnt(20)
  ds_read_b128 a[192:195], v66 offset:0
  ds_read_b128 a[196:199], v66 offset:4096
  s_min_u32 s63, s3, 2
  s_lshl_b32 s63, s63, 10
  s_mul_i32 s62, s51, 24576
  s_add_u32 s62, s62, 48234496
  s_add_u32 s75, s62, s63
  s_mul_i32 s62, s49, 3072
  s_add_u32 s74, s75, s62
  v_mfma_f32_32x32x16_bf16 v[16:31], v[192:195], a[164:167], v[16:31]
  ds_read_b64_tr_b16 v[192:193], v226 offset:45056
  ds_read_b64_tr_b16 v[194:195], v226 offset:45568
  ds_read_b128 a[200:203], v67 offset:0
  ds_read_b128 a[204:207], v67 offset:4096
  s_waitcnt lgkmcnt(10)
  v_mfma_f32_32x32x16_bf16 v[32:47], v[196:199], a[160:163], v[32:47]
  ds_read_b128 a[208:211], v68 offset:0
  ds_read_b128 a[212:215], v68 offset:4096
  v_mfma_f32_32x32x16_bf16 v[48:63], v[196:199], a[164:167], v[48:63]
  ds_read_b64_tr_b16 v[196:197], v227 offset:45056
  ds_read_b64_tr_b16 v[198:199], v227 offset:45568
  ds_read_b128 a[216:219], v69 offset:0
  ds_read_b128 a[220:223], v69 offset:4096
  s_waitcnt lgkmcnt(14)
  v_mfma_f32_32x32x16_bf16 v[0:15], v[200:203], a[168:171], v[0:15]
  s_lshl_b32 s62, s52, 2
  s_add_u32 s62, s62, s48
  s_lshl_b32 s62, s62, 2
  s_add_u32 s62, s62, s3
  s_mul_i32 s78, s62, 86016
  s_mul_i32 s79, s48, 1548288
  s_mul_i32 s62, s53, 9216
  s_add_u32 s79, s79, s62
  s_add_u32 s79, s79, 22020096
  v_mfma_f32_32x32x16_bf16 v[16:31], v[200:203], a[172:175], v[16:31]
  ds_read_b64_tr_b16 v[200:201], v226 offset:47104
  ds_read_b64_tr_b16 v[202:203], v226 offset:47616
  s_waitcnt lgkmcnt(14)
  v_mfma_f32_32x32x16_bf16 v[32:47], v[204:207], a[168:171], v[32:47]
  v_mfma_f32_32x32x16_bf16 v[48:63], v[204:207], a[172:175], v[48:63]
  ds_read_b64_tr_b16 v[204:205], v227 offset:47104
  ds_read_b64_tr_b16 v[206:207], v227 offset:47616
  s_lshl_b32 s62, s52, 2
  s_add_u32 s62, s62, s53
  s_lshl_b32 s62, s62, 2
  s_add_u32 s63, s62, s3
  s_lshl_b32 s63, s63, 2
  s_add_u32 s63, s63, s48
  s_mul_i32 s80, s63, 9216
  s_add_u32 s80, s80, 28311552
  s_add_u32 s63, s62, s48
  s_lshl_b32 s63, s63, 2
  s_mul_i32 s81, s63, 9216
  s_add_u32 s81, s81, 28311552
  s_waitcnt lgkmcnt(12)
  v_mfma_f32_32x32x16_bf16 v[0:15], v[192:195], a[176:179], v[0:15]
  s_lshl_b32 s62, s52, 2
  s_add_u32 s62, s62, s48
  s_mul_i32 s85, s62, 36864
  s_mul_i32 s62, s53, 288
  s_add_u32 s85, s85, s62
  v_mfma_f32_32x32x16_bf16 v[16:31], v[192:195], a[180:183], v[16:31]
  s_barrier
  ds_read_b64_tr_b16 v[192:193], v226 offset:49152
  ds_read_b64_tr_b16 v[194:195], v226 offset:49664
  s_add_u32 m0, s57, 24576
  s_add_u32 s62, s56, 884736
  buffer_load_dwordx4 v225, s[12:15], s62 offen lds
  s_add_u32 m0, s57, 25600
  s_add_u32 s62, s56, 958464
  buffer_load_dwordx4 v225, s[12:15], s62 offen lds
  s_waitcnt lgkmcnt(8)
  v_mfma_f32_32x32x16_bf16 v[32:47], v[196:199], a[176:179], v[32:47]
  s_add_u32 m0, s57, 26624
  s_add_u32 s62, s56, 1032192
  buffer_load_dwordx4 v225, s[12:15], s62 offen lds
  v_min_u32 v252, 15, v249
  v_lshlrev_b32 v252, 7, v252
  s_lshl_b32 s63, s3, 11
  s_add_u32 s62, s94, s63
  s_add_u32 s62, s62, 0
  buffer_load_dword v250, v252, s[16:19], s62 offen
  v_mfma_f32_32x32x16_bf16 v[48:63], v[196:199], a[180:183], v[48:63]
  ds_read_b64_tr_b16 v[196:197], v227 offset:49152
  ds_read_b64_tr_b16 v[198:199], v227 offset:49664
  s_lshl_b32 s63, s51, 8
  s_add_u32 s63, s63, 128
  s_add_u32 s62, s44, s63
  s_add_u32 s62, s62, 0
  v_min_u32 v252, 17, v249
  v_mul_u32_u24 v252, 9216, v252
  buffer_load_dword v250, v252, s[8:11], s62 offen
  s_lshl_b32 s63, s51, 8
  s_add_u32 s63, s63, 128
  s_add_u32 s62, s44, s63
  s_add_u32 s62, s62, 0
  v_min_u32 v252, 17, v249
  v_mul_u32_u24 v252, 9216, v252
  buffer_load_dword v250, v252, s[12:15], s62 offen
  s_waitcnt lgkmcnt(6)
  v_mfma_f32_32x32x16_bf16 v[0:15], v[200:203], a[184:187], v[0:15]
  s_mul_i32 s62, s49, 72
  s_and_b32 s63, s51, 3
  s_mul_i32 s63, s63, 18
  s_add_u32 s62, s62, s63
  s_and_b32 s63, s3, 1
  s_mul_i32 s63, s63, 9
  s_add_u32 s62, s62, s63
  s_mul_i32 s62, s62, 9216
  s_lshr_b32 s63, s51, 2
  s_lshl_b32 s63, s63, 7
  s_add_u32 s62, s62, s63
  s_add_u32 s62, s62, 8192
  v_min_u32 v252, 8, v249
  v_mul_u32_u24 v252, 9216, v252
  buffer_load_dword v250, v252, s[24:27], s62 offen
  v_mfma_f32_32x32x16_bf16 v[16:31], v[200:203], a[188:191], v[16:31]
  ds_read_b64_tr_b16 v[200:201], v226 offset:51200
  ds_read_b64_tr_b16 v[202:203], v226 offset:51712
  s_waitcnt lgkmcnt(6)
  v_mfma_f32_32x32x16_bf16 v[32:47], v[204:207], a[184:187], v[32:47]
  v_mfma_f32_32x32x16_bf16 v[48:63], v[204:207], a[188:191], v[48:63]
  ds_read_b64_tr_b16 v[204:205], v227 offset:51200
  ds_read_b64_tr_b16 v[206:207], v227 offset:51712
  s_waitcnt lgkmcnt(6)
  v_mfma_f32_32x32x16_bf16 v[0:15], v[192:195], a[192:195], v[0:15]
  s_waitcnt vmcnt(18)
  ds_read_b128 a[224:227], v66 offset:32768
  ds_read_b128 a[228:231], v66 offset:36864
  s_mov_b32 s86, 0xfff00000
  s_mov_b32 s87, 0xfff00000
  s_mov_b32 s88, 0x13f00000
  s_mov_b32 s89, 0x13f00000
  s_mov_b32 s90, 0x140000
  s_mov_b32 s91, 0x140000
  s_mov_b32 s96, 0x77777777
  s_mov_b32 s97, 0x77777777
  s_mov_b32 s98, 0x10000000
  s_mov_b32 s99, 0x10000000
  s_mov_b32 s92, -1
  s_mov_b32 s93, 0
  v_mfma_f32_32x32x16_bf16 v[16:31], v[192:195], a[196:199], v[16:31]
  ds_read_b64_tr_b16 v[192:193], v226 offset:53248
  ds_read_b64_tr_b16 v[194:195], v226 offset:53760
  ds_read_b128 a[232:235], v67 offset:32768
  ds_read_b128 a[236:239], v67 offset:36864
  s_waitcnt lgkmcnt(10)
  v_mfma_f32_32x32x16_bf16 v[32:47], v[196:199], a[192:195], v[32:47]
  ds_read_b128 a[240:243], v68 offset:32768
  ds_read_b128 a[244:247], v68 offset:36864
  v_mfma_f32_32x32x16_bf16 v[48:63], v[196:199], a[196:199], v[48:63]
  ds_read_b64_tr_b16 v[196:197], v227 offset:53248
  ds_read_b64_tr_b16 v[198:199], v227 offset:53760
  ds_read_b128 a[248:251], v69 offset:32768
  ds_read_b128 a[252:255], v69 offset:36864
  s_waitcnt lgkmcnt(14)
  v_mfma_f32_32x32x16_bf16 v[0:15], v[200:203], a[200:203], v[0:15]
  v_lshrrev_b32 v212, 4, v208
  v_lshlrev_b32 v212, 10, v212
  v_and_b32 v213, 15, v208
  v_lshl_add_u32 v212, v213, 4, v212
  v_lshl_add_u32 v228, v209, 9, v212
  v_lshl_add_u32 v234, v209, 8, v212
  v_add_u32 v253, 0x10000, v226
  v_add_u32 v254, 0x10000, v227
  v_mfma_f32_32x32x16_bf16 v[16:31], v[200:203], a[204:207], v[16:31]
  ds_read_b64_tr_b16 v[200:201], v226 offset:55296
  ds_read_b64_tr_b16 v[202:203], v226 offset:55808
  v_mul_u32_u24 v218, 6144, v214
  v_lshl_add_u32 v218, v217, 5, v218
  v_and_b32 v219, 1, v216
  v_lshl_add_u32 v218, v219, 4, v218
  v_lshrrev_b32 v219, 1, v216
  v_lshl_add_u32 v233, v219, 3, v218
  s_waitcnt lgkmcnt(14)
  v_mfma_f32_32x32x16_bf16 v[32:47], v[204:207], a[200:203], v[32:47]
  v_mfma_f32_32x32x16_bf16 v[48:63], v[204:207], a[204:207], v[48:63]
  ds_read_b64_tr_b16 v[204:205], v227 offset:55296
  ds_read_b64_tr_b16 v[206:207], v227 offset:55808
  v_lshl_add_u32 v218, v214, 2, v216
  v_lshlrev_b32 v219, 6, v217
  v_lshlrev_b32 v220, 3, v218
  v_add_u32 v221, 4096, v220
  v_add_u32 v222, -40, v220
  v_cmp_gt_u32 vcc, 5, v218
  s_nop 1
  v_cndmask_b32 v221, v222, v221, vcc
  v_add_u32 v230, v221, v219
  s_waitcnt lgkmcnt(12)
  v_mfma_f32_32x32x16_bf16 v[0:15], v[192:195], a[208:211], v[0:15]
  v_mfma_f32_32x32x16_bf16 v[16:31], v[192:195], a[212:215], v[16:31]
  ds_read_b64_tr_b16 v[192:193], v226 offset:57344
  ds_read_b64_tr_b16 v[194:195], v226 offset:57856
  s_waitcnt lgkmcnt(8)
  v_mfma_f32_32x32x16_bf16 v[32:47], v[196:199], a[208:211], v[32:47]
  v_add_u32 v221, 8192, v220
  v_add_u32 v222, -16, v220
  v_cmp_gt_u32 vcc, 5, v218
  s_nop 1
  v_cndmask_b32 v222, v222, v221, vcc
  v_mov_b32 v221, 48
  v_cmp_eq_u32 vcc, 7, v218
  s_nop 1
  v_cndmask_b32 v222, v222, v221, vcc
  v_add_u32 v231, v222, v219
  v_mfma_f32_32x32x16_bf16 v[48:63], v[196:199], a[212:215], v[48:63]
  ds_read_b64_tr_b16 v[196:197], v227 offset:57344
  ds_read_b64_tr_b16 v[198:199], v227 offset:57856
  s_waitcnt lgkmcnt(6)
  v_mfma_f32_32x32x16_bf16 v[0:15], v[200:203], a[216:219], v[0:15]
  v_lshrrev_b32 v219, 2, v249
  v_mul_u32_u24 v219, 3456, v219
  v_lshl_add_u32 v229, v216, 4, v219
  v_lshrrev_b32 v219, 1, v249
  v_mul_u32_u24 v219, 9216, v219
  v_and_b32 v220, 1, v249
  v_lshl_add_u32 v232, v220, 4, v219
  v_mfma_f32_32x32x16_bf16 v[16:31], v[200:203], a[220:223], v[16:31]
  ds_read_b64_tr_b16 v[200:201], v226 offset:59392
  ds_read_b64_tr_b16 v[202:203], v226 offset:59904
  s_waitcnt lgkmcnt(6)
  v_mfma_f32_32x32x16_bf16 v[32:47], v[204:207], a[216:219], v[32:47]
  v_lshrrev_b32 v220, 3, v249
  s_lshl_b32 s62, s3, 3
  v_add_u32 v220, s62, v220
  v_add_u32 v221, s67, v220
  v_mul_u32_u24 v222, 2731, v221
  v_lshrrev_b32 v222, 16, v222
  v_mul_u32_u24 v223, 24, v222
  v_sub_u32 v223, v221, v223
  v_mfma_f32_32x32x16_bf16 v[48:63], v[204:207], a[220:223], v[48:63]
  ds_read_b64_tr_b16 v[204:205], v227 offset:59392
  ds_read_b64_tr_b16 v[206:207], v227 offset:59904
  s_waitcnt lgkmcnt(6)
  v_mfma_f32_32x32x16_bf16 v[0:15], v[192:195], a[224:227], v[0:15]
  s_waitcnt vmcnt(7)
  ds_read_b128 v[160:163], v70 offset:0
  ds_read_b128 v[164:167], v70 offset:4096
  v_mul_lo_u32 v222, v222, s68
  v_sub_u32 v221, v221, v222
  v_mul_u32_u24 v221, 1152, v221
  v_and_b32 v222, 7, v249
  v_lshl_add_u32 v221, v222, 4, v221
  v_mov_b32 v222, 0x7fff0000
  v_cmp_gt_u32 vcc, s69, v223
  s_nop 1
  v_cndmask_b32 v245, v222, v221, vcc
  v_mfma_f32_32x32x16_bf16 v[16:31], v[192:195], a[228:231], v[16:31]
  s_barrier
  ds_read_b64_tr_b16 v[192:193], v226 offset:0
  ds_read_b64_tr_b16 v[194:195], v226 offset:512
  ds_read_b128 v[168:171], v71 offset:0
  ds_read_b128 v[172:175], v71 offset:4096
  s_waitcnt lgkmcnt(10)
  v_mfma_f32_32x32x16_bf16 v[32:47], v[196:199], a[224:227], v[32:47]
  ds_read_b128 v[176:179], v72 offset:0
  ds_read_b128 v[180:183], v72 offset:4096
  v_mfma_f32_32x32x16_bf16 v[48:63], v[196:199], a[228:231], v[48:63]
  ds_read_b64_tr_b16 v[196:197], v227 offset:0
  ds_read_b64_tr_b16 v[198:199], v227 offset:512
  ds_read_b128 v[184:187], v73 offset:0
  ds_read_b128 v[188:191], v73 offset:4096
  s_waitcnt lgkmcnt(14)
  v_mfma_f32_32x32x16_bf16 v[0:15], v[200:203], a[232:235], v[0:15]
  s_add_u32 m0, s57, 36864
  s_add_u32 s62, s56, 1769472
  buffer_load_dwordx4 v225, s[12:15], s62 offen lds
  s_add_u32 m0, s57, 37888
  s_add_u32 s62, s56, 1843200
  buffer_load_dwordx4 v225, s[12:15], s62 offen lds
  v_mfma_f32_32x32x16_bf16 v[16:31], v[200:203], a[236:239], v[16:31]
  ds_read_b64_tr_b16 v[200:201], v226 offset:2048
  ds_read_b64_tr_b16 v[202:203], v226 offset:2560
  s_add_u32 m0, s57, 38912
  s_add_u32 s62, s56, 1916928
  buffer_load_dwordx4 v225, s[12:15], s62 offen lds
  s_waitcnt lgkmcnt(14)
  v_mfma_f32_32x32x16_bf16 v[32:47], v[204:207], a[232:235], v[32:47]
  v_lshrrev_b32 v221, 4, v249
  v_mul_u32_u24 v221, 9216, v221
  v_lshl_add_u32 v221, v215, 7, v221
  v_lshl_add_u32 v221, v216, 3, v221
  s_lshl_b32 s62, s3, 5
  s_add_u32 s62, s62, 90112
  v_add_u32 v246, s62, v221
  v_mfma_f32_32x32x16_bf16 v[48:63], v[204:207], a[236:239], v[48:63]
  ds_read_b64_tr_b16 v[204:205], v227 offset:2048
  ds_read_b64_tr_b16 v[206:207], v227 offset:2560
  s_waitcnt lgkmcnt(12)
  v_mfma_f32_32x32x16_bf16 v[0:15], v[192:195], a[240:243], v[0:15]
  s_mul_i32 s62, s3, 4352
  s_add_u32 s62, s62, 126976
  v_add_u32 v221, -20, v208
  v_mul_i32_i24 v221, 136, v221
  v_lshl_add_u32 v221, v209, 3, v221
  v_add_u32 v247, s62, v221
  v_lshl_add_u32 v221, v209, 2, v215
  v_mul_u32_u24 v221, 136, v221
  v_lshl_add_u32 v221, v214, 5, v221
  v_lshl_add_u32 v221, v216, 3, v221
  v_add_u32 v248, s62, v221
  v_mfma_f32_32x32x16_bf16 v[16:31], v[192:195], a[244:247], v[16:31]
  ds_read_b64_tr_b16 v[192:193], v226 offset:4096
  ds_read_b64_tr_b16 v[194:195], v226 offset:4608
  s_waitcnt lgkmcnt(8)
  v_mfma_f32_32x32x16_bf16 v[32:47], v[196:199], a[240:243], v[32:47]
  v_mfma_f32_32x32x16_bf16 v[48:63], v[196:199], a[244:247], v[48:63]
  ds_read_b64_tr_b16 v[196:197], v227 offset:4096
  ds_read_b64_tr_b16 v[198:199], v227 offset:4608
  s_waitcnt lgkmcnt(6)
  v_mfma_f32_32x32x16_bf16 v[0:15], v[200:203], a[248:251], v[0:15]
  v_mfma_f32_32x32x16_bf16 v[16:31], v[200:203], a[252:255], v[16:31]
  ds_read_b64_tr_b16 v[200:201], v226 offset:6144
  ds_read_b64_tr_b16 v[202:203], v226 offset:6656
  s_waitcnt lgkmcnt(6)
  v_mfma_f32_32x32x16_bf16 v[32:47], v[204:207], a[248:251], v[32:47]
  v_mfma_f32_32x32x16_bf16 v[48:63], v[204:207], a[252:255], v[48:63]
  ds_read_b64_tr_b16 v[204:205], v227 offset:6144
  ds_read_b64_tr_b16 v[206:207], v227 offset:6656
  s_waitcnt lgkmcnt(6)
  v_mfma_f32_32x32x16_bf16 v[0:15], v[192:195], v[160:163], v[0:15]
  v_mfma_f32_32x32x16_bf16 v[16:31], v[192:195], v[164:167], v[16:31]
  ds_read_b64_tr_b16 v[192:193], v226 offset:8192
  ds_read_b64_tr_b16 v[194:195], v226 offset:8704
  s_waitcnt lgkmcnt(6)
  v_mfma_f32_32x32x16_bf16 v[32:47], v[196:199], v[160:163], v[32:47]
  v_mfma_f32_32x32x16_bf16 v[48:63], v[196:199], v[164:167], v[48:63]
  ds_read_b64_tr_b16 v[196:197], v227 offset:8192
  ds_read_b64_tr_b16 v[198:199], v227 offset:8704
  s_waitcnt lgkmcnt(6)
  v_mfma_f32_32x32x16_bf16 v[0:15], v[200:203], v[168:171], v[0:15]
  v_mfma_f32_32x32x16_bf16 v[16:31], v[200:203], v[172:175], v[16:31]
  ds_read_b64_tr_b16 v[200:201], v226 offset:10240
  ds_read_b64_tr_b16 v[202:203], v226 offset:10752
  s_waitcnt lgkmcnt(6)
  v_mfma_f32_32x32x16_bf16 v[32:47], v[204:207], v[168:171], v[32:47]
  v_mfma_f32_32x32x16_bf16 v[48:63], v[204:207], v[172:175], v[48:63]
  ds_read_b64_tr_b16 v[204:205], v227 offset:10240
  ds_read_b64_tr_b16 v[206:207], v227 offset:10752
  s_waitcnt lgkmcnt(6)
  v_mfma_f32_32x32x16_bf16 v[0:15], v[192:195], v[176:179], v[0:15]
  v_mfma_f32_32x32x16_bf16 v[16:31], v[192:195], v[180:183], v[16:31]
  s_barrier
  ds_read_b64_tr_b16 v[192:193], v226 offset:12288
  ds_read_b64_tr_b16 v[194:195], v226 offset:12800
  s_add_u32 m0, s57, 49152
  s_add_u32 s62, s56, 2654208
  buffer_load_dwordx4 v225, s[12:15], s62 offen lds
  s_add_u32 m0, s57, 50176
  s_add_u32 s62, s56, 2727936
  buffer_load_dwordx4 v225, s[12:15], s62 offen lds
  s_waitcnt lgkmcnt(6)
  v_mfma_f32_32x32x16_bf16 v[32:47], v[196:199], v[176:179], v[32:47]
  s_add_u32 m0, s57, 51200
  s_add_u32 s62, s56, 2801664
  buffer_load_dwordx4 v225, s[12:15], s62 offen lds
  v_mfma_f32_32x32x16_bf16 v[48:63], v[196:199], v[180:183], v[48:63]
  ds_read_b64_tr_b16 v[196:197], v227 offset:12288
  ds_read_b64_tr_b16 v[198:199], v227 offset:12800
  s_waitcnt lgkmcnt(6)
  v_mfma_f32_32x32x16_bf16 v[0:15], v[200:203], v[184:187], v[0:15]
  v_mfma_f32_32x32x16_bf16 v[16:31], v[200:203], v[188:191], v[16:31]
  ds_read_b64_tr_b16 v[200:201], v226 offset:14336
  ds_read_b64_tr_b16 v[202:203], v226 offset:14848
  s_waitcnt lgkmcnt(6)
  v_mfma_f32_32x32x16_bf16 v[32:47], v[204:207], v[184:187], v[32:47]
  v_mfma_f32_32x32x16_bf16 v[48:63], v[204:207], v[188:191], v[48:63]
  ds_read_b64_tr_b16 v[204:205], v227 offset:14336
  ds_read_b64_tr_b16 v[206:207], v227 offset:14848
  s_waitcnt lgkmcnt(6)
  v_mfma_f32_32x32x16_bf16 v[64:79], v[192:195], a[0:3], 0
  v_mfma_f32_32x32x16_bf16 v[80:95], v[192:195], a[4:7], 0
  ds_read_b64_tr_b16 v[192:193], v226 offset:16384
  ds_read_b64_tr_b16 v[194:195], v226 offset:16896
  s_waitcnt lgkmcnt(6)
  v_mfma_f32_32x32x16_bf16 v[96:111], v[196:199], a[0:3], 0
  v_mfma_f32_32x32x16_bf16 v[112:127], v[196:199], a[4:7], 0
  ds_read_b64_tr_b16 v[196:197], v227 offset:16384
  ds_read_b64_tr_b16 v[198:199], v227 offset:16896
  s_waitcnt lgkmcnt(6)
  v_mfma_f32_32x32x16_bf16 v[64:79], v[200:203], a[8:11], v[64:79]
  v_mfma_f32_32x32x16_bf16 v[80:95], v[200:203], a[12:15], v[80:95]
  ds_read_b64_tr_b16 v[200:201], v226 offset:18432
  ds_read_b64_tr_b16 v[202:203], v226 offset:18944
  s_waitcnt lgkmcnt(6)
  v_mfma_f32_32x32x16_bf16 v[96:111], v[204:207], a[8:11], v[96:111]
  v_mul_f32 v208, 0xbfb8aa3b, v0
  v_mul_f32 v209, 0xbfb8aa3b, v1
  v_mul_f32 v210, 0xbfb8aa3b, v2
  v_mul_f32 v211, 0xbfb8aa3b, v3
  v_mfma_f32_32x32x16_bf16 v[112:127], v[204:207], a[12:15], v[112:127]
  ds_read_b64_tr_b16 v[204:205], v227 offset:18432
  ds_read_b64_tr_b16 v[206:207], v227 offset:18944
  v_exp_f32 v208, v208
  v_exp_f32 v209, v209
  s_waitcnt lgkmcnt(6)
  v_mfma_f32_32x32x16_bf16 v[64:79], v[192:195], a[16:19], v[64:79]
  v_exp_f32 v210, v210
  v_exp_f32 v211, v211
  v_add_f32 v208, 1.0, v208
  v_add_f32 v209, 1.0, v209
  v_mfma_f32_32x32x16_bf16 v[80:95], v[192:195], a[20:23], v[80:95]
  ds_read_b64_tr_b16 v[192:193], v226 offset:20480
  ds_read_b64_tr_b16 v[194:195], v226 offset:20992
  v_add_f32 v210, 1.0, v210
  v_add_f32 v211, 1.0, v211
  s_waitcnt lgkmcnt(6)
  v_mfma_f32_32x32x16_bf16 v[96:111], v[196:199], a[16:19], v[96:111]
  v_rcp_f32 v208, v208
  v_rcp_f32 v209, v209
  v_rcp_f32 v210, v210
  v_mfma_f32_32x32x16_bf16 v[112:127], v[196:199], a[20:23], v[112:127]
  ds_read_b64_tr_b16 v[196:197], v227 offset:20480
  ds_read_b64_tr_b16 v[198:199], v227 offset:20992
  v_rcp_f32 v211, v211
  v_mul_f32 v208, v0, v208
  v_mul_f32 v209, v1, v209
  s_waitcnt lgkmcnt(6)
  v_mfma_f32_32x32x16_bf16 v[64:79], v[200:203], a[24:27], v[64:79]
  v_mul_f32 v210, v2, v210
  v_mul_f32 v211, v3, v211
  v_cvt_pk_bf16_f32 v128, v208, v209
  v_cvt_pk_bf16_f32 v129, v210, v211
  v_mul_f32 v212, 0xbfb8aa3b, v4
  v_mfma_f32_32x32x16_bf16 v[80:95], v[200:203], a[28:31], v[80:95]
  ds_read_b64_tr_b16 v[200:201], v226 offset:22528
  ds_read_b64_tr_b16 v[202:203], v226 offset:23040
  v_mul_f32 v213, 0xbfb8aa3b, v5
  v_mul_f32 v214, 0xbfb8aa3b, v6
  v_mul_f32 v215, 0xbfb8aa3b, v7
  s_waitcnt lgkmcnt(6)
  v_mfma_f32_32x32x16_bf16 v[96:111], v[204:207], a[24:27], v[96:111]
  v_exp_f32 v212, v212
  v_exp_f32 v213, v213
  v_exp_f32 v214, v214
  v_mfma_f32_32x32x16_bf16 v[112:127], v[204:207], a[28:31], v[112:127]
  ds_read_b64_tr_b16 v[204:205], v227 offset:22528
  ds_read_b64_tr_b16 v[206:207], v227 offset:23040
  v_exp_f32 v215, v215
  v_add_f32 v212, 1.0, v212
  s_waitcnt lgkmcnt(6)
  v_mfma_f32_32x32x16_bf16 v[64:79], v[192:195], a[32:35], v[64:79]
  v_add_f32 v213, 1.0, v213
  v_add_f32 v214, 1.0, v214
  v_add_f32 v215, 1.0, v215
  v_rcp_f32 v212, v212
  v_mfma_f32_32x32x16_bf16 v[80:95], v[192:195], a[36:39], v[80:95]
  s_waitcnt vmcnt(10)
  s_barrier
  ds_read_b64_tr_b16 v[192:193], v226 offset:24576
  ds_read_b64_tr_b16 v[194:195], v226 offset:25088
  s_add_u32 m0, s57, 0
  s_add_u32 s62, s56, 3538944
  buffer_load_dwordx4 v225, s[12:15], s62 offen lds
  s_waitcnt lgkmcnt(6)
  v_mfma_f32_32x32x16_bf16 v[96:111], v[196:199], a[32:35], v[96:111]
  s_add_u32 m0, s57, 1024
  s_add_u32 s62, s56, 3612672
  buffer_load_dwordx4 v225, s[12:15], s62 offen lds
  v_rcp_f32 v213, v213
  v_mfma_f32_32x32x16_bf16 v[112:127], v[196:199], a[36:39], v[112:127]
  ds_read_b64_tr_b16 v[196:197], v227 offset:24576
  ds_read_b64_tr_b16 v[198:199], v227 offset:25088
  s_add_u32 m0, s57, 2048
  s_add_u32 s62, s56, 3686400
  buffer_load_dwordx4 v225, s[12:15], s62 offen lds
  v_rcp_f32 v214, v214
  s_waitcnt lgkmcnt(6)
  v_mfma_f32_32x32x16_bf16 v[64:79], v[200:203], a[40:43], v[64:79]
  s_add_u32 m0, s57, 65536
  s_add_u32 s62, s56, 4423680
  buffer_load_dwordx4 v225, s[12:15], s62 offen lds
  v_rcp_f32 v215, v215
  v_mfma_f32_32x32x16_bf16 v[80:95], v[200:203], a[44:47], v[80:95]
  ds_read_b64_tr_b16 v[200:201], v226 offset:26624
  ds_read_b64_tr_b16 v[202:203], v226 offset:27136
  s_add_u32 m0, s57, 66560
  s_add_u32 s62, s56, 4497408
  buffer_load_dwordx4 v225, s[12:15], s62 offen lds
  v_mul_f32 v212, v4, v212
  s_waitcnt lgkmcnt(6)
  v_mfma_f32_32x32x16_bf16 v[96:111], v[204:207], a[40:43], v[96:111]
  s_add_u32 m0, s57, 67584
  s_add_u32 s62, s56, 4571136
  buffer_load_dwordx4 v225, s[12:15], s62 offen lds
  v_mul_f32 v213, v5, v213
  v_mul_f32 v214, v6, v214
  v_mul_f32 v215, v7, v215
  v_mfma_f32_32x32x16_bf16 v[112:127], v[204:207], a[44:47], v[112:127]
  ds_read_b64_tr_b16 v[204:205], v227 offset:26624
  ds_read_b64_tr_b16 v[206:207], v227 offset:27136
  s_add_u32 m0, s59, 77824
  s_add_u32 s62, s58, 0
  s_mov_b64 exec, s[96:97]
  buffer_load_dwordx4 v229, s[16:19], s62 offen lds
  s_mov_b64 exec, -1
  s_waitcnt lgkmcnt(6)
  v_mfma_f32_32x32x16_bf16 v[64:79], v[192:195], a[48:51], v[64:79]
  s_add_u32 m0, s59, 81920
  s_add_u32 s62, s58, 1152
  s_mov_b64 exec, s[96:97]
  buffer_load_dwordx4 v229, s[16:19], s62 offen lds
  s_mov_b64 exec, -1
  v_cvt_pk_bf16_f32 v130, v212, v213
  v_mfma_f32_32x32x16_bf16 v[80:95], v[192:195], a[52:55], v[80:95]
  ds_read_b64_tr_b16 v[192:193], v226 offset:28672
  ds_read_b64_tr_b16 v[194:195], v226 offset:29184
  s_add_u32 m0, s59, 86016
  s_add_u32 s62, s58, 2304
  s_mov_b64 exec, s[96:97]
  buffer_load_dwordx4 v229, s[16:19], s62 offen lds
  s_mov_b64 exec, -1
  s_waitcnt lgkmcnt(6)
  v_mfma_f32_32x32x16_bf16 v[96:111], v[196:199], a[48:51], v[96:111]
  v_add_u32 v252, 0x10000, v235
  ds_write_b16 v252, v236 offset:12288
  v_cvt_pk_bf16_f32 v131, v214, v215
  v_mul_f32 v208, 0xbfb8aa3b, v8
  v_mul_f32 v209, 0xbfb8aa3b, v9
  v_mfma_f32_32x32x16_bf16 v[112:127], v[196:199], a[52:55], v[112:127]
  ds_read_b64_tr_b16 v[196:197], v227 offset:28672
  ds_read_b64_tr_b16 v[198:199], v227 offset:29184
  s_add_u32 m0, s66, 0
  s_add_u32 s62, s64, 0
  buffer_load_dwordx4 v245, s[28:31], s62 offen lds
  v_mul_f32 v210, 0xbfb8aa3b, v10
  s_waitcnt lgkmcnt(7)
  v_mfma_f32_32x32x16_bf16 v[64:79], v[200:203], a[56:59], v[64:79]
  v_mul_f32 v211, 0xbfb8aa3b, v11
  v_exp_f32 v208, v208
  v_exp_f32 v209, v209
  v_mfma_f32_32x32x16_bf16 v[80:95], v[200:203], a[60:63], v[80:95]
  ds_read_b64_tr_b16 v[200:201], v226 offset:30720
  ds_read_b64_tr_b16 v[202:203], v226 offset:31232
  v_exp_f32 v210, v210
  v_exp_f32 v211, v211
  s_waitcnt lgkmcnt(7)
  v_mfma_f32_32x32x16_bf16 v[96:111], v[204:207], a[56:59], v[96:111]
  v_add_f32 v208, 1.0, v208
  v_add_f32 v209, 1.0, v209
  v_add_f32 v210, 1.0, v210
  v_add_f32 v211, 1.0, v211
  v_mfma_f32_32x32x16_bf16 v[112:127], v[204:207], a[60:63], v[112:127]
  ds_read_b64_tr_b16 v[204:205], v227 offset:30720
  ds_read_b64_tr_b16 v[206:207], v227 offset:31232
  s_add_u32 m0, s66, 1024
  s_add_u32 s62, s64, 128
  buffer_load_dwordx4 v245, s[28:31], s62 offen lds
  v_rcp_f32 v208, v208
  s_waitcnt lgkmcnt(7)
  v_mfma_f32_32x32x16_bf16 v[64:79], v[192:195], a[64:67], v[64:79]
  v_rcp_f32 v209, v209
  v_rcp_f32 v210, v210
  v_mfma_f32_32x32x16_bf16 v[80:95], v[192:195], a[68:71], v[80:95]
  ds_read_b64_tr_b16 v[192:193], v226 offset:32768
  ds_read_b64_tr_b16 v[194:195], v226 offset:33280
  v_rcp_f32 v211, v211
  v_mul_f32 v208, v8, v208
  v_mul_f32 v209, v9, v209
  s_waitcnt lgkmcnt(6)
  v_mfma_f32_32x32x16_bf16 v[96:111], v[196:199], a[64:67], v[96:111]
  v_mul_f32 v210, v10, v210
  v_mul_f32 v211, v11, v211
  v_cvt_pk_bf16_f32 v132, v208, v209
  v_cvt_pk_bf16_f32 v133, v210, v211
  v_mul_f32 v212, 0xbfb8aa3b, v12
  v_mul_f32 v213, 0xbfb8aa3b, v13
  v_mfma_f32_32x32x16_bf16 v[112:127], v[196:199], a[68:71], v[112:127]
  ds_read_b64_tr_b16 v[196:197], v227 offset:32768
  ds_read_b64_tr_b16 v[198:199], v227 offset:33280
  s_add_u32 m0, s66, 2048
  s_add_u32 s62, s64, 256
  buffer_load_dwordx4 v245, s[28:31], s62 offen lds
  v_mul_f32 v214, 0xbfb8aa3b, v14
  s_waitcnt lgkmcnt(6)
  v_mfma_f32_32x32x16_bf16 v[64:79], v[200:203], a[72:75], v[64:79]
  v_mul_f32 v215, 0xbfb8aa3b, v15
  v_exp_f32 v212, v212
  v_exp_f32 v213, v213
  v_mfma_f32_32x32x16_bf16 v[80:95], v[200:203], a[76:79], v[80:95]
  ds_read_b64_tr_b16 v[200:201], v226 offset:34816
  ds_read_b64_tr_b16 v[202:203], v226 offset:35328
  v_exp_f32 v214, v214
  s_waitcnt lgkmcnt(6)
  v_mfma_f32_32x32x16_bf16 v[96:111], v[204:207], a[72:75], v[96:111]
  v_exp_f32 v215, v215
  v_add_f32 v212, 1.0, v212
  v_add_f32 v213, 1.0, v213
  v_add_f32 v214, 1.0, v214
  v_add_f32 v215, 1.0, v215
  v_mfma_f32_32x32x16_bf16 v[112:127], v[204:207], a[76:79], v[112:127]
  ds_read_b64_tr_b16 v[204:205], v227 offset:34816
  ds_read_b64_tr_b16 v[206:207], v227 offset:35328
  s_add_u32 m0, s66, 3072
  s_add_u32 s62, s64, 384
  buffer_load_dwordx4 v245, s[28:31], s62 offen lds
  s_waitcnt lgkmcnt(6)
  v_mfma_f32_32x32x16_bf16 v[64:79], v[192:195], a[80:83], v[64:79]
  v_rcp_f32 v212, v212
  v_rcp_f32 v213, v213
  v_rcp_f32 v214, v214
  v_mfma_f32_32x32x16_bf16 v[80:95], v[192:195], a[84:87], v[80:95]
  s_waitcnt vmcnt(16)
  s_barrier
  ds_read_b64_tr_b16 v[192:193], v226 offset:36864
  ds_read_b64_tr_b16 v[194:195], v226 offset:37376
  s_add_u32 m0, s59, 12288
  s_add_u32 s62, s58, 221184
  s_mov_b64 exec, s[96:97]
  buffer_load_dwordx4 v229, s[16:19], s62 offen lds
  s_mov_b64 exec, -1
  s_waitcnt lgkmcnt(6)
  v_mfma_f32_32x32x16_bf16 v[96:111], v[196:199], a[80:83], v[96:111]
  s_add_u32 m0, s59, 16384
  s_add_u32 s62, s58, 222336
  s_mov_b64 exec, s[96:97]
  buffer_load_dwordx4 v229, s[16:19], s62 offen lds
  s_mov_b64 exec, -1
  v_mfma_f32_32x32x16_bf16 v[112:127], v[196:199], a[84:87], v[112:127]
  ds_read_b64_tr_b16 v[196:197], v227 offset:36864
  ds_read_b64_tr_b16 v[198:199], v227 offset:37376
  s_add_u32 m0, s59, 20480
  s_add_u32 s62, s58, 223488
  s_mov_b64 exec, s[96:97]
  buffer_load_dwordx4 v229, s[16:19], s62 offen lds
  s_mov_b64 exec, -1
  s_waitcnt lgkmcnt(6)
  v_mfma_f32_32x32x16_bf16 v[64:79], v[200:203], a[88:91], v[64:79]
  ds_write_b16 v235, v237 offset:12288
  v_rcp_f32 v215, v215
  v_mul_f32 v212, v12, v212
  v_mul_f32 v213, v13, v213
  v_mul_f32 v214, v14, v214
  v_mul_f32 v215, v15, v215
  v_mfma_f32_32x32x16_bf16 v[80:95], v[200:203], a[92:95], v[80:95]
  ds_read_b64_tr_b16 v[200:201], v226 offset:38912
  ds_read_b64_tr_b16 v[202:203], v226 offset:39424
  v_cvt_pk_bf16_f32 v134, v212, v213
  v_cvt_pk_bf16_f32 v135, v214, v215
  v_mul_f32 v208, 0xbfb8aa3b, v16
  s_waitcnt lgkmcnt(7)
  v_mfma_f32_32x32x16_bf16 v[96:111], v[204:207], a[88:91], v[96:111]
  v_mul_f32 v209, 0xbfb8aa3b, v17
  v_mul_f32 v210, 0xbfb8aa3b, v18
  v_mul_f32 v211, 0xbfb8aa3b, v19
  v_exp_f32 v208, v208
  v_mfma_f32_32x32x16_bf16 v[112:127], v[204:207], a[92:95], v[112:127]
  ds_read_b64_tr_b16 v[204:205], v227 offset:38912
  ds_read_b64_tr_b16 v[206:207], v227 offset:39424
  s_add_u32 m0, s66, 4096
  s_add_u32 s62, s64, 512
  buffer_load_dwordx4 v245, s[28:31], s62 offen lds
  s_waitcnt lgkmcnt(7)
  v_mfma_f32_32x32x16_bf16 v[64:79], v[192:195], a[96:99], v[64:79]
  v_exp_f32 v209, v209
  v_exp_f32 v210, v210
  v_exp_f32 v211, v211
  v_mfma_f32_32x32x16_bf16 v[80:95], v[192:195], a[100:103], v[80:95]
  ds_read_b64_tr_b16 v[192:193], v226 offset:40960
  ds_read_b64_tr_b16 v[194:195], v226 offset:41472
  v_add_f32 v208, 1.0, v208
  v_add_f32 v209, 1.0, v209
  v_add_f32 v210, 1.0, v210
  v_add_f32 v211, 1.0, v211
  s_waitcnt lgkmcnt(7)
  v_mfma_f32_32x32x16_bf16 v[96:111], v[196:199], a[96:99], v[96:111]
  v_rcp_f32 v208, v208
  v_rcp_f32 v209, v209
  v_mfma_f32_32x32x16_bf16 v[112:127], v[196:199], a[100:103], v[112:127]
  ds_read_b64_tr_b16 v[196:197], v227 offset:40960
  ds_read_b64_tr_b16 v[198:199], v227 offset:41472
  s_add_u32 m0, s66, 5120
  s_add_u32 s62, s64, 640
  buffer_load_dwordx4 v245, s[28:31], s62 offen lds
  v_rcp_f32 v210, v210
  s_waitcnt lgkmcnt(6)
  v_mfma_f32_32x32x16_bf16 v[64:79], v[200:203], a[104:107], v[64:79]
  v_rcp_f32 v211, v211
  v_mul_f32 v208, v16, v208
  v_mul_f32 v209, v17, v209
  v_mul_f32 v210, v18, v210
  v_mfma_f32_32x32x16_bf16 v[80:95], v[200:203], a[108:111], v[80:95]
  ds_read_b64_tr_b16 v[200:201], v226 offset:43008
  ds_read_b64_tr_b16 v[202:203], v226 offset:43520
  v_mul_f32 v211, v19, v211
  v_cvt_pk_bf16_f32 v136, v208, v209
  v_cvt_pk_bf16_f32 v137, v210, v211
  s_waitcnt lgkmcnt(6)
  v_mfma_f32_32x32x16_bf16 v[96:111], v[204:207], a[104:107], v[96:111]
  v_mul_f32 v212, 0xbfb8aa3b, v20
  v_mul_f32 v213, 0xbfb8aa3b, v21
  v_mul_f32 v214, 0xbfb8aa3b, v22
  v_mul_f32 v215, 0xbfb8aa3b, v23
  v_exp_f32 v212, v212
  v_mfma_f32_32x32x16_bf16 v[112:127], v[204:207], a[108:111], v[112:127]
  ds_read_b64_tr_b16 v[204:205], v227 offset:43008
  ds_read_b64_tr_b16 v[206:207], v227 offset:43520
  s_add_u32 m0, s66, 6144
  s_add_u32 s62, s64, 768
  buffer_load_dwordx4 v245, s[28:31], s62 offen lds
  s_waitcnt lgkmcnt(6)
  v_mfma_f32_32x32x16_bf16 v[64:79], v[192:195], a[112:115], v[64:79]
  v_exp_f32 v213, v213
  v_exp_f32 v214, v214
  v_exp_f32 v215, v215
  v_mfma_f32_32x32x16_bf16 v[80:95], v[192:195], a[116:119], v[80:95]
  ds_read_b64_tr_b16 v[192:193], v226 offset:45056
  ds_read_b64_tr_b16 v[194:195], v226 offset:45568
  v_add_f32 v212, 1.0, v212
  v_add_f32 v213, 1.0, v213
  v_add_f32 v214, 1.0, v214
  s_waitcnt lgkmcnt(6)
  v_mfma_f32_32x32x16_bf16 v[96:111], v[196:199], a[112:115], v[96:111]
  v_add_f32 v215, 1.0, v215
  v_rcp_f32 v212, v212
  v_rcp_f32 v213, v213
  v_mfma_f32_32x32x16_bf16 v[112:127], v[196:199], a[116:119], v[112:127]
  ds_read_b64_tr_b16 v[196:197], v227 offset:45056
  ds_read_b64_tr_b16 v[198:199], v227 offset:45568
  s_add_u32 m0, s66, 7168
  s_add_u32 s62, s64, 896
  buffer_load_dwordx4 v245, s[28:31], s62 offen lds
  s_waitcnt lgkmcnt(6)
  v_mfma_f32_32x32x16_bf16 v[64:79], v[200:203], a[120:123], v[64:79]
  v_rcp_f32 v214, v214
  v_rcp_f32 v215, v215
  v_mul_f32 v212, v20, v212
  v_mul_f32 v213, v21, v213
  v_mfma_f32_32x32x16_bf16 v[80:95], v[200:203], a[124:127], v[80:95]
  ds_read_b64_tr_b16 v[200:201], v226 offset:47104
  ds_read_b64_tr_b16 v[202:203], v226 offset:47616
  v_mul_f32 v214, v22, v214
  v_mul_f32 v215, v23, v215
  v_cvt_pk_bf16_f32 v138, v212, v213
  v_cvt_pk_bf16_f32 v139, v214, v215
  s_waitcnt lgkmcnt(6)
  v_mfma_f32_32x32x16_bf16 v[96:111], v[204:207], a[120:123], v[96:111]
  v_mul_f32 v208, 0xbfb8aa3b, v24
  v_mul_f32 v209, 0xbfb8aa3b, v25
  v_mul_f32 v210, 0xbfb8aa3b, v26
  v_mul_f32 v211, 0xbfb8aa3b, v27
  v_mfma_f32_32x32x16_bf16 v[112:127], v[204:207], a[124:127], v[112:127]
  ds_read_b64_tr_b16 v[204:205], v227 offset:47104
  ds_read_b64_tr_b16 v[206:207], v227 offset:47616
  s_add_u32 m0, s66, 8192
  s_add_u32 s62, s64, 1024
  buffer_load_dwordx4 v245, s[28:31], s62 offen lds
  v_exp_f32 v208, v208
  s_waitcnt lgkmcnt(6)
  v_mfma_f32_32x32x16_bf16 v[64:79], v[192:195], a[128:131], v[64:79]
  v_exp_f32 v209, v209
  v_exp_f32 v210, v210
  v_mfma_f32_32x32x16_bf16 v[80:95], v[192:195], a[132:135], v[80:95]
  s_waitcnt vmcnt(21)
  s_barrier
  ds_read_b64_tr_b16 v[192:193], v226 offset:49152
  ds_read_b64_tr_b16 v[194:195], v226 offset:49664
  s_add_u32 m0, s59, 24576
  s_add_u32 s62, s58, 442368
  s_mov_b64 exec, s[96:97]
  buffer_load_dwordx4 v229, s[16:19], s62 offen lds
  s_mov_b64 exec, -1
  s_waitcnt lgkmcnt(6)
  v_mfma_f32_32x32x16_bf16 v[96:111], v[196:199], a[128:131], v[96:111]
  s_add_u32 m0, s59, 28672
  s_add_u32 s62, s58, 443520
  s_mov_b64 exec, s[96:97]
  buffer_load_dwordx4 v229, s[16:19], s62 offen lds
  s_mov_b64 exec, -1
  v_exp_f32 v211, v211
  v_mfma_f32_32x32x16_bf16 v[112:127], v[196:199], a[132:135], v[112:127]
  ds_read_b64_tr_b16 v[196:197], v227 offset:49152
  ds_read_b64_tr_b16 v[198:199], v227 offset:49664
  s_add_u32 m0, s59, 32768
  s_add_u32 s62, s58, 444672
  s_mov_b64 exec, s[96:97]
  buffer_load_dwordx4 v229, s[16:19], s62 offen lds
  s_mov_b64 exec, -1
  s_waitcnt lgkmcnt(6)
  v_mfma_f32_32x32x16_bf16 v[64:79], v[200:203], a[136:139], v[64:79]
  ds_write_b16 v235, v238 offset:24576
  v_add_f32 v208, 1.0, v208
  v_add_f32 v209, 1.0, v209
  v_add_f32 v210, 1.0, v210
  v_add_f32 v211, 1.0, v211
  v_mfma_f32_32x32x16_bf16 v[80:95], v[200:203], a[140:143], v[80:95]
  ds_read_b64_tr_b16 v[200:201], v226 offset:51200
  ds_read_b64_tr_b16 v[202:203], v226 offset:51712
  v_rcp_f32 v208, v208
  v_rcp_f32 v209, v209
  s_waitcnt lgkmcnt(7)
  v_mfma_f32_32x32x16_bf16 v[96:111], v[204:207], a[136:139], v[96:111]
  v_rcp_f32 v210, v210
  v_rcp_f32 v211, v211
  v_mul_f32 v208, v24, v208
  v_mfma_f32_32x32x16_bf16 v[112:127], v[204:207], a[140:143], v[112:127]
  ds_read_b64_tr_b16 v[204:205], v227 offset:51200
  ds_read_b64_tr_b16 v[206:207], v227 offset:51712
  v_mul_f32 v209, v25, v209
  v_mul_f32 v210, v26, v210
  v_mul_f32 v211, v27, v211
  s_waitcnt lgkmcnt(7)
  v_mfma_f32_32x32x16_bf16 v[64:79], v[192:195], a[144:147], v[64:79]
  v_cvt_pk_bf16_f32 v140, v208, v209
  v_cvt_pk_bf16_f32 v141, v210, v211
  v_mul_f32 v212, 0xbfb8aa3b, v28
  v_mul_f32 v213, 0xbfb8aa3b, v29
  v_mul_f32 v214, 0xbfb8aa3b, v30
  v_mul_f32 v215, 0xbfb8aa3b, v31
  v_mfma_f32_32x32x16_bf16 v[80:95], v[192:195], a[148:151], v[80:95]
  ds_read_b64_tr_b16 v[192:193], v226 offset:53248
  ds_read_b64_tr_b16 v[194:195], v226 offset:53760
  v_exp_f32 v212, v212
  s_waitcnt lgkmcnt(7)
  v_mfma_f32_32x32x16_bf16 v[96:111], v[196:199], a[144:147], v[96:111]
  v_exp_f32 v213, v213
  v_exp_f32 v214, v214
  v_exp_f32 v215, v215
  v_mfma_f32_32x32x16_bf16 v[112:127], v[196:199], a[148:151], v[112:127]
  ds_read_b64_tr_b16 v[196:197], v227 offset:53248
  ds_read_b64_tr_b16 v[198:199], v227 offset:53760
  v_add_f32 v212, 1.0, v212
  v_add_f32 v213, 1.0, v213
  v_add_f32 v214, 1.0, v214
  v_add_f32 v215, 1.0, v215
  s_waitcnt lgkmcnt(6)
  v_mfma_f32_32x32x16_bf16 v[64:79], v[200:203], a[152:155], v[64:79]
  v_rcp_f32 v212, v212
  v_rcp_f32 v213, v213
  v_mfma_f32_32x32x16_bf16 v[80:95], v[200:203], a[156:159], v[80:95]
  ds_read_b64_tr_b16 v[200:201], v226 offset:55296
  ds_read_b64_tr_b16 v[202:203], v226 offset:55808
  v_rcp_f32 v214, v214
  v_rcp_f32 v215, v215
  s_waitcnt lgkmcnt(6)
  v_mfma_f32_32x32x16_bf16 v[96:111], v[204:207], a[152:155], v[96:111]
  v_mul_f32 v212, v28, v212
  v_mul_f32 v213, v29, v213
  v_mul_f32 v214, v30, v214
  v_mul_f32 v215, v31, v215
  v_cvt_pk_bf16_f32 v142, v212, v213
  v_cvt_pk_bf16_f32 v143, v214, v215
  v_mfma_f32_32x32x16_bf16 v[112:127], v[204:207], a[156:159], v[112:127]
  ds_read_b64_tr_b16 v[204:205], v227 offset:55296
  ds_read_b64_tr_b16 v[206:207], v227 offset:55808
  v_mul_f32 v208, 0xbfb8aa3b, v32
  v_mul_f32 v209, 0xbfb8aa3b, v33
  v_mul_f32 v210, 0xbfb8aa3b, v34
  s_waitcnt lgkmcnt(6)
  v_mfma_f32_32x32x16_bf16 v[64:79], v[192:195], a[160:163], v[64:79]
  v_mul_f32 v211, 0xbfb8aa3b, v35
  v_exp_f32 v208, v208
  v_exp_f32 v209, v209
  v_mfma_f32_32x32x16_bf16 v[80:95], v[192:195], a[164:167], v[80:95]
  ds_read_b64_tr_b16 v[192:193], v226 offset:57344
  ds_read_b64_tr_b16 v[194:195], v226 offset:57856
  v_exp_f32 v210, v210
  v_exp_f32 v211, v211
  s_waitcnt lgkmcnt(6)
  v_mfma_f32_32x32x16_bf16 v[96:111], v[196:199], a[160:163], v[96:111]
  v_add_f32 v208, 1.0, v208
  v_add_f32 v209, 1.0, v209
  v_add_f32 v210, 1.0, v210
  v_add_f32 v211, 1.0, v211
  v_mfma_f32_32x32x16_bf16 v[112:127], v[196:199], a[164:167], v[112:127]
  ds_read_b64_tr_b16 v[196:197], v227 offset:57344
  ds_read_b64_tr_b16 v[198:199], v227 offset:57856
  v_rcp_f32 v208, v208
  v_rcp_f32 v209, v209
  s_waitcnt lgkmcnt(6)
  v_mfma_f32_32x32x16_bf16 v[64:79], v[200:203], a[168:171], v[64:79]
  v_rcp_f32 v210, v210
  v_rcp_f32 v211, v211
  v_mul_f32 v208, v32, v208
  v_mul_f32 v209, v33, v209
  v_mfma_f32_32x32x16_bf16 v[80:95], v[200:203], a[172:175], v[80:95]
  ds_read_b64_tr_b16 v[200:201], v226 offset:59392
  ds_read_b64_tr_b16 v[202:203], v226 offset:59904
  v_mul_f32 v210, v34, v210
  v_mul_f32 v211, v35, v211
  v_cvt_pk_bf16_f32 v144, v208, v209
  s_waitcnt lgkmcnt(6)
  v_mfma_f32_32x32x16_bf16 v[96:111], v[204:207], a[168:171], v[96:111]
  v_cvt_pk_bf16_f32 v145, v210, v211
  v_mul_f32 v212, 0xbfb8aa3b, v36
  v_mul_f32 v213, 0xbfb8aa3b, v37
  v_mul_f32 v214, 0xbfb8aa3b, v38
  v_mul_f32 v215, 0xbfb8aa3b, v39
  v_mfma_f32_32x32x16_bf16 v[112:127], v[204:207], a[172:175], v[112:127]
  ds_read_b64_tr_b16 v[204:205], v227 offset:59392
  ds_read_b64_tr_b16 v[206:207], v227 offset:59904
  v_exp_f32 v212, v212
  v_exp_f32 v213, v213
  s_waitcnt lgkmcnt(6)
  v_mfma_f32_32x32x16_bf16 v[64:79], v[192:195], a[176:179], v[64:79]
  v_exp_f32 v214, v214
  v_exp_f32 v215, v215
  v_add_f32 v212, 1.0, v212
  v_mfma_f32_32x32x16_bf16 v[80:95], v[192:195], a[180:183], v[80:95]
  s_waitcnt vmcnt(21)
  s_barrier
  ds_read_b64_tr_b16 v[192:193], v226 offset:0
  ds_read_b64_tr_b16 v[194:195], v226 offset:512
  s_add_u32 m0, s59, 36864
  s_add_u32 s62, s58, 663552
  s_mov_b64 exec, s[96:97]
  buffer_load_dwordx4 v229, s[16:19], s62 offen lds
  s_mov_b64 exec, -1
  s_waitcnt lgkmcnt(6)
  v_mfma_f32_32x32x16_bf16 v[96:111], v[196:199], a[176:179], v[96:111]
  s_add_u32 m0, s59, 40960
  s_add_u32 s62, s58, 664704
  s_mov_b64 exec, s[96:97]
  buffer_load_dwordx4 v229, s[16:19], s62 offen lds
  s_mov_b64 exec, -1
  v_add_f32 v213, 1.0, v213
  v_mfma_f32_32x32x16_bf16 v[112:127], v[196:199], a[180:183], v[112:127]
  ds_read_b64_tr_b16 v[196:197], v227 offset:0
  ds_read_b64_tr_b16 v[198:199], v227 offset:512
  s_add_u32 m0, s59, 45056
  s_add_u32 s62, s58, 665856
  s_mov_b64 exec, s[96:97]
  buffer_load_dwordx4 v229, s[16:19], s62 offen lds
  s_mov_b64 exec, -1
  s_waitcnt lgkmcnt(6)
  v_mfma_f32_32x32x16_bf16 v[64:79], v[200:203], a[184:187], v[64:79]
  ds_write_b16 v235, v239 offset:36864
  v_add_f32 v214, 1.0, v214
  v_add_f32 v215, 1.0, v215
  v_rcp_f32 v212, v212
  v_mfma_f32_32x32x16_bf16 v[80:95], v[200:203], a[188:191], v[80:95]
  ds_read_b64_tr_b16 v[200:201], v226 offset:2048
  ds_read_b64_tr_b16 v[202:203], v226 offset:2560
  v_rcp_f32 v213, v213
  s_waitcnt lgkmcnt(7)
  v_mfma_f32_32x32x16_bf16 v[96:111], v[204:207], a[184:187], v[96:111]
  v_rcp_f32 v214, v214
  v_rcp_f32 v215, v215
  v_mul_f32 v212, v36, v212
  v_mul_f32 v213, v37, v213
  v_mul_f32 v214, v38, v214
  v_mfma_f32_32x32x16_bf16 v[112:127], v[204:207], a[188:191], v[112:127]
  ds_read_b64_tr_b16 v[204:205], v227 offset:2048
  ds_read_b64_tr_b16 v[206:207], v227 offset:2560
  v_mul_f32 v215, v39, v215
  v_cvt_pk_bf16_f32 v146, v212, v213
  v_cvt_pk_bf16_f32 v147, v214, v215
  s_waitcnt lgkmcnt(7)
  v_mfma_f32_32x32x16_bf16 v[64:79], v[192:195], a[192:195], v[64:79]
  v_mul_f32 v208, 0xbfb8aa3b, v40
  v_mul_f32 v209, 0xbfb8aa3b, v41
  v_mul_f32 v210, 0xbfb8aa3b, v42
  v_mul_f32 v211, 0xbfb8aa3b, v43
  v_mfma_f32_32x32x16_bf16 v[80:95], v[192:195], a[196:199], v[80:95]
  ds_read_b64_tr_b16 v[192:193], v226 offset:4096
  ds_read_b64_tr_b16 v[194:195], v226 offset:4608
  v_exp_f32 v208, v208
  v_exp_f32 v209, v209
  s_waitcnt lgkmcnt(7)
  v_mfma_f32_32x32x16_bf16 v[96:111], v[196:199], a[192:195], v[96:111]
  v_exp_f32 v210, v210
  v_exp_f32 v211, v211
  v_add_f32 v208, 1.0, v208
  v_add_f32 v209, 1.0, v209
  v_mfma_f32_32x32x16_bf16 v[112:127], v[196:199], a[196:199], v[112:127]
  ds_read_b64_tr_b16 v[196:197], v227 offset:4096
  ds_read_b64_tr_b16 v[198:199], v227 offset:4608
  v_add_f32 v210, 1.0, v210
  v_add_f32 v211, 1.0, v211
  s_waitcnt lgkmcnt(6)
  v_mfma_f32_32x32x16_bf16 v[64:79], v[200:203], a[200:203], v[64:79]
  v_rcp_f32 v208, v208
  v_rcp_f32 v209, v209
  v_rcp_f32 v210, v210
  v_mfma_f32_32x32x16_bf16 v[80:95], v[200:203], a[204:207], v[80:95]
  ds_read_b64_tr_b16 v[200:201], v226 offset:6144
  ds_read_b64_tr_b16 v[202:203], v226 offset:6656
  v_rcp_f32 v211, v211
  v_mul_f32 v208, v40, v208
  v_mul_f32 v209, v41, v209
  s_waitcnt lgkmcnt(6)
  v_mfma_f32_32x32x16_bf16 v[96:111], v[204:207], a[200:203], v[96:111]
  v_mul_f32 v210, v42, v210
  v_mul_f32 v211, v43, v211
  v_cvt_pk_bf16_f32 v148, v208, v209
  v_cvt_pk_bf16_f32 v149, v210, v211
  v_mul_f32 v212, 0xbfb8aa3b, v44
  v_mfma_f32_32x32x16_bf16 v[112:127], v[204:207], a[204:207], v[112:127]
  ds_read_b64_tr_b16 v[204:205], v227 offset:6144
  ds_read_b64_tr_b16 v[206:207], v227 offset:6656
  v_mul_f32 v213, 0xbfb8aa3b, v45
  v_mul_f32 v214, 0xbfb8aa3b, v46
  v_mul_f32 v215, 0xbfb8aa3b, v47
  s_waitcnt lgkmcnt(6)
  v_mfma_f32_32x32x16_bf16 v[64:79], v[192:195], a[208:211], v[64:79]
  v_exp_f32 v212, v212
  v_exp_f32 v213, v213
  v_exp_f32 v214, v214
  v_mfma_f32_32x32x16_bf16 v[80:95], v[192:195], a[212:215], v[80:95]
  ds_read_b64_tr_b16 v[192:193], v226 offset:8192
  ds_read_b64_tr_b16 v[194:195], v226 offset:8704
  v_exp_f32 v215, v215
  v_add_f32 v212, 1.0, v212
  s_waitcnt lgkmcnt(6)
  v_mfma_f32_32x32x16_bf16 v[96:111], v[196:199], a[208:211], v[96:111]
  v_add_f32 v213, 1.0, v213
  v_add_f32 v214, 1.0, v214
  v_add_f32 v215, 1.0, v215
  v_rcp_f32 v212, v212
  v_mfma_f32_32x32x16_bf16 v[112:127], v[196:199], a[212:215], v[112:127]
  ds_read_b64_tr_b16 v[196:197], v227 offset:8192
  ds_read_b64_tr_b16 v[198:199], v227 offset:8704
  v_rcp_f32 v213, v213
  v_rcp_f32 v214, v214
  s_waitcnt lgkmcnt(6)
  v_mfma_f32_32x32x16_bf16 v[64:79], v[200:203], a[216:219], v[64:79]
  v_rcp_f32 v215, v215
  v_mul_f32 v212, v44, v212
  v_mul_f32 v213, v45, v213
  v_mul_f32 v214, v46, v214
  v_mfma_f32_32x32x16_bf16 v[80:95], v[200:203], a[220:223], v[80:95]
  ds_read_b64_tr_b16 v[200:201], v226 offset:10240
  ds_read_b64_tr_b16 v[202:203], v226 offset:10752
  v_mul_f32 v215, v47, v215
  v_cvt_pk_bf16_f32 v150, v212, v213
  v_cvt_pk_bf16_f32 v151, v214, v215
  v_mul_f32 v208, 0xbfb8aa3b, v48
  s_waitcnt lgkmcnt(6)
  v_mfma_f32_32x32x16_bf16 v[96:111], v[204:207], a[216:219], v[96:111]
  v_mul_f32 v209, 0xbfb8aa3b, v49
  v_mul_f32 v210, 0xbfb8aa3b, v50
  v_mul_f32 v211, 0xbfb8aa3b, v51
  v_exp_f32 v208, v208
  v_mfma_f32_32x32x16_bf16 v[112:127], v[204:207], a[220:223], v[112:127]
  ds_read_b64_tr_b16 v[204:205], v227 offset:10240
  ds_read_b64_tr_b16 v[206:207], v227 offset:10752
  v_exp_f32 v209, v209
  s_waitcnt lgkmcnt(6)
  v_mfma_f32_32x32x16_bf16 v[64:79], v[192:195], a[224:227], v[64:79]
  v_exp_f32 v210, v210
  v_exp_f32 v211, v211
  v_add_f32 v208, 1.0, v208
  v_add_f32 v209, 1.0, v209
  v_mfma_f32_32x32x16_bf16 v[80:95], v[192:195], a[228:231], v[80:95]
  s_waitcnt vmcnt(21)
  s_barrier
  ds_read_b64_tr_b16 v[192:193], v253 offset:0
  ds_read_b64_tr_b16 v[194:195], v253 offset:512
  s_add_u32 m0, s59, 49152
  s_add_u32 s62, s58, 884736
  s_mov_b64 exec, s[96:97]
  buffer_load_dwordx4 v229, s[16:19], s62 offen lds
  s_mov_b64 exec, -1
  s_waitcnt lgkmcnt(6)
  v_mfma_f32_32x32x16_bf16 v[96:111], v[196:199], a[224:227], v[96:111]
  s_add_u32 m0, s59, 53248
  s_add_u32 s62, s58, 885888
  s_mov_b64 exec, s[96:97]
  buffer_load_dwordx4 v229, s[16:19], s62 offen lds
  s_mov_b64 exec, -1
  v_add_f32 v210, 1.0, v210
  v_mfma_f32_32x32x16_bf16 v[112:127], v[196:199], a[228:231], v[112:127]
  ds_read_b64_tr_b16 v[196:197], v254 offset:0
  ds_read_b64_tr_b16 v[198:199], v254 offset:512
  s_add_u32 m0, s59, 57344
  s_add_u32 s62, s58, 887040
  s_mov_b64 exec, s[96:97]
  buffer_load_dwordx4 v229, s[16:19], s62 offen lds
  s_mov_b64 exec, -1
  s_waitcnt lgkmcnt(6)
  v_mfma_f32_32x32x16_bf16 v[64:79], v[200:203], a[232:235], v[64:79]
  ds_write_b16 v235, v240 offset:49152
  v_add_f32 v211, 1.0, v211
  v_rcp_f32 v208, v208
  v_rcp_f32 v209, v209
  v_mfma_f32_32x32x16_bf16 v[80:95], v[200:203], a[236:239], v[80:95]
  ds_read_b64_tr_b16 v[200:201], v253 offset:2048
  ds_read_b64_tr_b16 v[202:203], v253 offset:2560
  s_cmp_eq_u32 s3, 0
  s_cselect_b32 s62, s0, 0x1000
  s_mov_b64 exec, 1
  buffer_atomic_add v251, off, s[40:43], s62 sc1
  s_mov_b64 exec, -1
  s_waitcnt lgkmcnt(7)
  v_mfma_f32_32x32x16_bf16 v[96:111], v[204:207], a[232:235], v[96:111]
  v_rcp_f32 v210, v210
  v_rcp_f32 v211, v211
  v_mul_f32 v208, v48, v208
  v_mfma_f32_32x32x16_bf16 v[112:127], v[204:207], a[236:239], v[112:127]
  ds_read_b64_tr_b16 v[204:205], v254 offset:2048
  ds_read_b64_tr_b16 v[206:207], v254 offset:2560
  v_mul_f32 v209, v49, v209
  v_mul_f32 v210, v50, v210
  v_mul_f32 v211, v51, v211
  s_waitcnt lgkmcnt(7)
  v_mfma_f32_32x32x16_bf16 v[64:79], v[192:195], a[240:243], v[64:79]
  v_cvt_pk_bf16_f32 v152, v208, v209
  v_cvt_pk_bf16_f32 v153, v210, v211
  v_mul_f32 v212, 0xbfb8aa3b, v52
  v_mul_f32 v213, 0xbfb8aa3b, v53
  v_mul_f32 v214, 0xbfb8aa3b, v54
  v_mul_f32 v215, 0xbfb8aa3b, v55
  v_mfma_f32_32x32x16_bf16 v[80:95], v[192:195], a[244:247], v[80:95]
  ds_read_b64_tr_b16 v[192:193], v253 offset:4096
  ds_read_b64_tr_b16 v[194:195], v253 offset:4608
  v_exp_f32 v212, v212
  s_waitcnt lgkmcnt(7)
  v_mfma_f32_32x32x16_bf16 v[96:111], v[196:199], a[240:243], v[96:111]
  v_exp_f32 v213, v213
  v_exp_f32 v214, v214
  v_exp_f32 v215, v215
  v_mfma_f32_32x32x16_bf16 v[112:127], v[196:199], a[244:247], v[112:127]
  ds_read_b64_tr_b16 v[196:197], v254 offset:4096
  ds_read_b64_tr_b16 v[198:199], v254 offset:4608
  v_add_f32 v212, 1.0, v212
  v_add_f32 v213, 1.0, v213
  v_add_f32 v214, 1.0, v214
  v_add_f32 v215, 1.0, v215
  s_waitcnt lgkmcnt(6)
  v_mfma_f32_32x32x16_bf16 v[64:79], v[200:203], a[248:251], v[64:79]
  v_rcp_f32 v212, v212
  v_rcp_f32 v213, v213
  v_mfma_f32_32x32x16_bf16 v[80:95], v[200:203], a[252:255], v[80:95]
  ds_read_b64_tr_b16 v[200:201], v253 offset:6144
  ds_read_b64_tr_b16 v[202:203], v253 offset:6656
  v_rcp_f32 v214, v214
  v_rcp_f32 v215, v215
  s_waitcnt lgkmcnt(6)
  v_mfma_f32_32x32x16_bf16 v[96:111], v[204:207], a[248:251], v[96:111]
  v_mul_f32 v212, v52, v212
  v_mul_f32 v213, v53, v213
  v_mul_f32 v214, v54, v214
  v_mul_f32 v215, v55, v215
  v_cvt_pk_bf16_f32 v154, v212, v213
  v_mfma_f32_32x32x16_bf16 v[112:127], v[204:207], a[252:255], v[112:127]
  ds_read_b64_tr_b16 v[204:205], v254 offset:6144
  ds_read_b64_tr_b16 v[206:207], v254 offset:6656
  v_cvt_pk_bf16_f32 v155, v214, v215
  v_mul_f32 v208, 0xbfb8aa3b, v56
  v_mul_f32 v209, 0xbfb8aa3b, v57
  v_mul_f32 v210, 0xbfb8aa3b, v58
  s_waitcnt lgkmcnt(6)
  v_mfma_f32_32x32x16_bf16 v[64:79], v[192:195], v[160:163], v[64:79]
  v_mul_f32 v211, 0xbfb8aa3b, v59
  v_exp_f32 v208, v208
  v_exp_f32 v209, v209
  v_mfma_f32_32x32x16_bf16 v[80:95], v[192:195], v[164:167], v[80:95]
  ds_read_b64_tr_b16 v[192:193], v253 offset:8192
  ds_read_b64_tr_b16 v[194:195], v253 offset:8704
  v_exp_f32 v210, v210
  v_exp_f32 v211, v211
  s_waitcnt lgkmcnt(6)
  v_mfma_f32_32x32x16_bf16 v[96:111], v[196:199], v[160:163], v[96:111]
  v_add_f32 v208, 1.0, v208
  v_add_f32 v209, 1.0, v209
  v_add_f32 v210, 1.0, v210
  v_add_f32 v211, 1.0, v211
  v_mfma_f32_32x32x16_bf16 v[112:127], v[196:199], v[164:167], v[112:127]
  ds_read_b64_tr_b16 v[196:197], v254 offset:8192
  ds_read_b64_tr_b16 v[198:199], v254 offset:8704
  v_rcp_f32 v208, v208
  v_rcp_f32 v209, v209
  s_waitcnt lgkmcnt(6)
  v_mfma_f32_32x32x16_bf16 v[64:79], v[200:203], v[168:171], v[64:79]
  v_rcp_f32 v210, v210
  v_rcp_f32 v211, v211
  v_mul_f32 v208, v56, v208
  v_mfma_f32_32x32x16_bf16 v[80:95], v[200:203], v[172:175], v[80:95]
  ds_read_b64_tr_b16 v[200:201], v253 offset:10240
  ds_read_b64_tr_b16 v[202:203], v253 offset:10752
  v_mul_f32 v209, v57, v209
  v_mul_f32 v210, v58, v210
  v_mul_f32 v211, v59, v211
  v_cvt_pk_bf16_f32 v156, v208, v209
  s_waitcnt lgkmcnt(6)
  v_mfma_f32_32x32x16_bf16 v[96:111], v[204:207], v[168:171], v[96:111]
  v_cvt_pk_bf16_f32 v157, v210, v211
  v_mul_f32 v212, 0xbfb8aa3b, v60
  v_mul_f32 v213, 0xbfb8aa3b, v61
  v_mul_f32 v214, 0xbfb8aa3b, v62
  v_mul_f32 v215, 0xbfb8aa3b, v63
  v_mfma_f32_32x32x16_bf16 v[112:127], v[204:207], v[172:175], v[112:127]
  ds_read_b64_tr_b16 v[204:205], v254 offset:10240
  ds_read_b64_tr_b16 v[206:207], v254 offset:10752
  v_exp_f32 v212, v212
  v_exp_f32 v213, v213
  s_waitcnt lgkmcnt(6)
  v_mfma_f32_32x32x16_bf16 v[64:79], v[192:195], v[176:179], v[64:79]
  v_exp_f32 v214, v214
  v_exp_f32 v215, v215
  v_add_f32 v212, 1.0, v212
  v_mfma_f32_32x32x16_bf16 v[80:95], v[192:195], v[180:183], v[80:95]
  s_waitcnt vmcnt(22)
  s_barrier
  v_add_u32 v253, 0x10000, v230
  v_add_u32 v254, 0x10000, v231
  ds_read_b64_tr_b16 v[192:193], v253 offset:12288
  ds_read_b64_tr_b16 v[194:195], v253 offset:12544
  s_add_u32 m0, s59, 0
  s_add_u32 s62, s58, 1105920
  s_mov_b64 exec, s[96:97]
  buffer_load_dwordx4 v229, s[16:19], s62 offen lds
  s_mov_b64 exec, -1
  s_waitcnt lgkmcnt(6)
  v_mfma_f32_32x32x16_bf16 v[96:111], v[196:199], v[176:179], v[96:111]
  s_add_u32 m0, s59, 4096
  s_add_u32 s62, s58, 1107072
  s_mov_b64 exec, s[96:97]
  buffer_load_dwordx4 v229, s[16:19], s62 offen lds
  s_mov_b64 exec, -1
  v_add_f32 v213, 1.0, v213
  v_mfma_f32_32x32x16_bf16 v[112:127], v[196:199], v[180:183], v[112:127]
  ds_read_b64_tr_b16 v[196:197], v254 offset:12288
  ds_read_b64_tr_b16 v[198:199], v254 offset:12544
  s_add_u32 m0, s59, 8192
  s_add_u32 s62, s58, 1108224
  s_mov_b64 exec, s[96:97]
  buffer_load_dwordx4 v229, s[16:19], s62 offen lds
  s_mov_b64 exec, -1
  s_waitcnt lgkmcnt(6)
  v_mfma_f32_32x32x16_bf16 v[64:79], v[200:203], v[184:187], v[64:79]
  ds_write_b16 v235, v241 offset:0
  v_add_f32 v214, 1.0, v214
  v_add_f32 v215, 1.0, v215
  v_rcp_f32 v212, v212
  v_mfma_f32_32x32x16_bf16 v[80:95], v[200:203], v[188:191], v[80:95]
  ds_read_b64_tr_b16 v[200:201], v253 offset:13312
  ds_read_b64_tr_b16 v[202:203], v253 offset:13568
  v_rcp_f32 v213, v213
  s_waitcnt lgkmcnt(7)
  v_mfma_f32_32x32x16_bf16 v[96:111], v[204:207], v[184:187], v[96:111]
  v_rcp_f32 v214, v214
  v_rcp_f32 v215, v215
  v_mul_f32 v212, v60, v212
  v_mul_f32 v213, v61, v213
  v_mul_f32 v214, v62, v214
  v_mfma_f32_32x32x16_bf16 v[112:127], v[204:207], v[188:191], v[112:127]
  ds_read_b64_tr_b16 v[204:205], v254 offset:13312
  ds_read_b64_tr_b16 v[206:207], v254 offset:13568
  v_mul_f32 v215, v63, v215
  v_cvt_pk_bf16_f32 v158, v212, v213
  v_cvt_pk_bf16_f32 v159, v214, v215
  s_waitcnt lgkmcnt(7)
  v_mfma_f32_32x32x16_bf16 v[0:15], a[0:3], v[192:195], 0
  v_mfma_f32_32x32x16_bf16 v[16:31], a[4:7], v[192:195], 0
  ds_read_b64_tr_b16 v[192:193], v253 offset:14336
  ds_read_b64_tr_b16 v[194:195], v253 offset:14592
  s_waitcnt lgkmcnt(7)
  v_mfma_f32_32x32x16_bf16 v[32:47], a[0:3], v[196:199], 0
  v_mfma_f32_32x32x16_bf16 v[48:63], a[4:7], v[196:199], 0
  ds_read_b64_tr_b16 v[196:197], v254 offset:14336
  ds_read_b64_tr_b16 v[198:199], v254 offset:14592
  s_waitcnt lgkmcnt(6)
  v_mfma_f32_32x32x16_bf16 v[0:15], a[8:11], v[200:203], v[0:15]
  v_mfma_f32_32x32x16_bf16 v[16:31], a[12:15], v[200:203], v[16:31]
  ds_read_b64_tr_b16 v[200:201], v253 offset:15360
  ds_read_b64_tr_b16 v[202:203], v253 offset:15616
  s_waitcnt lgkmcnt(6)
  v_mfma_f32_32x32x16_bf16 v[32:47], a[8:11], v[204:207], v[32:47]
  v_lshlrev_b32 v208, 16, v128
  v_and_b32 v209, 0xffff0000, v128
  v_mfma_f32_32x32x16_bf16 v[48:63], a[12:15], v[204:207], v[48:63]
  ds_read_b64_tr_b16 v[204:205], v254 offset:15360
  ds_read_b64_tr_b16 v[206:207], v254 offset:15616
  v_lshlrev_b32 v210, 16, v129
  s_waitcnt lgkmcnt(6)
  v_mfma_f32_32x32x16_bf16 v[0:15], a[16:19], v[192:195], v[0:15]
  v_and_b32 v211, 0xffff0000, v129
  v_mul_f32 v208, v208, v64
  v_mfma_f32_32x32x16_bf16 v[16:31], a[20:23], v[192:195], v[16:31]
  s_waitcnt vmcnt(18)
  s_barrier
  ds_read_b64_tr_b16 v[192:193], v230 offset:12288
  ds_read_b64_tr_b16 v[194:195], v230 offset:12544
  s_add_u32 m0, s59, 65536
  s_add_u32 s62, s58, 1327104
  s_mov_b64 exec, s[96:97]
  buffer_load_dwordx4 v229, s[16:19], s62 offen lds
  s_mov_b64 exec, -1
  s_waitcnt lgkmcnt(6)
  v_mfma_f32_32x32x16_bf16 v[32:47], a[16:19], v[196:199], v[32:47]
  s_add_u32 m0, s59, 69632
  s_add_u32 s62, s58, 1328256
  s_mov_b64 exec, s[96:97]
  buffer_load_dwordx4 v229, s[16:19], s62 offen lds
  s_mov_b64 exec, -1
  v_mfma_f32_32x32x16_bf16 v[48:63], a[20:23], v[196:199], v[48:63]
  ds_read_b64_tr_b16 v[196:197], v231 offset:12288
  ds_read_b64_tr_b16 v[198:199], v231 offset:12544
  s_add_u32 m0, s59, 73728
  s_add_u32 s62, s58, 1329408
  s_mov_b64 exec, s[96:97]
  buffer_load_dwordx4 v229, s[16:19], s62 offen lds
  s_mov_b64 exec, -1
  s_waitcnt lgkmcnt(6)
  v_mfma_f32_32x32x16_bf16 v[0:15], a[24:27], v[200:203], v[0:15]
  v_add_u32 v252, 0x10000, v235
  ds_write_b16 v252, v242 offset:0
  v_mul_f32 v209, v209, v65
  v_mfma_f32_32x32x16_bf16 v[16:31], a[28:31], v[200:203], v[16:31]
  ds_read_b64_tr_b16 v[200:201], v230 offset:13312
  ds_read_b64_tr_b16 v[202:203], v230 offset:13568
  v_mul_f32 v210, v210, v66
  v_mul_f32 v211, v211, v67
  s_waitcnt lgkmcnt(7)
  v_mfma_f32_32x32x16_bf16 v[32:47], a[24:27], v[204:207], v[32:47]
  v_cvt_pk_bf16_f32 v216, v208, v209
  v_mfma_f32_32x32x16_bf16 v[48:63], a[28:31], v[204:207], v[48:63]
  ds_read_b64_tr_b16 v[204:205], v231 offset:13312
  ds_read_b64_tr_b16 v[206:207], v231 offset:13568
  v_cvt_pk_bf16_f32 v217, v210, v211
  v_lshlrev_b32 v208, 16, v130
  s_waitcnt lgkmcnt(7)
  v_mfma_f32_32x32x16_bf16 v[0:15], a[32:35], v[192:195], v[0:15]
  v_and_b32 v209, 0xffff0000, v130
  v_mfma_f32_32x32x16_bf16 v[16:31], a[36:39], v[192:195], v[16:31]
  ds_read_b64_tr_b16 v[192:193], v230 offset:14336
  ds_read_b64_tr_b16 v[194:195], v230 offset:14592
  v_lshlrev_b32 v210, 16, v131
  v_and_b32 v211, 0xffff0000, v131
  s_waitcnt lgkmcnt(7)
  v_mfma_f32_32x32x16_bf16 v[32:47], a[32:35], v[196:199], v[32:47]
  v_mul_f32 v208, v208, v68
  v_mfma_f32_32x32x16_bf16 v[48:63], a[36:39], v[196:199], v[48:63]
  ds_read_b64_tr_b16 v[196:197], v231 offset:14336
  ds_read_b64_tr_b16 v[198:199], v231 offset:14592
  v_mul_f32 v209, v209, v69
  v_mul_f32 v210, v210, v70
  s_waitcnt lgkmcnt(6)
  v_mfma_f32_32x32x16_bf16 v[0:15], a[40:43], v[200:203], v[0:15]
  v_mul_f32 v211, v211, v71
  v_mfma_f32_32x32x16_bf16 v[16:31], a[44:47], v[200:203], v[16:31]
  ds_read_b64_tr_b16 v[200:201], v230 offset:15360
  ds_read_b64_tr_b16 v[202:203], v230 offset:15616
  v_cvt_pk_bf16_f32 v218, v208, v209
  v_cvt_pk_bf16_f32 v219, v210, v211
  s_waitcnt lgkmcnt(6)
  v_mfma_f32_32x32x16_bf16 v[32:47], a[40:43], v[204:207], v[32:47]
  v_mfma_f32_32x32x16_bf16 v[48:63], a[44:47], v[204:207], v[48:63]
  ds_read_b64_tr_b16 v[204:205], v231 offset:15360
  ds_read_b64_tr_b16 v[206:207], v231 offset:15616
  s_add_u32 s63, s61, 0
  buffer_store_dwordx4 v[216:219], v228, s[20:23], s63 offen offset:0 sc1
  v_lshlrev_b32 v208, 16, v132
  s_waitcnt lgkmcnt(6)
  v_mfma_f32_32x32x16_bf16 v[0:15], a[48:51], v[192:195], v[0:15]
  v_and_b32 v209, 0xffff0000, v132
  v_mfma_f32_32x32x16_bf16 v[16:31], a[52:55], v[192:195], v[16:31]
  s_waitcnt vmcnt(14)
  s_barrier
  ds_read_b64_tr_b16 v[192:193], v230 offset:24576
  ds_read_b64_tr_b16 v[194:195], v230 offset:24832
  s_add_u32 m0, s59, 77824
  s_add_u32 s62, s58, 1548288
  s_mov_b64 exec, s[96:97]
  buffer_load_dwordx4 v229, s[16:19], s62 offen lds
  s_mov_b64 exec, -1
  s_waitcnt lgkmcnt(6)
  v_mfma_f32_32x32x16_bf16 v[32:47], a[48:51], v[196:199], v[32:47]
  s_add_u32 m0, s59, 81920
  s_add_u32 s62, s58, 1549440
  s_mov_b64 exec, s[96:97]
  buffer_load_dwordx4 v229, s[16:19], s62 offen lds
  s_mov_b64 exec, -1
  v_lshlrev_b32 v210, 16, v133
  v_mfma_f32_32x32x16_bf16 v[48:63], a[52:55], v[196:199], v[48:63]
  ds_read_b64_tr_b16 v[196:197], v231 offset:24576
  ds_read_b64_tr_b16 v[198:199], v231 offset:24832
  s_add_u32 m0, s59, 86016
  s_add_u32 s62, s58, 1550592
  s_mov_b64 exec, s[96:97]
  buffer_load_dwordx4 v229, s[16:19], s62 offen lds
  s_mov_b64 exec, -1
  s_waitcnt lgkmcnt(6)
  v_mfma_f32_32x32x16_bf16 v[0:15], a[56:59], v[200:203], v[0:15]
  v_add_u32 v252, 0x10000, v235
  ds_write_b16 v252, v243 offset:12288
  v_and_b32 v211, 0xffff0000, v133
  v_mfma_f32_32x32x16_bf16 v[16:31], a[60:63], v[200:203], v[16:31]
  ds_read_b64_tr_b16 v[200:201], v230 offset:25600
  ds_read_b64_tr_b16 v[202:203], v230 offset:25856
  v_mul_f32 v208, v208, v72
  s_waitcnt lgkmcnt(7)
  v_mfma_f32_32x32x16_bf16 v[32:47], a[56:59], v[204:207], v[32:47]
  v_mul_f32 v209, v209, v73
  v_mul_f32 v210, v210, v74
  v_mfma_f32_32x32x16_bf16 v[48:63], a[60:63], v[204:207], v[48:63]
  ds_read_b64_tr_b16 v[204:205], v231 offset:25600
  ds_read_b64_tr_b16 v[206:207], v231 offset:25856
  v_mul_f32 v211, v211, v75
  s_waitcnt lgkmcnt(7)
  v_mfma_f32_32x32x16_bf16 v[0:15], a[64:67], v[192:195], v[0:15]
  v_cvt_pk_bf16_f32 v220, v208, v209
  v_cvt_pk_bf16_f32 v221, v210, v211
  v_mfma_f32_32x32x16_bf16 v[16:31], a[68:71], v[192:195], v[16:31]
  ds_read_b64_tr_b16 v[192:193], v230 offset:26624
  ds_read_b64_tr_b16 v[194:195], v230 offset:26880
  v_lshlrev_b32 v208, 16, v134
  s_waitcnt lgkmcnt(7)
  v_mfma_f32_32x32x16_bf16 v[32:47], a[64:67], v[196:199], v[32:47]
  v_and_b32 v209, 0xffff0000, v134
  v_lshlrev_b32 v210, 16, v135
  v_mfma_f32_32x32x16_bf16 v[48:63], a[68:71], v[196:199], v[48:63]
  ds_read_b64_tr_b16 v[196:197], v231 offset:26624
  ds_read_b64_tr_b16 v[198:199], v231 offset:26880
  v_and_b32 v211, 0xffff0000, v135
  s_waitcnt lgkmcnt(6)
  v_mfma_f32_32x32x16_bf16 v[0:15], a[72:75], v[200:203], v[0:15]
  v_mul_f32 v208, v208, v76
  v_mul_f32 v209, v209, v77
  v_mfma_f32_32x32x16_bf16 v[16:31], a[76:79], v[200:203], v[16:31]
  ds_read_b64_tr_b16 v[200:201], v230 offset:27648
  ds_read_b64_tr_b16 v[202:203], v230 offset:27904
  v_mul_f32 v210, v210, v78
  s_waitcnt lgkmcnt(6)
  v_mfma_f32_32x32x16_bf16 v[32:47], a[72:75], v[204:207], v[32:47]
  v_mul_f32 v211, v211, v79
  v_cvt_pk_bf16_f32 v222, v208, v209
  v_mfma_f32_32x32x16_bf16 v[48:63], a[76:79], v[204:207], v[48:63]
  ds_read_b64_tr_b16 v[204:205], v231 offset:27648
  ds_read_b64_tr_b16 v[206:207], v231 offset:27904
  v_cvt_pk_bf16_f32 v223, v210, v211
  s_waitcnt lgkmcnt(6)
  v_mfma_f32_32x32x16_bf16 v[0:15], a[80:83], v[192:195], v[0:15]
  s_add_u32 s63, s61, 0
  buffer_store_dwordx4 v[220:223], v228, s[20:23], s63 offen offset:256 sc1
  v_mfma_f32_32x32x16_bf16 v[16:31], a[84:87], v[192:195], v[16:31]
  s_waitcnt vmcnt(15)
  s_barrier
  ds_read_b64_tr_b16 v[192:193], v230 offset:36864
  ds_read_b64_tr_b16 v[194:195], v230 offset:37120
  s_add_u32 m0, s59, 12288
  s_add_u32 s62, s58, 1769472
  s_mov_b64 exec, s[96:97]
  buffer_load_dwordx4 v229, s[16:19], s62 offen lds
  s_mov_b64 exec, -1
  s_waitcnt lgkmcnt(6)
  v_mfma_f32_32x32x16_bf16 v[32:47], a[80:83], v[196:199], v[32:47]
  s_add_u32 m0, s59, 16384
  s_add_u32 s62, s58, 1770624
  s_mov_b64 exec, s[96:97]
  buffer_load_dwordx4 v229, s[16:19], s62 offen lds
  s_mov_b64 exec, -1
  v_mfma_f32_32x32x16_bf16 v[48:63], a[84:87], v[196:199], v[48:63]
  ds_read_b64_tr_b16 v[196:197], v231 offset:36864
  ds_read_b64_tr_b16 v[198:199], v231 offset:37120
  s_add_u32 m0, s59, 20480
  s_add_u32 s62, s58, 1771776
  s_mov_b64 exec, s[96:97]
  buffer_load_dwordx4 v229, s[16:19], s62 offen lds
  s_mov_b64 exec, -1
  s_waitcnt lgkmcnt(6)
  v_mfma_f32_32x32x16_bf16 v[0:15], a[88:91], v[200:203], v[0:15]
  ds_write_b16 v235, v244 offset:12288
  v_lshlrev_b32 v208, 16, v136
  v_and_b32 v209, 0xffff0000, v136
  v_mfma_f32_32x32x16_bf16 v[16:31], a[92:95], v[200:203], v[16:31]
  ds_read_b64_tr_b16 v[200:201], v230 offset:37888
  ds_read_b64_tr_b16 v[202:203], v230 offset:38144
  v_lshlrev_b32 v210, 16, v137
  s_waitcnt lgkmcnt(7)
  v_mfma_f32_32x32x16_bf16 v[32:47], a[88:91], v[204:207], v[32:47]
  v_and_b32 v211, 0xffff0000, v137
  v_mul_f32 v208, v208, v80
  v_mfma_f32_32x32x16_bf16 v[48:63], a[92:95], v[204:207], v[48:63]
  ds_read_b64_tr_b16 v[204:205], v231 offset:37888
  ds_read_b64_tr_b16 v[206:207], v231 offset:38144
  v_mul_f32 v209, v209, v81
  s_waitcnt lgkmcnt(7)
  v_mfma_f32_32x32x16_bf16 v[0:15], a[96:99], v[192:195], v[0:15]
  v_mul_f32 v210, v210, v82
  v_mul_f32 v211, v211, v83
  v_mfma_f32_32x32x16_bf16 v[16:31], a[100:103], v[192:195], v[16:31]
  ds_read_b64_tr_b16 v[192:193], v230 offset:38912
  ds_read_b64_tr_b16 v[194:195], v230 offset:39168
  v_cvt_pk_bf16_f32 v216, v208, v209
  s_waitcnt lgkmcnt(7)
  v_mfma_f32_32x32x16_bf16 v[32:47], a[96:99], v[196:199], v[32:47]
  v_cvt_pk_bf16_f32 v217, v210, v211
  v_lshlrev_b32 v208, 16, v138
  v_mfma_f32_32x32x16_bf16 v[48:63], a[100:103], v[196:199], v[48:63]
  ds_read_b64_tr_b16 v[196:197], v231 offset:38912
  ds_read_b64_tr_b16 v[198:199], v231 offset:39168
  v_and_b32 v209, 0xffff0000, v138
  s_waitcnt lgkmcnt(6)
  v_mfma_f32_32x32x16_bf16 v[0:15], a[104:107], v[200:203], v[0:15]
  v_lshlrev_b32 v210, 16, v139
  v_and_b32 v211, 0xffff0000, v139
  v_mfma_f32_32x32x16_bf16 v[16:31], a[108:111], v[200:203], v[16:31]
  ds_read_b64_tr_b16 v[200:201], v230 offset:39936
  ds_read_b64_tr_b16 v[202:203], v230 offset:40192
  v_mul_f32 v208, v208, v84
  s_waitcnt lgkmcnt(6)
  v_mfma_f32_32x32x16_bf16 v[32:47], a[104:107], v[204:207], v[32:47]
  v_mul_f32 v209, v209, v85
  v_mul_f32 v210, v210, v86
  v_mfma_f32_32x32x16_bf16 v[48:63], a[108:111], v[204:207], v[48:63]
  ds_read_b64_tr_b16 v[204:205], v231 offset:39936
  ds_read_b64_tr_b16 v[206:207], v231 offset:40192
  v_mul_f32 v211, v211, v87
  s_waitcnt lgkmcnt(6)
  v_mfma_f32_32x32x16_bf16 v[0:15], a[112:115], v[192:195], v[0:15]
  v_cvt_pk_bf16_f32 v218, v208, v209
  v_cvt_pk_bf16_f32 v219, v210, v211
  v_mfma_f32_32x32x16_bf16 v[16:31], a[116:119], v[192:195], v[16:31]
  s_waitcnt vmcnt(15)
  s_barrier
  ds_read_b64_tr_b16 v[192:193], v230 offset:49152
  ds_read_b64_tr_b16 v[194:195], v230 offset:49408
  s_add_u32 m0, s57, 24576
  s_add_u32 s62, s56, 128
  buffer_load_dwordx4 v225, s[8:11], s62 offen lds
  s_waitcnt lgkmcnt(6)
  v_mfma_f32_32x32x16_bf16 v[32:47], a[112:115], v[196:199], v[32:47]
  s_add_u32 m0, s57, 25600
  s_add_u32 s62, s56, 73856
  buffer_load_dwordx4 v225, s[8:11], s62 offen lds
  v_mfma_f32_32x32x16_bf16 v[48:63], a[116:119], v[196:199], v[48:63]
  ds_read_b64_tr_b16 v[196:197], v231 offset:49152
  ds_read_b64_tr_b16 v[198:199], v231 offset:49408
  s_add_u32 m0, s57, 26624
  s_add_u32 s62, s56, 147584
  buffer_load_dwordx4 v225, s[8:11], s62 offen lds
  s_waitcnt lgkmcnt(6)
  v_mfma_f32_32x32x16_bf16 v[0:15], a[120:123], v[200:203], v[0:15]
  s_add_u32 s63, s61, 86016
  buffer_store_dwordx4 v[216:219], v228, s[20:23], s63 offen offset:0 sc1
  v_lshlrev_b32 v208, 16, v140
  v_mfma_f32_32x32x16_bf16 v[16:31], a[124:127], v[200:203], v[16:31]
  ds_read_b64_tr_b16 v[200:201], v230 offset:50176
  ds_read_b64_tr_b16 v[202:203], v230 offset:50432
  v_and_b32 v209, 0xffff0000, v140
  s_waitcnt lgkmcnt(6)
  v_mfma_f32_32x32x16_bf16 v[32:47], a[120:123], v[204:207], v[32:47]
  v_lshlrev_b32 v210, 16, v141
  v_and_b32 v211, 0xffff0000, v141
  v_mfma_f32_32x32x16_bf16 v[48:63], a[124:127], v[204:207], v[48:63]
  ds_read_b64_tr_b16 v[204:205], v231 offset:50176
  ds_read_b64_tr_b16 v[206:207], v231 offset:50432
  v_mul_f32 v208, v208, v88
  s_waitcnt lgkmcnt(6)
  v_mfma_f32_32x32x16_bf16 v[0:15], a[128:131], v[192:195], v[0:15]
  v_mul_f32 v209, v209, v89
  v_mul_f32 v210, v210, v90
  v_mfma_f32_32x32x16_bf16 v[16:31], a[132:135], v[192:195], v[16:31]
  ds_read_b64_tr_b16 v[192:193], v230 offset:51200
  ds_read_b64_tr_b16 v[194:195], v230 offset:51456
  v_mul_f32 v211, v211, v91
  s_waitcnt lgkmcnt(6)
  v_mfma_f32_32x32x16_bf16 v[32:47], a[128:131], v[196:199], v[32:47]
  v_cvt_pk_bf16_f32 v220, v208, v209
  v_cvt_pk_bf16_f32 v221, v210, v211
  v_mfma_f32_32x32x16_bf16 v[48:63], a[132:135], v[196:199], v[48:63]
  ds_read_b64_tr_b16 v[196:197], v231 offset:51200
  ds_read_b64_tr_b16 v[198:199], v231 offset:51456
  v_lshlrev_b32 v208, 16, v142
  s_waitcnt lgkmcnt(6)
  v_mfma_f32_32x32x16_bf16 v[0:15], a[136:139], v[200:203], v[0:15]
  v_and_b32 v209, 0xffff0000, v142
  v_lshlrev_b32 v210, 16, v143
  v_mfma_f32_32x32x16_bf16 v[16:31], a[140:143], v[200:203], v[16:31]
  ds_read_b64_tr_b16 v[200:201], v230 offset:52224
  ds_read_b64_tr_b16 v[202:203], v230 offset:52480
  v_and_b32 v211, 0xffff0000, v143
  s_waitcnt lgkmcnt(6)
  v_mfma_f32_32x32x16_bf16 v[32:47], a[136:139], v[204:207], v[32:47]
  v_mul_f32 v208, v208, v92
  v_mul_f32 v209, v209, v93
  v_mfma_f32_32x32x16_bf16 v[48:63], a[140:143], v[204:207], v[48:63]
  ds_read_b64_tr_b16 v[204:205], v231 offset:52224
  ds_read_b64_tr_b16 v[206:207], v231 offset:52480
  v_mul_f32 v210, v210, v94
  s_waitcnt lgkmcnt(6)
  v_mfma_f32_32x32x16_bf16 v[0:15], a[144:147], v[192:195], v[0:15]
  v_mul_f32 v211, v211, v95
  v_cvt_pk_bf16_f32 v222, v208, v209
  v_mfma_f32_32x32x16_bf16 v[16:31], a[148:151], v[192:195], v[16:31]
  s_waitcnt vmcnt(15)
  s_barrier
  ds_read_b64_tr_b16 v[192:193], v230 offset:0
  ds_read_b64_tr_b16 v[194:195], v230 offset:256
  s_add_u32 m0, s57, 36864
  s_add_u32 s62, s56, 884864
  buffer_load_dwordx4 v225, s[8:11], s62 offen lds
  s_waitcnt lgkmcnt(6)
  v_mfma_f32_32x32x16_bf16 v[32:47], a[144:147], v[196:199], v[32:47]
  s_add_u32 m0, s57, 37888
  s_add_u32 s62, s56, 958592
  buffer_load_dwordx4 v225, s[8:11], s62 offen lds
  v_cvt_pk_bf16_f32 v223, v210, v211
  v_mfma_f32_32x32x16_bf16 v[48:63], a[148:151], v[196:199], v[48:63]
  ds_read_b64_tr_b16 v[196:197], v231 offset:0
  ds_read_b64_tr_b16 v[198:199], v231 offset:256
  s_add_u32 m0, s57, 38912
  s_add_u32 s62, s56, 1032320
  buffer_load_dwordx4 v225, s[8:11], s62 offen lds
  s_waitcnt lgkmcnt(6)
  v_mfma_f32_32x32x16_bf16 v[0:15], a[152:155], v[200:203], v[0:15]
  s_add_u32 s63, s61, 86016
  buffer_store_dwordx4 v[220:223], v228, s[20:23], s63 offen offset:256 sc1
  v_mfma_f32_32x32x16_bf16 v[16:31], a[156:159], v[200:203], v[16:31]
  ds_read_b64_tr_b16 v[200:201], v230 offset:1024
  ds_read_b64_tr_b16 v[202:203], v230 offset:1280
  v_lshlrev_b32 v208, 16, v144
  v_and_b32 v209, 0xffff0000, v144
  s_waitcnt lgkmcnt(6)
  v_mfma_f32_32x32x16_bf16 v[32:47], a[152:155], v[204:207], v[32:47]
  v_lshlrev_b32 v210, 16, v145
  v_mfma_f32_32x32x16_bf16 v[48:63], a[156:159], v[204:207], v[48:63]
  ds_read_b64_tr_b16 v[204:205], v231 offset:1024
  ds_read_b64_tr_b16 v[206:207], v231 offset:1280
  v_and_b32 v211, 0xffff0000, v145
  v_mul_f32 v208, v208, v96
  s_waitcnt lgkmcnt(6)
  v_mfma_f32_32x32x16_bf16 v[0:15], a[160:163], v[192:195], v[0:15]
  v_mul_f32 v209, v209, v97
  v_mfma_f32_32x32x16_bf16 v[16:31], a[164:167], v[192:195], v[16:31]
  ds_read_b64_tr_b16 v[192:193], v230 offset:2048
  ds_read_b64_tr_b16 v[194:195], v230 offset:2304
  v_mul_f32 v210, v210, v98
  v_mul_f32 v211, v211, v99
  s_waitcnt lgkmcnt(6)
  v_mfma_f32_32x32x16_bf16 v[32:47], a[160:163], v[196:199], v[32:47]
  v_cvt_pk_bf16_f32 v216, v208, v209
  v_mfma_f32_32x32x16_bf16 v[48:63], a[164:167], v[196:199], v[48:63]
  ds_read_b64_tr_b16 v[196:197], v231 offset:2048
  ds_read_b64_tr_b16 v[198:199], v231 offset:2304
  v_cvt_pk_bf16_f32 v217, v210, v211
  v_lshlrev_b32 v208, 16, v146
  s_waitcnt lgkmcnt(6)
  v_mfma_f32_32x32x16_bf16 v[0:15], a[168:171], v[200:203], v[0:15]
  v_and_b32 v209, 0xffff0000, v146
  v_mfma_f32_32x32x16_bf16 v[16:31], a[172:175], v[200:203], v[16:31]
  ds_read_b64_tr_b16 v[200:201], v230 offset:3072
  ds_read_b64_tr_b16 v[202:203], v230 offset:3328
  v_lshlrev_b32 v210, 16, v147
  v_and_b32 v211, 0xffff0000, v147
  s_waitcnt lgkmcnt(6)
  v_mfma_f32_32x32x16_bf16 v[32:47], a[168:171], v[204:207], v[32:47]
  v_mul_f32 v208, v208, v100
  v_mfma_f32_32x32x16_bf16 v[48:63], a[172:175], v[204:207], v[48:63]
  ds_read_b64_tr_b16 v[204:205], v231 offset:3072
  ds_read_b64_tr_b16 v[206:207], v231 offset:3328
  v_mul_f32 v209, v209, v101
  v_mul_f32 v210, v210, v102
  s_waitcnt lgkmcnt(6)
  v_mfma_f32_32x32x16_bf16 v[0:15], a[176:179], v[192:195], v[0:15]
  v_mul_f32 v211, v211, v103
  v_mfma_f32_32x32x16_bf16 v[16:31], a[180:183], v[192:195], v[16:31]
  s_waitcnt vmcnt(16)
  s_barrier
  ds_read_b64_tr_b16 v[192:193], v253 offset:0
  ds_read_b64_tr_b16 v[194:195], v253 offset:256
  s_add_u32 m0, s57, 49152
  s_add_u32 s62, s56, 1769600
  buffer_load_dwordx4 v225, s[8:11], s62 offen lds
  s_waitcnt lgkmcnt(6)
  v_mfma_f32_32x32x16_bf16 v[32:47], a[176:179], v[196:199], v[32:47]
  s_add_u32 m0, s57, 50176
  s_add_u32 s62, s56, 1843328
  buffer_load_dwordx4 v225, s[8:11], s62 offen lds
  v_cvt_pk_bf16_f32 v218, v208, v209
  v_mfma_f32_32x32x16_bf16 v[48:63], a[180:183], v[196:199], v[48:63]
  ds_read_b64_tr_b16 v[196:197], v254 offset:0
  ds_read_b64_tr_b16 v[198:199], v254 offset:256
  s_add_u32 m0, s57, 51200
  s_add_u32 s62, s56, 1917056
  buffer_load_dwordx4 v225, s[8:11], s62 offen lds
  v_cvt_pk_bf16_f32 v219, v210, v211
  s_waitcnt lgkmcnt(6)
  v_mfma_f32_32x32x16_bf16 v[0:15], a[184:187], v[200:203], v[0:15]
  v_mfma_f32_32x32x16_bf16 v[16:31], a[188:191], v[200:203], v[16:31]
  ds_read_b64_tr_b16 v[200:201], v253 offset:1024
  ds_read_b64_tr_b16 v[202:203], v253 offset:1280
  s_add_u32 s63, s61, 2048
  buffer_store_dwordx4 v[216:219], v228, s[20:23], s63 offen offset:0 sc1
  v_lshlrev_b32 v208, 16, v148
  s_waitcnt lgkmcnt(6)
  v_mfma_f32_32x32x16_bf16 v[32:47], a[184:187], v[204:207], v[32:47]
  v_and_b32 v209, 0xffff0000, v148
  v_mfma_f32_32x32x16_bf16 v[48:63], a[188:191], v[204:207], v[48:63]
  ds_read_b64_tr_b16 v[204:205], v254 offset:1024
  ds_read_b64_tr_b16 v[206:207], v254 offset:1280
  v_lshlrev_b32 v210, 16, v149
  v_and_b32 v211, 0xffff0000, v149
  s_waitcnt lgkmcnt(6)
  v_mfma_f32_32x32x16_bf16 v[0:15], a[192:195], v[192:195], v[0:15]
  v_mul_f32 v208, v208, v104
  v_mul_f32 v209, v209, v105
  v_mfma_f32_32x32x16_bf16 v[16:31], a[196:199], v[192:195], v[16:31]
  ds_read_b64_tr_b16 v[192:193], v253 offset:2048
  ds_read_b64_tr_b16 v[194:195], v253 offset:2304
  v_mul_f32 v210, v210, v106
  s_waitcnt lgkmcnt(6)
  v_mfma_f32_32x32x16_bf16 v[32:47], a[192:195], v[196:199], v[32:47]
  v_mul_f32 v211, v211, v107
  v_cvt_pk_bf16_f32 v220, v208, v209
  v_mfma_f32_32x32x16_bf16 v[48:63], a[196:199], v[196:199], v[48:63]
  ds_read_b64_tr_b16 v[196:197], v254 offset:2048
  ds_read_b64_tr_b16 v[198:199], v254 offset:2304
  v_cvt_pk_bf16_f32 v221, v210, v211
  s_waitcnt lgkmcnt(6)
  v_mfma_f32_32x32x16_bf16 v[0:15], a[200:203], v[200:203], v[0:15]
  v_lshlrev_b32 v208, 16, v150
  v_and_b32 v209, 0xffff0000, v150
  v_mfma_f32_32x32x16_bf16 v[16:31], a[204:207], v[200:203], v[16:31]
  ds_read_b64_tr_b16 v[200:201], v253 offset:3072
  ds_read_b64_tr_b16 v[202:203], v253 offset:3328
  v_lshlrev_b32 v210, 16, v151
  s_waitcnt lgkmcnt(6)
  v_mfma_f32_32x32x16_bf16 v[32:47], a[200:203], v[204:207], v[32:47]
  v_and_b32 v211, 0xffff0000, v151
  v_mul_f32 v208, v208, v108
  v_mfma_f32_32x32x16_bf16 v[48:63], a[204:207], v[204:207], v[48:63]
  ds_read_b64_tr_b16 v[204:205], v254 offset:3072
  ds_read_b64_tr_b16 v[206:207], v254 offset:3328
  v_mul_f32 v209, v209, v109
  s_waitcnt lgkmcnt(6)
  v_mfma_f32_32x32x16_bf16 v[0:15], a[208:211], v[192:195], v[0:15]
  v_mul_f32 v210, v210, v110
  v_mul_f32 v211, v211, v111
  v_mfma_f32_32x32x16_bf16 v[16:31], a[212:215], v[192:195], v[16:31]
  s_waitcnt vmcnt(16)
  s_barrier
  ds_read_b64_tr_b16 v[192:193], v253 offset:12288
  ds_read_b64_tr_b16 v[194:195], v253 offset:12544
  s_add_u32 m0, s57, 0
  s_add_u32 s62, s56, 2654336
  buffer_load_dwordx4 v225, s[8:11], s62 offen lds
  s_waitcnt lgkmcnt(6)
  v_mfma_f32_32x32x16_bf16 v[32:47], a[208:211], v[196:199], v[32:47]
  s_add_u32 m0, s57, 1024
  s_add_u32 s62, s56, 2728064
  buffer_load_dwordx4 v225, s[8:11], s62 offen lds
  v_cvt_pk_bf16_f32 v222, v208, v209
  v_mfma_f32_32x32x16_bf16 v[48:63], a[212:215], v[196:199], v[48:63]
  ds_read_b64_tr_b16 v[196:197], v254 offset:12288
  ds_read_b64_tr_b16 v[198:199], v254 offset:12544
  s_add_u32 m0, s57, 2048
  s_add_u32 s62, s56, 2801792
  buffer_load_dwordx4 v225, s[8:11], s62 offen lds
  s_waitcnt lgkmcnt(6)
  v_mfma_f32_32x32x16_bf16 v[0:15], a[216:219], v[200:203], v[0:15]
  v_cvt_pk_bf16_f32 v223, v210, v211
  v_mfma_f32_32x32x16_bf16 v[16:31], a[220:223], v[200:203], v[16:31]
  ds_read_b64_tr_b16 v[200:201], v253 offset:13312
  ds_read_b64_tr_b16 v[202:203], v253 offset:13568
  s_add_u32 s63, s61, 2048
  buffer_store_dwordx4 v[220:223], v228, s[20:23], s63 offen offset:256 sc1
  s_waitcnt lgkmcnt(6)
  v_mfma_f32_32x32x16_bf16 v[32:47], a[216:219], v[204:207], v[32:47]
  v_lshlrev_b32 v208, 16, v152
  v_and_b32 v209, 0xffff0000, v152
  v_mfma_f32_32x32x16_bf16 v[48:63], a[220:223], v[204:207], v[48:63]
  ds_read_b64_tr_b16 v[204:205], v254 offset:13312
  ds_read_b64_tr_b16 v[206:207], v254 offset:13568
  v_lshlrev_b32 v210, 16, v153
  s_waitcnt lgkmcnt(6)
  v_mfma_f32_32x32x16_bf16 v[0:15], a[224:227], v[192:195], v[0:15]
  v_and_b32 v211, 0xffff0000, v153
  v_mul_f32 v208, v208, v112
  v_mfma_f32_32x32x16_bf16 v[16:31], a[228:231], v[192:195], v[16:31]
  ds_read_b64_tr_b16 v[192:193], v253 offset:14336
  ds_read_b64_tr_b16 v[194:195], v253 offset:14592
  v_mul_f32 v209, v209, v113
  s_waitcnt lgkmcnt(6)
  v_mfma_f32_32x32x16_bf16 v[32:47], a[224:227], v[196:199], v[32:47]
  v_mul_f32 v210, v210, v114
  v_mul_f32 v211, v211, v115
  v_mfma_f32_32x32x16_bf16 v[48:63], a[228:231], v[196:199], v[48:63]
  ds_read_b64_tr_b16 v[196:197], v254 offset:14336
  ds_read_b64_tr_b16 v[198:199], v254 offset:14592
  v_cvt_pk_bf16_f32 v216, v208, v209
  s_waitcnt lgkmcnt(6)
  v_mfma_f32_32x32x16_bf16 v[0:15], a[232:235], v[200:203], v[0:15]
  v_cvt_pk_bf16_f32 v217, v210, v211
  v_lshlrev_b32 v208, 16, v154
  v_mfma_f32_32x32x16_bf16 v[16:31], a[236:239], v[200:203], v[16:31]
  ds_read_b64_tr_b16 v[200:201], v253 offset:15360
  ds_read_b64_tr_b16 v[202:203], v253 offset:15616
  v_and_b32 v209, 0xffff0000, v154
  s_waitcnt lgkmcnt(6)
  v_mfma_f32_32x32x16_bf16 v[32:47], a[232:235], v[204:207], v[32:47]
  v_lshlrev_b32 v210, 16, v155
  v_and_b32 v211, 0xffff0000, v155
  v_mfma_f32_32x32x16_bf16 v[48:63], a[236:239], v[204:207], v[48:63]
  ds_read_b64_tr_b16 v[204:205], v254 offset:15360
  ds_read_b64_tr_b16 v[206:207], v254 offset:15616
  v_mul_f32 v208, v208, v116
  s_waitcnt lgkmcnt(6)
  v_mfma_f32_32x32x16_bf16 v[0:15], a[240:243], v[192:195], v[0:15]
  v_mul_f32 v209, v209, v117
  v_mul_f32 v210, v210, v118
  v_mfma_f32_32x32x16_bf16 v[16:31], a[244:247], v[192:195], v[16:31]
  s_waitcnt vmcnt(16)
  s_barrier
  ds_read_b64_tr_b16 v[192:193], v230 offset:12288
  ds_read_b64_tr_b16 v[194:195], v230 offset:12544
  s_add_u32 m0, s57, 65536
  s_add_u32 s62, s56, 3539072
  buffer_load_dwordx4 v225, s[8:11], s62 offen lds
  s_waitcnt lgkmcnt(6)
  v_mfma_f32_32x32x16_bf16 v[32:47], a[240:243], v[196:199], v[32:47]
  s_add_u32 m0, s57, 66560
  s_add_u32 s62, s56, 3612800
  buffer_load_dwordx4 v225, s[8:11], s62 offen lds
  v_mul_f32 v211, v211, v119
  v_mfma_f32_32x32x16_bf16 v[48:63], a[244:247], v[196:199], v[48:63]
  ds_read_b64_tr_b16 v[196:197], v231 offset:12288
  ds_read_b64_tr_b16 v[198:199], v231 offset:12544
  s_add_u32 m0, s57, 67584
  s_add_u32 s62, s56, 3686528
  buffer_load_dwordx4 v225, s[8:11], s62 offen lds
  s_waitcnt lgkmcnt(6)
  v_mfma_f32_32x32x16_bf16 v[0:15], a[248:251], v[200:203], v[0:15]
  v_cvt_pk_bf16_f32 v218, v208, v209
  v_cvt_pk_bf16_f32 v219, v210, v211
  v_mfma_f32_32x32x16_bf16 v[16:31], a[252:255], v[200:203], v[16:31]
  ds_read_b64_tr_b16 v[200:201], v230 offset:13312
  ds_read_b64_tr_b16 v[202:203], v230 offset:13568
  s_waitcnt lgkmcnt(6)
  v_mfma_f32_32x32x16_bf16 v[32:47], a[248:251], v[204:207], v[32:47]
  s_add_u32 s63, s61, 88064
  buffer_store_dwordx4 v[216:219], v228, s[20:23], s63 offen offset:0 sc1
  v_lshlrev_b32 v208, 16, v156
  v_mfma_f32_32x32x16_bf16 v[48:63], a[252:255], v[204:207], v[48:63]
  ds_read_b64_tr_b16 v[204:205], v231 offset:13312
  ds_read_b64_tr_b16 v[206:207], v231 offset:13568
  v_and_b32 v209, 0xffff0000, v156
  s_waitcnt lgkmcnt(6)
  v_mfma_f32_32x32x16_bf16 v[0:15], v[160:163], v[192:195], v[0:15]
  v_lshlrev_b32 v210, 16, v157
  v_and_b32 v211, 0xffff0000, v157
  v_mfma_f32_32x32x16_bf16 v[16:31], v[164:167], v[192:195], v[16:31]
  ds_read_b64_tr_b16 v[192:193], v230 offset:14336
  ds_read_b64_tr_b16 v[194:195], v230 offset:14592
  v_mul_f32 v208, v208, v120
  s_waitcnt lgkmcnt(6)
  v_mfma_f32_32x32x16_bf16 v[32:47], v[160:163], v[196:199], v[32:47]
  v_mul_f32 v209, v209, v121
  v_mul_f32 v210, v210, v122
  v_mfma_f32_32x32x16_bf16 v[48:63], v[164:167], v[196:199], v[48:63]
  ds_read_b64_tr_b16 v[196:197], v231 offset:14336
  ds_read_b64_tr_b16 v[198:199], v231 offset:14592
  v_mul_f32 v211, v211, v123
  s_waitcnt lgkmcnt(6)
  v_mfma_f32_32x32x16_bf16 v[0:15], v[168:171], v[200:203], v[0:15]
  v_cvt_pk_bf16_f32 v220, v208, v209
  v_cvt_pk_bf16_f32 v221, v210, v211
  v_mfma_f32_32x32x16_bf16 v[16:31], v[172:175], v[200:203], v[16:31]
  ds_read_b64_tr_b16 v[200:201], v230 offset:15360
  ds_read_b64_tr_b16 v[202:203], v230 offset:15616
  v_lshlrev_b32 v208, 16, v158
  s_waitcnt lgkmcnt(6)
  v_mfma_f32_32x32x16_bf16 v[32:47], v[168:171], v[204:207], v[32:47]
  v_and_b32 v209, 0xffff0000, v158
  v_lshlrev_b32 v210, 16, v159
  v_mfma_f32_32x32x16_bf16 v[48:63], v[172:175], v[204:207], v[48:63]
  ds_read_b64_tr_b16 v[204:205], v231 offset:15360
  ds_read_b64_tr_b16 v[206:207], v231 offset:15616
  v_and_b32 v211, 0xffff0000, v159
  s_waitcnt lgkmcnt(6)
  v_mfma_f32_32x32x16_bf16 v[0:15], v[176:179], v[192:195], v[0:15]
  v_mul_f32 v208, v208, v124
  v_mul_f32 v209, v209, v125
  v_mfma_f32_32x32x16_bf16 v[16:31], v[180:183], v[192:195], v[16:31]
  s_waitcnt vmcnt(17)
  s_barrier
  v_add_u32 v253, 0x10000, v226
  v_add_u32 v254, 0x10000, v227
  ds_read_b64_tr_b16 v[192:193], v226 offset:24576
  ds_read_b64_tr_b16 v[194:195], v226 offset:25088
  s_add_u32 m0, s57, 77824
  s_add_u32 s62, s56, 4423808
  buffer_load_dwordx4 v225, s[8:11], s62 offen lds
  s_waitcnt lgkmcnt(6)
  v_mfma_f32_32x32x16_bf16 v[32:47], v[176:179], v[196:199], v[32:47]
  s_add_u32 m0, s57, 78848
  s_add_u32 s62, s56, 4497536
  buffer_load_dwordx4 v225, s[8:11], s62 offen lds
  v_mul_f32 v210, v210, v126
  v_mfma_f32_32x32x16_bf16 v[48:63], v[180:183], v[196:199], v[48:63]
  ds_read_b64_tr_b16 v[196:197], v227 offset:24576
  ds_read_b64_tr_b16 v[198:199], v227 offset:25088
  s_add_u32 m0, s57, 79872
  s_add_u32 s62, s56, 4571264
  buffer_load_dwordx4 v225, s[8:11], s62 offen lds
  s_waitcnt lgkmcnt(6)
  v_mfma_f32_32x32x16_bf16 v[0:15], v[184:187], v[200:203], v[0:15]
  v_lshlrev_b32 v244, 2, v249
  v_mul_f32 v211, v211, v127
  v_cvt_pk_bf16_f32 v222, v208, v209
  v_mfma_f32_32x32x16_bf16 v[16:31], v[188:191], v[200:203], v[16:31]
  ds_read_b64_tr_b16 v[200:201], v226 offset:26624
  ds_read_b64_tr_b16 v[202:203], v226 offset:27136
  buffer_load_dword v252, v244, s[40:43], 0 offen sc1
  v_cvt_pk_bf16_f32 v223, v210, v211
  s_waitcnt lgkmcnt(6)
  v_mfma_f32_32x32x16_bf16 v[32:47], v[184:187], v[204:207], v[32:47]
  ds_read_b64_tr_b16 v[240:241], v246 offset:0
  ds_read_b64_tr_b16 v[242:243], v246 offset:512
  v_mfma_f32_32x32x16_bf16 v[48:63], v[188:191], v[204:207], v[48:63]
  ds_read_b64_tr_b16 v[204:205], v227 offset:26624
  ds_read_b64_tr_b16 v[206:207], v227 offset:27136
  s_add_u32 s63, s61, 88064
  buffer_store_dwordx4 v[220:223], v228, s[20:23], s63 offen offset:256 sc1
  s_waitcnt lgkmcnt(8)
  v_mfma_f32_32x32x16_bf16 v[64:79], v[192:195], a[0:3], 0
  s_add_u32 s62, s65, 0
  s_waitcnt lgkmcnt(2)
  buffer_store_dwordx4 v[240:243], v224, s[32:35], s62 offen sc1
  v_mfma_f32_32x32x16_bf16 v[80:95], v[192:195], a[4:7], 0
  ds_read_b64_tr_b16 v[192:193], v226 offset:28672
  ds_read_b64_tr_b16 v[194:195], v226 offset:29184
  ds_read_b64_tr_b16 v[240:241], v246 offset:1024
  ds_read_b64_tr_b16 v[242:243], v246 offset:1536
  v_mfma_f32_32x32x16_bf16 v[96:111], v[196:199], a[0:3], 0
  v_mfma_f32_32x32x16_bf16 v[112:127], v[196:199], a[4:7], 0
  ds_read_b64_tr_b16 v[196:197], v227 offset:28672
  ds_read_b64_tr_b16 v[198:199], v227 offset:29184
  s_add_u32 s62, s65, 4096
  s_waitcnt lgkmcnt(2)
  buffer_store_dwordx4 v[240:243], v224, s[32:35], s62 offen sc1
  v_mfma_f32_32x32x16_bf16 v[64:79], v[200:203], a[8:11], v[64:79]
  ds_read_b64_tr_b16 v[240:241], v246 offset:2048
  ds_read_b64_tr_b16 v[242:243], v246 offset:2560
  v_mfma_f32_32x32x16_bf16 v[80:95], v[200:203], a[12:15], v[80:95]
  ds_read_b64_tr_b16 v[200:201], v226 offset:30720
  ds_read_b64_tr_b16 v[202:203], v226 offset:31232
  v_mfma_f32_32x32x16_bf16 v[96:111], v[204:207], a[8:11], v[96:111]
  s_add_u32 s62, s65, 8192
  s_waitcnt lgkmcnt(2)
  buffer_store_dwordx4 v[240:243], v224, s[32:35], s62 offen sc1
  v_mfma_f32_32x32x16_bf16 v[112:127], v[204:207], a[12:15], v[112:127]
  ds_read_b64_tr_b16 v[204:205], v227 offset:30720
  ds_read_b64_tr_b16 v[206:207], v227 offset:31232
  ds_read_b64_tr_b16 v[240:241], v246 offset:3072
  ds_read_b64_tr_b16 v[242:243], v246 offset:3584
  s_lshl_b32 s63, s3, 7
  s_add_u32 s63, s63, 62464
  v_lshrrev_b32 v237, 5, v249
  v_lshlrev_b32 v237, 3, v237
  v_add_u32 v237, s63, v237
  v_add_u32 v236, 1632, v247
  v_cndmask_b32 v236, v236, v237, s[98:99]
  s_lshl_b32 s63, s3, 8
  s_add_u32 s63, s63, 61440
  v_lshlrev_b32 v237, 2, v249
  v_add_u32 v237, s63, v237
  s_mul_i32 s63, s3, 3072
  s_add_u32 s63, s63, 145408
  v_add_u32 v238, s63, v224
  v_mfma_f32_32x32x16_bf16 v[64:79], v[192:195], a[16:19], v[64:79]
  s_mul_i32 s63, s3, 4352
  s_add_u32 s63, s63, 129152
  v_add_u32 v220, s63, v224
  v_mov_b32 v216, 0
  v_mov_b32 v217, 0
  v_mfma_f32_32x32x16_bf16 v[80:95], v[192:195], a[20:23], v[80:95]
  ds_read_b64_tr_b16 v[192:193], v226 offset:32768
  ds_read_b64_tr_b16 v[194:195], v226 offset:33280
  s_add_u32 s62, s65, 12288
  s_waitcnt lgkmcnt(2)
  buffer_store_dwordx4 v[240:243], v224, s[32:35], s62 offen sc1
  v_mfma_f32_32x32x16_bf16 v[96:111], v[196:199], a[16:19], v[96:111]
  ds_read_b64_tr_b16 v[240:241], v246 offset:4096
  ds_read_b64_tr_b16 v[242:243], v246 offset:4608
  v_mov_b32 v218, 0
  v_mov_b32 v219, 0
  ds_write_b128 v220, v[216:219]
  ds_write_b128 v220, v[216:219] offset:1024
  ds_write_b128 v220, v[216:219] offset:1152
  v_min_f32 v212, 0, v0
  v_min_f32 v213, 0, v1
  v_min_f32 v214, 0, v2
  v_mfma_f32_32x32x16_bf16 v[112:127], v[196:199], a[20:23], v[112:127]
  ds_read_b64_tr_b16 v[196:197], v227 offset:32768
  ds_read_b64_tr_b16 v[198:199], v227 offset:33280
  v_min_f32 v215, 0, v3
  v_max_f32 v208, 0, v0
  v_max_f32 v209, 0, v1
  v_max_f32 v210, 0, v2
  v_mfma_f32_32x32x16_bf16 v[64:79], v[200:203], a[24:27], v[64:79]
  s_add_u32 s62, s65, 16384
  s_waitcnt lgkmcnt(5)
  buffer_store_dwordx4 v[240:243], v224, s[32:35], s62 offen sc1
  v_max_f32 v211, 0, v3
  v_mul_f32 v212, 0x3fb8aa3b, v212
  v_mul_f32 v213, 0x3fb8aa3b, v213
  v_mul_f32 v214, 0x3fb8aa3b, v214
  v_mfma_f32_32x32x16_bf16 v[80:95], v[200:203], a[28:31], v[80:95]
  ds_read_b64_tr_b16 v[200:201], v226 offset:34816
  ds_read_b64_tr_b16 v[202:203], v226 offset:35328
  ds_read_b64_tr_b16 v[240:241], v246 offset:5120
  ds_read_b64_tr_b16 v[242:243], v246 offset:5632
  v_mul_f32 v215, 0x3fb8aa3b, v215
  v_exp_f32 v212, v212
  v_mfma_f32_32x32x16_bf16 v[96:111], v[204:207], a[24:27], v[96:111]
  v_exp_f32 v213, v213
  v_exp_f32 v214, v214
  v_exp_f32 v215, v215
  v_mfma_f32_32x32x16_bf16 v[112:127], v[204:207], a[28:31], v[112:127]
  ds_read_b64_tr_b16 v[204:205], v227 offset:34816
  ds_read_b64_tr_b16 v[206:207], v227 offset:35328
  s_add_u32 s62, s65, 20480
  s_waitcnt lgkmcnt(2)
  buffer_store_dwordx4 v[240:243], v224, s[32:35], s62 offen sc1
  v_add_f32 v208, 0x358637bd, v208
  v_add_f32 v209, 0x358637bd, v209
  v_mfma_f32_32x32x16_bf16 v[64:79], v[192:195], a[32:35], v[64:79]
  ds_read_b64_tr_b16 v[240:241], v246 offset:6144
  ds_read_b64_tr_b16 v[242:243], v246 offset:6656
  v_add_f32 v210, 0x358637bd, v210
  v_add_f32 v211, 0x358637bd, v211
  v_add_f32 v208, v208, v212
  v_add_f32 v209, v209, v213
  v_mfma_f32_32x32x16_bf16 v[80:95], v[192:195], a[36:39], v[80:95]
  s_waitcnt vmcnt(24)
  s_barrier
  ds_read_b64_tr_b16 v[192:193], v226 offset:36864
  ds_read_b64_tr_b16 v[194:195], v226 offset:37376
  s_add_u32 m0, s57, 12288
  s_add_u32 s62, s56, 128
  buffer_load_dwordx4 v225, s[12:15], s62 offen lds
  v_mfma_f32_32x32x16_bf16 v[96:111], v[196:199], a[32:35], v[96:111]
  s_add_u32 m0, s57, 13312
  s_add_u32 s62, s56, 73856
  buffer_load_dwordx4 v225, s[12:15], s62 offen lds
  v_add_f32 v210, v210, v214
  v_add_f32 v211, v211, v215
  v_cvt_pk_bf16_f32 v0, v208, v209
  v_mfma_f32_32x32x16_bf16 v[112:127], v[196:199], a[36:39], v[112:127]
  ds_read_b64_tr_b16 v[196:197], v227 offset:36864
  ds_read_b64_tr_b16 v[198:199], v227 offset:37376
  s_add_u32 m0, s57, 14336
  s_add_u32 s62, s56, 147584
  buffer_load_dwordx4 v225, s[12:15], s62 offen lds
  v_cvt_pk_bf16_f32 v1, v210, v211
  v_mfma_f32_32x32x16_bf16 v[64:79], v[200:203], a[40:43], v[64:79]
  v_min_f32 v212, 0, v4
  v_min_f32 v213, 0, v5
  v_min_f32 v214, 0, v6
  v_min_f32 v215, 0, v7
  v_max_f32 v208, 0, v4
  v_max_f32 v209, 0, v5
  v_max_f32 v210, 0, v6
  v_mfma_f32_32x32x16_bf16 v[80:95], v[200:203], a[44:47], v[80:95]
  ds_read_b64_tr_b16 v[200:201], v226 offset:38912
  ds_read_b64_tr_b16 v[202:203], v226 offset:39424
  s_add_u32 s62, s65, 24576
  s_waitcnt lgkmcnt(6)
  buffer_store_dwordx4 v[240:243], v224, s[32:35], s62 offen sc1
  v_max_f32 v211, 0, v7
  v_mul_f32 v212, 0x3fb8aa3b, v212
  v_mfma_f32_32x32x16_bf16 v[96:111], v[204:207], a[40:43], v[96:111]
  ds_read_b64_tr_b16 v[240:241], v246 offset:7168
  ds_read_b64_tr_b16 v[242:243], v246 offset:7680
  v_mul_f32 v213, 0x3fb8aa3b, v213
  v_mul_f32 v214, 0x3fb8aa3b, v214
  v_mul_f32 v215, 0x3fb8aa3b, v215
  v_mfma_f32_32x32x16_bf16 v[112:127], v[204:207], a[44:47], v[112:127]
  ds_read_b64_tr_b16 v[204:205], v227 offset:38912
  ds_read_b64_tr_b16 v[206:207], v227 offset:39424
  v_exp_f32 v212, v212
  v_exp_f32 v213, v213
  s_waitcnt lgkmcnt(8)
  v_mfma_f32_32x32x16_bf16 v[64:79], v[192:195], a[48:51], v[64:79]
  s_add_u32 s62, s65, 28672
  s_waitcnt lgkmcnt(2)
  buffer_store_dwordx4 v[240:243], v224, s[32:35], s62 offen sc1
  v_exp_f32 v214, v214
  v_exp_f32 v215, v215
  v_add_f32 v208, 0x358637bd, v208
  v_mfma_f32_32x32x16_bf16 v[80:95], v[192:195], a[52:55], v[80:95]
  ds_read_b64_tr_b16 v[192:193], v226 offset:40960
  ds_read_b64_tr_b16 v[194:195], v226 offset:41472
  ds_read_b64_tr_b16 v[240:241], v246 offset:8192
  ds_read_b64_tr_b16 v[242:243], v246 offset:8704
  v_add_f32 v209, 0x358637bd, v209
  v_add_f32 v210, 0x358637bd, v210
  v_mfma_f32_32x32x16_bf16 v[96:111], v[196:199], a[48:51], v[96:111]
  v_add_f32 v211, 0x358637bd, v211
  v_add_f32 v208, v208, v212
  v_add_f32 v209, v209, v213
  v_add_f32 v210, v210, v214
  v_add_f32 v211, v211, v215
  v_cvt_pk_bf16_f32 v2, v208, v209
  v_mfma_f32_32x32x16_bf16 v[112:127], v[196:199], a[52:55], v[112:127]
  ds_read_b64_tr_b16 v[196:197], v227 offset:40960
  ds_read_b64_tr_b16 v[198:199], v227 offset:41472
  s_add_u32 s62, s65, 32768
  s_waitcnt lgkmcnt(2)
  buffer_store_dwordx4 v[240:243], v224, s[32:35], s62 offen sc1
  v_cvt_pk_bf16_f32 v3, v210, v211
  v_min_f32 v212, 0, v8
  v_min_f32 v213, 0, v9
  v_mfma_f32_32x32x16_bf16 v[64:79], v[200:203], a[56:59], v[64:79]
  s_waitcnt vmcnt(13)
  v_cmp_le_u32 vcc, 4, v252
  s_nop 1
  s_cmp_eq_u64 vcc, exec
  s_cbranch_scc1 L_ok_1
  s_mov_b32 s82, 0
L_spin_2:
  buffer_load_dword v252, v244, s[40:43], 0 offen sc1
  s_add_u32 s82, s82, 1
  s_waitcnt vmcnt(0)
  v_cmp_le_u32 vcc, 4, v252
  s_nop 4
  s_cmp_ge_u32 s82, 0x40000
  s_cbranch_scc1 L_ok_1
  s_cmp_eq_u64 vcc, exec
  s_cbranch_scc0 L_spin_2
L_ok_1:
  v_min_f32 v214, 0, v10
  v_min_f32 v215, 0, v11
  v_max_f32 v208, 0, v8
  v_mfma_f32_32x32x16_bf16 v[80:95], v[200:203], a[60:63], v[80:95]
  ds_read_b64_tr_b16 v[200:201], v226 offset:43008
  ds_read_b64_tr_b16 v[202:203], v226 offset:43520
  v_max_f32 v209, 0, v9
  v_max_f32 v210, 0, v10
  v_max_f32 v211, 0, v11
  v_mul_f32 v212, 0x3fb8aa3b, v212
  v_mfma_f32_32x32x16_bf16 v[96:111], v[204:207], a[56:59], v[96:111]
  v_mul_f32 v213, 0x3fb8aa3b, v213
  v_mul_f32 v214, 0x3fb8aa3b, v214
  v_mul_f32 v215, 0x3fb8aa3b, v215
  v_exp_f32 v212, v212
  v_mfma_f32_32x32x16_bf16 v[112:127], v[204:207], a[60:63], v[112:127]
  ds_read_b64_tr_b16 v[204:205], v227 offset:43008
  ds_read_b64_tr_b16 v[206:207], v227 offset:43520
  v_exp_f32 v213, v213
  v_exp_f32 v214, v214
  v_mfma_f32_32x32x16_bf16 v[64:79], v[192:195], a[64:67], v[64:79]
  v_exp_f32 v215, v215
  v_add_f32 v208, 0x358637bd, v208
  v_add_f32 v209, 0x358637bd, v209
  v_add_f32 v210, 0x358637bd, v210
  v_add_f32 v211, 0x358637bd, v211
  v_add_f32 v208, v208, v212
  v_mfma_f32_32x32x16_bf16 v[80:95], v[192:195], a[68:71], v[80:95]
  ds_read_b64_tr_b16 v[192:193], v226 offset:45056
  ds_read_b64_tr_b16 v[194:195], v226 offset:45568
  v_add_f32 v209, v209, v213
  v_add_f32 v210, v210, v214
  v_add_f32 v211, v211, v215
  v_cvt_pk_bf16_f32 v4, v208, v209
  v_cvt_pk_bf16_f32 v5, v210, v211
  s_waitcnt lgkmcnt(6)
  v_mfma_f32_32x32x16_bf16 v[96:111], v[196:199], a[64:67], v[96:111]
  v_min_f32 v212, 0, v12
  v_min_f32 v213, 0, v13
  v_min_f32 v214, 0, v14
  v_min_f32 v215, 0, v15
  v_max_f32 v208, 0, v12
  v_max_f32 v209, 0, v13
  v_mfma_f32_32x32x16_bf16 v[112:127], v[196:199], a[68:71], v[112:127]
  ds_read_b64_tr_b16 v[196:197], v227 offset:45056
  ds_read_b64_tr_b16 v[198:199], v227 offset:45568
  v_max_f32 v210, 0, v14
  v_max_f32 v211, 0, v15
  v_mul_f32 v212, 0x3fb8aa3b, v212
  v_mul_f32 v213, 0x3fb8aa3b, v213
  s_waitcnt lgkmcnt(6)
  v_mfma_f32_32x32x16_bf16 v[64:79], v[200:203], a[72:75], v[64:79]
  v_mul_f32 v214, 0x3fb8aa3b, v214
  v_mul_f32 v215, 0x3fb8aa3b, v215
  v_exp_f32 v212, v212
  v_exp_f32 v213, v213
  v_mfma_f32_32x32x16_bf16 v[80:95], v[200:203], a[76:79], v[80:95]
  ds_read_b64_tr_b16 v[200:201], v226 offset:47104
  ds_read_b64_tr_b16 v[202:203], v226 offset:47616
  v_exp_f32 v214, v214
  v_exp_f32 v215, v215
  s_waitcnt lgkmcnt(6)
  v_mfma_f32_32x32x16_bf16 v[96:111], v[204:207], a[72:75], v[96:111]
  v_add_f32 v208, 0x358637bd, v208
  v_add_f32 v209, 0x358637bd, v209
  v_add_f32 v210, 0x358637bd, v210
  v_add_f32 v211, 0x358637bd, v211
  v_add_f32 v208, v208, v212
  v_add_f32 v209, v209, v213
  v_mfma_f32_32x32x16_bf16 v[112:127], v[204:207], a[76:79], v[112:127]
  ds_read_b64_tr_b16 v[204:205], v227 offset:47104
  ds_read_b64_tr_b16 v[206:207], v227 offset:47616
  v_add_f32 v210, v210, v214
  v_add_f32 v211, v211, v215
  v_cvt_pk_bf16_f32 v6, v208, v209
  v_cvt_pk_bf16_f32 v7, v210, v211
  s_waitcnt lgkmcnt(6)
  v_mfma_f32_32x32x16_bf16 v[64:79], v[192:195], a[80:83], v[64:79]
  s_mov_b64 exec, s[86:87]
  ds_write_b64 v247, v[0:1] offset:0
  ds_write_b64 v247, v[2:3] offset:16
  ds_write_b64 v247, v[4:5] offset:32
  ds_write_b64 v247, v[6:7] offset:48
  s_mov_b64 exec, -1
  v_mov_b32 v8, 0x3f803f80
  v_mfma_f32_32x32x16_bf16 v[80:95], v[192:195], a[84:87], v[80:95]
  s_waitcnt vmcnt(12)
  s_barrier
  ds_read_b64_tr_b16 v[192:193], v226 offset:49152
  ds_read_b64_tr_b16 v[194:195], v226 offset:49664
  s_add_u32 m0, s57, 24576
  s_add_u32 s62, s56, 884864
  buffer_load_dwordx4 v225, s[12:15], s62 offen lds
  s_waitcnt lgkmcnt(10)
  v_mfma_f32_32x32x16_bf16 v[96:111], v[196:199], a[80:83], v[96:111]
  s_add_u32 m0, s57, 25600
  s_add_u32 s62, s56, 958592
  buffer_load_dwordx4 v225, s[12:15], s62 offen lds
  v_mov_b32 v9, 0x3f803f80
  v_mov_b32 v10, 0x3f803f80
  v_mov_b32 v11, 0x3f803f80
  v_mfma_f32_32x32x16_bf16 v[112:127], v[196:199], a[84:87], v[112:127]
  ds_read_b64_tr_b16 v[196:197], v227 offset:49152
  ds_read_b64_tr_b16 v[198:199], v227 offset:49664
  s_add_u32 m0, s57, 26624
  s_add_u32 s62, s56, 1032320
  buffer_load_dwordx4 v225, s[12:15], s62 offen lds
  v_min_f32 v212, 0, v32
  s_waitcnt lgkmcnt(10)
  v_mfma_f32_32x32x16_bf16 v[64:79], v[200:203], a[88:91], v[64:79]
  s_lshl_b32 s45, s50, 2
  s_add_u32 s45, s45, s71
  s_mov_b64 exec, 1
  buffer_store_dword v251, off, s[20:23], s45 sc1
  s_mov_b64 exec, -1
  v_min_f32 v213, 0, v33
  v_mfma_f32_32x32x16_bf16 v[80:95], v[200:203], a[92:95], v[80:95]
  ds_read_b64_tr_b16 v[200:201], v226 offset:51200
  ds_read_b64_tr_b16 v[202:203], v226 offset:51712
  v_min_f32 v214, 0, v34
  v_min_f32 v215, 0, v35
  v_max_f32 v208, 0, v32
  v_max_f32 v209, 0, v33
  s_waitcnt lgkmcnt(10)
  v_mfma_f32_32x32x16_bf16 v[96:111], v[204:207], a[88:91], v[96:111]
  v_max_f32 v210, 0, v34
  v_max_f32 v211, 0, v35
  v_mul_f32 v212, 0x3fb8aa3b, v212
  v_mul_f32 v213, 0x3fb8aa3b, v213
  v_mul_f32 v214, 0x3fb8aa3b, v214
  v_mul_f32 v215, 0x3fb8aa3b, v215
  v_mfma_f32_32x32x16_bf16 v[112:127], v[204:207], a[92:95], v[112:127]
  ds_read_b64_tr_b16 v[204:205], v227 offset:51200
  ds_read_b64_tr_b16 v[206:207], v227 offset:51712
  v_exp_f32 v212, v212
  v_exp_f32 v213, v213
  s_waitcnt lgkmcnt(6)
  v_mfma_f32_32x32x16_bf16 v[64:79], v[192:195], a[96:99], v[64:79]
  v_exp_f32 v214, v214
  v_exp_f32 v215, v215
  v_add_f32 v208, 0x358637bd, v208
  v_add_f32 v209, 0x358637bd, v209
  v_add_f32 v210, 0x358637bd, v210
  v_mfma_f32_32x32x16_bf16 v[80:95], v[192:195], a[100:103], v[80:95]
  ds_read_b64_tr_b16 v[192:193], v226 offset:53248
  ds_read_b64_tr_b16 v[194:195], v226 offset:53760
  v_add_f32 v211, 0x358637bd, v211
  v_add_f32 v208, v208, v212
  v_add_f32 v209, v209, v213
  v_add_f32 v210, v210, v214
  s_waitcnt lgkmcnt(6)
  v_mfma_f32_32x32x16_bf16 v[96:111], v[196:199], a[96:99], v[96:111]
  v_add_f32 v211, v211, v215
  v_cvt_pk_bf16_f32 v216, v208, v209
  v_cvt_pk_bf16_f32 v217, v210, v211
  v_cvt_pk_bf16_f32 v32, v32, v33
  v_cvt_pk_bf16_f32 v33, v34, v35
  v_cndmask_b32 v216, v216, v32, s[98:99]
  v_mfma_f32_32x32x16_bf16 v[112:127], v[196:199], a[100:103], v[112:127]
  ds_read_b64_tr_b16 v[196:197], v227 offset:53248
  ds_read_b64_tr_b16 v[198:199], v227 offset:53760
  v_cndmask_b32 v217, v217, v33, s[98:99]
  v_min_f32 v212, 0, v36
  v_min_f32 v213, 0, v37
  v_min_f32 v214, 0, v38
  s_waitcnt lgkmcnt(6)
  v_mfma_f32_32x32x16_bf16 v[64:79], v[200:203], a[104:107], v[64:79]
  v_min_f32 v215, 0, v39
  v_max_f32 v208, 0, v36
  v_max_f32 v209, 0, v37
  v_max_f32 v210, 0, v38
  v_max_f32 v211, 0, v39
  v_mul_f32 v212, 0x3fb8aa3b, v212
  v_mfma_f32_32x32x16_bf16 v[80:95], v[200:203], a[108:111], v[80:95]
  ds_read_b64_tr_b16 v[200:201], v226 offset:55296
  ds_read_b64_tr_b16 v[202:203], v226 offset:55808
  v_mul_f32 v213, 0x3fb8aa3b, v213
  v_mul_f32 v214, 0x3fb8aa3b, v214
  v_mul_f32 v215, 0x3fb8aa3b, v215
  v_exp_f32 v212, v212
  s_waitcnt lgkmcnt(6)
  v_mfma_f32_32x32x16_bf16 v[96:111], v[204:207], a[104:107], v[96:111]
  v_exp_f32 v213, v213
  v_exp_f32 v214, v214
  v_exp_f32 v215, v215
  v_mfma_f32_32x32x16_bf16 v[112:127], v[204:207], a[108:111], v[112:127]
  ds_read_b64_tr_b16 v[204:205], v227 offset:55296
  ds_read_b64_tr_b16 v[206:207], v227 offset:55808
  v_add_f32 v208, 0x358637bd, v208
  v_add_f32 v209, 0x358637bd, v209
  v_add_f32 v210, 0x358637bd, v210
  v_add_f32 v211, 0x358637bd, v211
  s_waitcnt lgkmcnt(6)
  v_mfma_f32_32x32x16_bf16 v[64:79], v[192:195], a[112:115], v[64:79]
  v_add_f32 v208, v208, v212
  v_add_f32 v209, v209, v213
  v_add_f32 v210, v210, v214
  v_add_f32 v211, v211, v215
  v_cvt_pk_bf16_f32 v218, v208, v209
  v_cvt_pk_bf16_f32 v219, v210, v211
  v_mfma_f32_32x32x16_bf16 v[80:95], v[192:195], a[116:119], v[80:95]
  ds_read_b64_tr_b16 v[192:193], v226 offset:57344
  ds_read_b64_tr_b16 v[194:195], v226 offset:57856
  v_cvt_pk_bf16_f32 v34, v36, v37
  v_cvt_pk_bf16_f32 v35, v38, v39
  v_cndmask_b32 v218, v218, v34, s[98:99]
  v_cndmask_b32 v219, v219, v35, s[98:99]
  s_waitcnt lgkmcnt(6)
  v_mfma_f32_32x32x16_bf16 v[96:111], v[196:199], a[112:115], v[96:111]
  v_min_f32 v212, 0, v40
  v_min_f32 v213, 0, v41
  v_min_f32 v214, 0, v42
  v_min_f32 v215, 0, v43
  v_max_f32 v208, 0, v40
  v_max_f32 v209, 0, v41
  v_mfma_f32_32x32x16_bf16 v[112:127], v[196:199], a[116:119], v[112:127]
  ds_read_b64_tr_b16 v[196:197], v227 offset:57344
  ds_read_b64_tr_b16 v[198:199], v227 offset:57856
  v_max_f32 v210, 0, v42
  v_max_f32 v211, 0, v43
  v_mul_f32 v212, 0x3fb8aa3b, v212
  v_mul_f32 v213, 0x3fb8aa3b, v213
  s_waitcnt lgkmcnt(6)
  v_mfma_f32_32x32x16_bf16 v[64:79], v[200:203], a[120:123], v[64:79]
  v_mul_f32 v214, 0x3fb8aa3b, v214
  v_mul_f32 v215, 0x3fb8aa3b, v215
  v_exp_f32 v212, v212
  v_exp_f32 v213, v213
  v_mfma_f32_32x32x16_bf16 v[80:95], v[200:203], a[124:127], v[80:95]
  ds_read_b64_tr_b16 v[200:201], v226 offset:59392
  ds_read_b64_tr_b16 v[202:203], v226 offset:59904
  v_exp_f32 v214, v214
  v_exp_f32 v215, v215
  v_add_f32 v208, 0x358637bd, v208
  s_waitcnt lgkmcnt(6)
  v_mfma_f32_32x32x16_bf16 v[96:111], v[204:207], a[120:123], v[96:111]
  v_add_f32 v209, 0x358637bd, v209
  v_add_f32 v210, 0x358637bd, v210
  v_add_f32 v211, 0x358637bd, v211
  v_add_f32 v208, v208, v212
  v_add_f32 v209, v209, v213
  v_add_f32 v210, v210, v214
  v_mfma_f32_32x32x16_bf16 v[112:127], v[204:207], a[124:127], v[112:127]
  ds_read_b64_tr_b16 v[204:205], v227 offset:59392
  ds_read_b64_tr_b16 v[206:207], v227 offset:59904
  v_add_f32 v211, v211, v215
  v_cvt_pk_bf16_f32 v220, v208, v209
  v_cvt_pk_bf16_f32 v221, v210, v211
  v_cvt_pk_bf16_f32 v36, v40, v41
  s_waitcnt lgkmcnt(6)
  v_mfma_f32_32x32x16_bf16 v[64:79], v[192:195], a[128:131], v[64:79]
  v_cvt_pk_bf16_f32 v37, v42, v43
  v_cndmask_b32 v220, v220, v36, s[98:99]
  v_cndmask_b32 v221, v221, v37, s[98:99]
  v_min_f32 v212, 0, v44
  v_min_f32 v213, 0, v45
  v_min_f32 v214, 0, v46
  v_mfma_f32_32x32x16_bf16 v[80:95], v[192:195], a[132:135], v[80:95]
  s_barrier
  ds_read_b64_tr_b16 v[192:193], v226 offset:0
  ds_read_b64_tr_b16 v[194:195], v226 offset:512
  s_add_u32 m0, s57, 36864
  s_add_u32 s62, s56, 1769600
  buffer_load_dwordx4 v225, s[12:15], s62 offen lds
  s_waitcnt lgkmcnt(6)
  v_mfma_f32_32x32x16_bf16 v[96:111], v[196:199], a[128:131], v[96:111]
  s_add_u32 m0, s57, 37888
  s_add_u32 s62, s56, 1843328
  buffer_load_dwordx4 v225, s[12:15], s62 offen lds
  v_min_f32 v215, 0, v47
  v_max_f32 v208, 0, v44
  v_max_f32 v209, 0, v45
  v_mfma_f32_32x32x16_bf16 v[112:127], v[196:199], a[132:135], v[112:127]
  ds_read_b64_tr_b16 v[196:197], v227 offset:0
  ds_read_b64_tr_b16 v[198:199], v227 offset:512
  s_add_u32 m0, s57, 38912
  s_add_u32 s62, s56, 1917056
  buffer_load_dwordx4 v225, s[12:15], s62 offen lds
  v_max_f32 v210, 0, v46
  v_max_f32 v211, 0, v47
  s_waitcnt lgkmcnt(6)
  v_mfma_f32_32x32x16_bf16 v[64:79], v[200:203], a[136:139], v[64:79]
  v_mul_f32 v212, 0x3fb8aa3b, v212
  v_mul_f32 v213, 0x3fb8aa3b, v213
  v_mul_f32 v214, 0x3fb8aa3b, v214
  v_mul_f32 v215, 0x3fb8aa3b, v215
  v_exp_f32 v212, v212
  v_mfma_f32_32x32x16_bf16 v[80:95], v[200:203], a[140:143], v[80:95]
  ds_read_b64_tr_b16 v[200:201], v226 offset:2048
  ds_read_b64_tr_b16 v[202:203], v226 offset:2560
  v_exp_f32 v213, v213
  v_exp_f32 v214, v214
  s_waitcnt lgkmcnt(6)
  v_mfma_f32_32x32x16_bf16 v[96:111], v[204:207], a[136:139], v[96:111]
  v_exp_f32 v215, v215
  v_add_f32 v208, 0x358637bd, v208
  v_add_f32 v209, 0x358637bd, v209
  v_add_f32 v210, 0x358637bd, v210
  v_add_f32 v211, 0x358637bd, v211
  v_mfma_f32_32x32x16_bf16 v[112:127], v[204:207], a[140:143], v[112:127]
  ds_read_b64_tr_b16 v[204:205], v227 offset:2048
  ds_read_b64_tr_b16 v[206:207], v227 offset:2560
  v_add_f32 v208, v208, v212
  v_add_f32 v209, v209, v213
  v_add_f32 v210, v210, v214
  v_add_f32 v211, v211, v215
  s_waitcnt lgkmcnt(6)
  v_mfma_f32_32x32x16_bf16 v[64:79], v[192:195], a[144:147], v[64:79]
  v_cvt_pk_bf16_f32 v222, v208, v209
  v_cvt_pk_bf16_f32 v223, v210, v211
  v_cvt_pk_bf16_f32 v38, v44, v45
  v_cvt_pk_bf16_f32 v39, v46, v47
  v_cndmask_b32 v222, v222, v38, s[98:99]
  v_cndmask_b32 v223, v223, v39, s[98:99]
  v_mfma_f32_32x32x16_bf16 v[80:95], v[192:195], a[148:151], v[80:95]
  ds_read_b64_tr_b16 v[192:193], v226 offset:4096
  ds_read_b64_tr_b16 v[194:195], v226 offset:4608
  s_waitcnt lgkmcnt(6)
  v_mfma_f32_32x32x16_bf16 v[96:111], v[196:199], a[144:147], v[96:111]
  s_mov_b64 exec, s[88:89]
  ds_write_b64 v236, v[216:217] offset:0
  ds_write_b64 v236, v[218:219] offset:16
  ds_write_b64 v236, v[220:221] offset:32
  ds_write_b64 v236, v[222:223] offset:48
  s_mov_b64 exec, -1
  v_mfma_f32_32x32x16_bf16 v[128:143], v[0:3], v[32:35], 0
  v_mfma_f32_32x32x16_bf16 v[144:159], v[0:3], v[8:11], 0
  v_mfma_f32_32x32x16_bf16 v[112:127], v[196:199], a[148:151], v[112:127]
  ds_read_b64_tr_b16 v[196:197], v227 offset:4096
  ds_read_b64_tr_b16 v[198:199], v227 offset:4608
  v_mfma_f32_32x32x16_bf16 v[128:143], v[4:7], v[36:39], v[128:143]
  v_mfma_f32_32x32x16_bf16 v[144:159], v[4:7], v[8:11], v[144:159]
  v_min_f32 v212, 0, v16
  s_waitcnt lgkmcnt(10)
  v_mfma_f32_32x32x16_bf16 v[64:79], v[200:203], a[152:155], v[64:79]
  v_min_f32 v213, 0, v17
  v_min_f32 v214, 0, v18
  v_min_f32 v215, 0, v19
  v_max_f32 v208, 0, v16
  v_max_f32 v209, 0, v17
  v_max_f32 v210, 0, v18
  v_mfma_f32_32x32x16_bf16 v[80:95], v[200:203], a[156:159], v[80:95]
  ds_read_b64_tr_b16 v[200:201], v226 offset:6144
  ds_read_b64_tr_b16 v[202:203], v226 offset:6656
  v_max_f32 v211, 0, v19
  v_mul_f32 v212, 0x3fb8aa3b, v212
  v_mul_f32 v213, 0x3fb8aa3b, v213
  v_mul_f32 v214, 0x3fb8aa3b, v214
  s_waitcnt lgkmcnt(10)
  v_mfma_f32_32x32x16_bf16 v[96:111], v[204:207], a[152:155], v[96:111]
  v_mul_f32 v215, 0x3fb8aa3b, v215
  v_exp_f32 v212, v212
  v_exp_f32 v213, v213
  v_mfma_f32_32x32x16_bf16 v[112:127], v[204:207], a[156:159], v[112:127]
  ds_read_b64_tr_b16 v[204:205], v227 offset:6144
  ds_read_b64_tr_b16 v[206:207], v227 offset:6656
  v_exp_f32 v214, v214
  v_exp_f32 v215, v215
  v_add_f32 v208, 0x358637bd, v208
  s_waitcnt lgkmcnt(10)
  v_mfma_f32_32x32x16_bf16 v[64:79], v[192:195], a[160:163], v[64:79]
  v_add_f32 v209, 0x358637bd, v209
  v_add_f32 v210, 0x358637bd, v210
  v_add_f32 v211, 0x358637bd, v211
  v_add_f32 v208, v208, v212
  v_add_f32 v209, v209, v213
  v_add_f32 v210, v210, v214
  v_add_f32 v211, v211, v215
  v_mfma_f32_32x32x16_bf16 v[80:95], v[192:195], a[164:167], v[80:95]
  ds_read_b64_tr_b16 v[192:193], v226 offset:8192
  ds_read_b64_tr_b16 v[194:195], v226 offset:8704
  v_cvt_pk_bf16_f32 v16, v208, v209
  v_cvt_pk_bf16_f32 v17, v210, v211
  v_min_f32 v212, 0, v20
  v_min_f32 v213, 0, v21
  s_waitcnt lgkmcnt(6)
  v_mfma_f32_32x32x16_bf16 v[96:111], v[196:199], a[160:163], v[96:111]
  v_min_f32 v214, 0, v22
  v_min_f32 v215, 0, v23
  v_max_f32 v208, 0, v20
  v_max_f32 v209, 0, v21
  v_max_f32 v210, 0, v22
  v_max_f32 v211, 0, v23
  v_mfma_f32_32x32x16_bf16 v[112:127], v[196:199], a[164:167], v[112:127]
  ds_read_b64_tr_b16 v[196:197], v227 offset:8192
  ds_read_b64_tr_b16 v[198:199], v227 offset:8704
  v_mul_f32 v212, 0x3fb8aa3b, v212
  v_mul_f32 v213, 0x3fb8aa3b, v213
  v_mul_f32 v214, 0x3fb8aa3b, v214
  v_mul_f32 v215, 0x3fb8aa3b, v215
  s_waitcnt lgkmcnt(6)
  v_mfma_f32_32x32x16_bf16 v[64:79], v[200:203], a[168:171], v[64:79]
  v_exp_f32 v212, v212
  v_exp_f32 v213, v213
  v_exp_f32 v214, v214
  v_mfma_f32_32x32x16_bf16 v[80:95], v[200:203], a[172:175], v[80:95]
  ds_read_b64_tr_b16 v[200:201], v226 offset:10240
  ds_read_b64_tr_b16 v[202:203], v226 offset:10752
  v_exp_f32 v215, v215
  v_add_f32 v208, 0x358637bd, v208
  v_add_f32 v209, 0x358637bd, v209
  s_waitcnt lgkmcnt(6)
  v_mfma_f32_32x32x16_bf16 v[96:111], v[204:207], a[168:171], v[96:111]
  v_add_f32 v210, 0x358637bd, v210
  v_add_f32 v211, 0x358637bd, v211
  v_add_f32 v208, v208, v212
  v_add_f32 v209, v209, v213
  v_add_f32 v210, v210, v214
  v_add_f32 v211, v211, v215
  v_mfma_f32_32x32x16_bf16 v[112:127], v[204:207], a[172:175], v[112:127]
  ds_read_b64_tr_b16 v[204:205], v227 offset:10240
  ds_read_b64_tr_b16 v[206:207], v227 offset:10752
  v_cvt_pk_bf16_f32 v18, v208, v209
  v_cvt_pk_bf16_f32 v19, v210, v211
  v_min_f32 v212, 0, v24
  v_min_f32 v213, 0, v25
  v_min_f32 v214, 0, v26
  s_waitcnt lgkmcnt(6)
  v_mfma_f32_32x32x16_bf16 v[64:79], v[192:195], a[176:179], v[64:79]
  v_min_f32 v215, 0, v27
  v_max_f32 v208, 0, v24
  v_max_f32 v209, 0, v25
  v_max_f32 v210, 0, v26
  v_max_f32 v211, 0, v27
  v_mul_f32 v212, 0x3fb8aa3b, v212
  v_mfma_f32_32x32x16_bf16 v[80:95], v[192:195], a[180:183], v[80:95]
  s_waitcnt vmcnt(7)
  s_barrier
  ds_read_b64_tr_b16 v[192:193], v253 offset:0
  ds_read_b64_tr_b16 v[194:195], v253 offset:512
  s_add_u32 m0, s57, 49152
  s_add_u32 s62, s56, 2654336
  buffer_load_dwordx4 v225, s[12:15], s62 offen lds
  s_waitcnt lgkmcnt(6)
  v_mfma_f32_32x32x16_bf16 v[96:111], v[196:199], a[176:179], v[96:111]
  s_add_u32 m0, s57, 50176
  s_add_u32 s62, s56, 2728064
  buffer_load_dwordx4 v225, s[12:15], s62 offen lds
  v_mul_f32 v213, 0x3fb8aa3b, v213
  v_mul_f32 v214, 0x3fb8aa3b, v214
  v_mul_f32 v215, 0x3fb8aa3b, v215
  v_mfma_f32_32x32x16_bf16 v[112:127], v[196:199], a[180:183], v[112:127]
  ds_read_b64_tr_b16 v[196:197], v254 offset:0
  ds_read_b64_tr_b16 v[198:199], v254 offset:512
  s_add_u32 m0, s57, 51200
  s_add_u32 s62, s56, 2801792
  buffer_load_dwordx4 v225, s[12:15], s62 offen lds
  s_waitcnt lgkmcnt(6)
  v_mfma_f32_32x32x16_bf16 v[64:79], v[200:203], a[184:187], v[64:79]
  s_mov_b64 exec, 1
  buffer_store_dword v251, off, s[32:35], s84 sc1
  s_mov_b64 exec, -1
  v_exp_f32 v212, v212
  v_exp_f32 v213, v213
  v_mfma_f32_32x32x16_bf16 v[80:95], v[200:203], a[188:191], v[80:95]
  ds_read_b64_tr_b16 v[200:201], v253 offset:2048
  ds_read_b64_tr_b16 v[202:203], v253 offset:2560
  v_exp_f32 v214, v214
  v_exp_f32 v215, v215
  v_add_f32 v208, 0x358637bd, v208
  s_waitcnt lgkmcnt(6)
  v_mfma_f32_32x32x16_bf16 v[96:111], v[204:207], a[184:187], v[96:111]
  v_add_f32 v209, 0x358637bd, v209
  v_add_f32 v210, 0x358637bd, v210
  v_add_f32 v211, 0x358637bd, v211
  v_add_f32 v208, v208, v212
  v_add_f32 v209, v209, v213
  v_add_f32 v210, v210, v214
  v_mfma_f32_32x32x16_bf16 v[112:127], v[204:207], a[188:191], v[112:127]
  ds_read_b64_tr_b16 v[204:205], v254 offset:2048
  ds_read_b64_tr_b16 v[206:207], v254 offset:2560
  v_add_f32 v211, v211, v215
  v_cvt_pk_bf16_f32 v20, v208, v209
  v_cvt_pk_bf16_f32 v21, v210, v211
  v_min_f32 v212, 0, v28
  s_waitcnt lgkmcnt(6)
  v_mfma_f32_32x32x16_bf16 v[64:79], v[192:195], a[192:195], v[64:79]
  v_min_f32 v213, 0, v29
  v_min_f32 v214, 0, v30
  v_min_f32 v215, 0, v31
  v_max_f32 v208, 0, v28
  v_max_f32 v209, 0, v29
  v_max_f32 v210, 0, v30
  v_mfma_f32_32x32x16_bf16 v[80:95], v[192:195], a[196:199], v[80:95]
  ds_read_b64_tr_b16 v[192:193], v253 offset:4096
  ds_read_b64_tr_b16 v[194:195], v253 offset:4608
  v_max_f32 v211, 0, v31
  v_mul_f32 v212, 0x3fb8aa3b, v212
  v_mul_f32 v213, 0x3fb8aa3b, v213
  v_mul_f32 v214, 0x3fb8aa3b, v214
  s_waitcnt lgkmcnt(6)
  v_mfma_f32_32x32x16_bf16 v[96:111], v[196:199], a[192:195], v[96:111]
  v_mul_f32 v215, 0x3fb8aa3b, v215
  v_exp_f32 v212, v212
  v_exp_f32 v213, v213
  v_mfma_f32_32x32x16_bf16 v[112:127], v[196:199], a[196:199], v[112:127]
  ds_read_b64_tr_b16 v[196:197], v254 offset:4096
  ds_read_b64_tr_b16 v[198:199], v254 offset:4608
  v_exp_f32 v214, v214
  v_exp_f32 v215, v215
  v_add_f32 v208, 0x358637bd, v208
  s_waitcnt lgkmcnt(6)
  v_mfma_f32_32x32x16_bf16 v[64:79], v[200:203], a[200:203], v[64:79]
  v_add_f32 v209, 0x358637bd, v209
  v_add_f32 v210, 0x358637bd, v210
  v_add_f32 v211, 0x358637bd, v211
  v_add_f32 v208, v208, v212
  v_add_f32 v209, v209, v213
  v_add_f32 v210, v210, v214
  v_add_f32 v211, v211, v215
  v_mfma_f32_32x32x16_bf16 v[80:95], v[200:203], a[204:207], v[80:95]
  ds_read_b64_tr_b16 v[200:201], v253 offset:6144
  ds_read_b64_tr_b16 v[202:203], v253 offset:6656
  v_cvt_pk_bf16_f32 v22, v208, v209
  v_cvt_pk_bf16_f32 v23, v210, v211
  s_waitcnt lgkmcnt(6)
  v_mfma_f32_32x32x16_bf16 v[96:111], v[204:207], a[200:203], v[96:111]
  s_mov_b64 exec, s[86:87]
  ds_write_b64 v247, v[16:17] offset:64
  ds_write_b64 v247, v[18:19] offset:80
  ds_write_b64 v247, v[20:21] offset:96
  ds_write_b64 v247, v[22:23] offset:112
  s_mov_b64 exec, -1
  v_min_f32 v212, 0, v48
  v_min_f32 v213, 0, v49
  v_mfma_f32_32x32x16_bf16 v[112:127], v[204:207], a[204:207], v[112:127]
  ds_read_b64_tr_b16 v[204:205], v254 offset:6144
  ds_read_b64_tr_b16 v[206:207], v254 offset:6656
  v_min_f32 v214, 0, v50
  v_min_f32 v215, 0, v51
  v_max_f32 v208, 0, v48
  v_max_f32 v209, 0, v49
  s_waitcnt lgkmcnt(10)
  v_mfma_f32_32x32x16_bf16 v[64:79], v[192:195], a[208:211], v[64:79]
  v_max_f32 v210, 0, v50
  v_max_f32 v211, 0, v51
  v_mul_f32 v212, 0x3fb8aa3b, v212
  v_mul_f32 v213, 0x3fb8aa3b, v213
  v_mul_f32 v214, 0x3fb8aa3b, v214
  v_mul_f32 v215, 0x3fb8aa3b, v215
  v_mfma_f32_32x32x16_bf16 v[80:95], v[192:195], a[212:215], v[80:95]
  ds_read_b64_tr_b16 v[192:193], v253 offset:8192
  ds_read_b64_tr_b16 v[194:195], v253 offset:8704
  v_exp_f32 v212, v212
  v_exp_f32 v213, v213
  s_waitcnt lgkmcnt(10)
  v_mfma_f32_32x32x16_bf16 v[96:111], v[196:199], a[208:211], v[96:111]
  v_exp_f32 v214, v214
  v_exp_f32 v215, v215
  v_add_f32 v208, 0x358637bd, v208
  v_add_f32 v209, 0x358637bd, v209
  v_mfma_f32_32x32x16_bf16 v[112:127], v[196:199], a[212:215], v[112:127]
  ds_read_b64_tr_b16 v[196:197], v254 offset:8192
  ds_read_b64_tr_b16 v[198:199], v254 offset:8704
  v_add_f32 v210, 0x358637bd, v210
  v_add_f32 v211, 0x358637bd, v211
  v_add_f32 v208, v208, v212
  v_add_f32 v209, v209, v213
  v_add_f32 v210, v210, v214
  s_waitcnt lgkmcnt(10)
  v_mfma_f32_32x32x16_bf16 v[64:79], v[200:203], a[216:219], v[64:79]
  v_add_f32 v211, v211, v215
  v_cvt_pk_bf16_f32 v216, v208, v209
  v_cvt_pk_bf16_f32 v217, v210, v211
  v_cvt_pk_bf16_f32 v48, v48, v49
  v_cvt_pk_bf16_f32 v49, v50, v51
  v_cndmask_b32 v216, v216, v48, s[98:99]
  v_mfma_f32_32x32x16_bf16 v[80:95], v[200:203], a[220:223], v[80:95]
  ds_read_b64_tr_b16 v[200:201], v253 offset:10240
  ds_read_b64_tr_b16 v[202:203], v253 offset:10752
  v_cndmask_b32 v217, v217, v49, s[98:99]
  v_min_f32 v212, 0, v52
  v_min_f32 v213, 0, v53
  v_min_f32 v214, 0, v54
  s_waitcnt lgkmcnt(6)
  v_mfma_f32_32x32x16_bf16 v[96:111], v[204:207], a[216:219], v[96:111]
  v_min_f32 v215, 0, v55
  v_max_f32 v208, 0, v52
  v_max_f32 v209, 0, v53
  v_max_f32 v210, 0, v54
  v_max_f32 v211, 0, v55
  v_mul_f32 v212, 0x3fb8aa3b, v212
  v_mfma_f32_32x32x16_bf16 v[112:127], v[204:207], a[220:223], v[112:127]
  ds_read_b64_tr_b16 v[204:205], v254 offset:10240
  ds_read_b64_tr_b16 v[206:207], v254 offset:10752
  v_mul_f32 v213, 0x3fb8aa3b, v213
  v_mul_f32 v214, 0x3fb8aa3b, v214
  v_mul_f32 v215, 0x3fb8aa3b, v215
  s_waitcnt lgkmcnt(6)
  v_mfma_f32_32x32x16_bf16 v[64:79], v[192:195], a[224:227], v[64:79]
  v_exp_f32 v212, v212
  v_exp_f32 v213, v213
  v_exp_f32 v214, v214
  v_mfma_f32_32x32x16_bf16 v[80:95], v[192:195], a[228:231], v[80:95]
  s_barrier
  ds_read_b64_tr_b16 v[192:193], v253 offset:12288
  ds_read_b64_tr_b16 v[194:195], v253 offset:12800
  s_add_u32 m0, s57, 0
  s_add_u32 s62, s56, 3539072
  buffer_load_dwordx4 v225, s[12:15], s62 offen lds
  v_exp_f32 v215, v215
  s_waitcnt lgkmcnt(6)
  v_mfma_f32_32x32x16_bf16 v[96:111], v[196:199], a[224:227], v[96:111]
  s_add_u32 m0, s57, 1024
  s_add_u32 s62, s56, 3612800
  buffer_load_dwordx4 v225, s[12:15], s62 offen lds
  v_add_f32 v208, 0x358637bd, v208
  v_add_f32 v209, 0x358637bd, v209
  v_add_f32 v210, 0x358637bd, v210
  v_mfma_f32_32x32x16_bf16 v[112:127], v[196:199], a[228:231], v[112:127]
  ds_read_b64_tr_b16 v[196:197], v254 offset:12288
  ds_read_b64_tr_b16 v[198:199], v254 offset:12800
  s_add_u32 m0, s57, 2048
  s_add_u32 s62, s56, 3686528
  buffer_load_dwordx4 v225, s[12:15], s62 offen lds
  v_add_f32 v211, 0x358637bd, v211
  s_waitcnt lgkmcnt(6)
  v_mfma_f32_32x32x16_bf16 v[64:79], v[200:203], a[232:235], v[64:79]
  v_add_f32 v208, v208, v212
  v_add_f32 v209, v209, v213
  v_add_f32 v210, v210, v214
  v_add_f32 v211, v211, v215
  v_cvt_pk_bf16_f32 v218, v208, v209
  v_cvt_pk_bf16_f32 v219, v210, v211
  v_mfma_f32_32x32x16_bf16 v[80:95], v[200:203], a[236:239], v[80:95]
  ds_read_b64_tr_b16 v[200:201], v253 offset:14336
  ds_read_b64_tr_b16 v[202:203], v253 offset:14848
  v_cvt_pk_bf16_f32 v50, v52, v53
  v_cvt_pk_bf16_f32 v51, v54, v55
  v_cndmask_b32 v218, v218, v50, s[98:99]
  v_cndmask_b32 v219, v219, v51, s[98:99]
  s_waitcnt lgkmcnt(6)
  v_mfma_f32_32x32x16_bf16 v[96:111], v[204:207], a[232:235], v[96:111]
  v_min_f32 v212, 0, v56
  v_min_f32 v213, 0, v57
  v_min_f32 v214, 0, v58
  v_min_f32 v215, 0, v59
  v_max_f32 v208, 0, v56
  v_max_f32 v209, 0, v57
  v_mfma_f32_32x32x16_bf16 v[112:127], v[204:207], a[236:239], v[112:127]
  ds_read_b64_tr_b16 v[204:205], v254 offset:14336
  ds_read_b64_tr_b16 v[206:207], v254 offset:14848
  v_max_f32 v210, 0, v58
  v_max_f32 v211, 0, v59
  v_mul_f32 v212, 0x3fb8aa3b, v212
  v_mul_f32 v213, 0x3fb8aa3b, v213
  s_waitcnt lgkmcnt(6)
  v_mfma_f32_32x32x16_bf16 v[64:79], v[192:195], a[240:243], v[64:79]
  v_mul_f32 v214, 0x3fb8aa3b, v214
  v_mul_f32 v215, 0x3fb8aa3b, v215
  v_exp_f32 v212, v212
  v_exp_f32 v213, v213
  v_mfma_f32_32x32x16_bf16 v[80:95], v[192:195], a[244:247], v[80:95]
  ds_read_b64_tr_b16 v[192:193], v253 offset:16384
  ds_read_b64_tr_b16 v[194:195], v253 offset:16896
  v_exp_f32 v214, v214
  v_exp_f32 v215, v215
  v_add_f32 v208, 0x358637bd, v208
  s_waitcnt lgkmcnt(6)
  v_mfma_f32_32x32x16_bf16 v[96:111], v[196:199], a[240:243], v[96:111]
  v_add_f32 v209, 0x358637bd, v209
  v_add_f32 v210, 0x358637bd, v210
  v_add_f32 v211, 0x358637bd, v211
  v_add_f32 v208, v208, v212
  v_add_f32 v209, v209, v213
  v_add_f32 v210, v210, v214
  v_mfma_f32_32x32x16_bf16 v[112:127], v[196:199], a[244:247], v[112:127]
  ds_read_b64_tr_b16 v[196:197], v254 offset:16384
  ds_read_b64_tr_b16 v[198:199], v254 offset:16896
  v_add_f32 v211, v211, v215
  v_cvt_pk_bf16_f32 v220, v208, v209
  v_cvt_pk_bf16_f32 v221, v210, v211
  v_cvt_pk_bf16_f32 v52, v56, v57
  s_waitcnt lgkmcnt(6)
  v_mfma_f32_32x32x16_bf16 v[64:79], v[200:203], a[248:251], v[64:79]
  v_cvt_pk_bf16_f32 v53, v58, v59
  v_cndmask_b32 v220, v220, v52, s[98:99]
  v_cndmask_b32 v221, v221, v53, s[98:99]
  v_min_f32 v212, 0, v60
  v_min_f32 v213, 0, v61
  v_min_f32 v214, 0, v62
  v_mfma_f32_32x32x16_bf16 v[80:95], v[200:203], a[252:255], v[80:95]
  ds_read_b64_tr_b16 v[200:201], v253 offset:18432
  ds_read_b64_tr_b16 v[202:203], v253 offset:18944
  v_min_f32 v215, 0, v63
  v_max_f32 v208, 0, v60
  v_max_f32 v209, 0, v61
  v_max_f32 v210, 0, v62
  s_waitcnt lgkmcnt(6)
  v_mfma_f32_32x32x16_bf16 v[96:111], v[204:207], a[248:251], v[96:111]
  v_max_f32 v211, 0, v63
  v_mul_f32 v212, 0x3fb8aa3b, v212
  v_mul_f32 v213, 0x3fb8aa3b, v213
  v_mul_f32 v214, 0x3fb8aa3b, v214
  v_mul_f32 v215, 0x3fb8aa3b, v215
  v_mfma_f32_32x32x16_bf16 v[112:127], v[204:207], a[252:255], v[112:127]
  ds_read_b64_tr_b16 v[204:205], v254 offset:18432
  ds_read_b64_tr_b16 v[206:207], v254 offset:18944
  v_exp_f32 v212, v212
  v_exp_f32 v213, v213
  v_exp_f32 v214, v214
  s_waitcnt lgkmcnt(6)
  v_mfma_f32_32x32x16_bf16 v[64:79], v[192:195], v[160:163], v[64:79]
  v_exp_f32 v215, v215
  v_add_f32 v208, 0x358637bd, v208
  v_add_f32 v209, 0x358637bd, v209
  v_add_f32 v210, 0x358637bd, v210
  v_add_f32 v211, 0x358637bd, v211
  v_mfma_f32_32x32x16_bf16 v[80:95], v[192:195], v[164:167], v[80:95]
  ds_read_b64_tr_b16 v[192:193], v253 offset:20480
  ds_read_b64_tr_b16 v[194:195], v253 offset:20992
  v_add_f32 v208, v208, v212
  v_add_f32 v209, v209, v213
  v_add_f32 v210, v210, v214
  v_add_f32 v211, v211, v215
  s_waitcnt lgkmcnt(6)
  v_mfma_f32_32x32x16_bf16 v[96:111], v[196:199], v[160:163], v[96:111]
  v_cvt_pk_bf16_f32 v222, v208, v209
  v_cvt_pk_bf16_f32 v223, v210, v211
  v_cvt_pk_bf16_f32 v54, v60, v61
  v_cvt_pk_bf16_f32 v55, v62, v63
  v_cndmask_b32 v222, v222, v54, s[98:99]
  v_cndmask_b32 v223, v223, v55, s[98:99]
  v_mfma_f32_32x32x16_bf16 v[112:127], v[196:199], v[164:167], v[112:127]
  ds_read_b64_tr_b16 v[196:197], v254 offset:20480
  ds_read_b64_tr_b16 v[198:199], v254 offset:20992
  s_waitcnt lgkmcnt(6)
  v_mfma_f32_32x32x16_bf16 v[64:79], v[200:203], v[168:171], v[64:79]
  s_mov_b64 exec, s[88:89]
  ds_write_b64 v236, v[216:217] offset:64
  ds_write_b64 v236, v[218:219] offset:80
  ds_write_b64 v236, v[220:221] offset:96
  ds_write_b64 v236, v[222:223] offset:112
  s_mov_b64 exec, -1
  v_mfma_f32_32x32x16_bf16 v[128:143], v[16:19], v[48:51], v[128:143]
  v_mfma_f32_32x32x16_bf16 v[144:159], v[16:19], v[8:11], v[144:159]
  v_mfma_f32_32x32x16_bf16 v[80:95], v[200:203], v[172:175], v[80:95]
  ds_read_b64_tr_b16 v[200:201], v253 offset:22528
  ds_read_b64_tr_b16 v[202:203], v253 offset:23040
  v_mfma_f32_32x32x16_bf16 v[128:143], v[20:23], v[52:55], v[128:143]
  v_mfma_f32_32x32x16_bf16 v[144:159], v[20:23], v[8:11], v[144:159]
  s_waitcnt lgkmcnt(10)
  v_mfma_f32_32x32x16_bf16 v[96:111], v[204:207], v[168:171], v[96:111]
  s_lshl_b32 s63, s3, 7
  s_add_u32 s63, s63, 62464
  v_lshlrev_b32 v236, 1, v249
  v_add_u32 v236, s63, v236
  ds_read_u16 v221, v236
  s_waitcnt lgkmcnt(0)
  v_lshlrev_b32 v221, 16, v221
  v_mul_f32 v221, 0xbfb8aa3b, v221
  v_mfma_f32_32x32x16_bf16 v[112:127], v[204:207], v[172:175], v[112:127]
  ds_read_b64_tr_b16 v[204:205], v254 offset:22528
  ds_read_b64_tr_b16 v[206:207], v254 offset:23040
  v_exp_f32 v221, v221
  s_nop 0
  v_add_f32 v221, 1.0, v221
  v_mfma_f32_32x32x16_bf16 v[64:79], v[192:195], v[176:179], v[64:79]
  v_rcp_f32 v221, v221
  ds_write_b32 v237, v221
  v_cndmask_b32 v128, v128, v144, s[90:91]
  v_cndmask_b32 v129, v129, v145, s[90:91]
  v_cndmask_b32 v130, v130, v146, s[90:91]
  v_cndmask_b32 v131, v131, v147, s[90:91]
  v_mfma_f32_32x32x16_bf16 v[80:95], v[192:195], v[180:183], v[80:95]
  s_barrier
  ds_read_b64_tr_b16 v[192:193], v226 offset:12288
  ds_read_b64_tr_b16 v[194:195], v226 offset:12800
  s_add_u32 m0, s57, 65536
  s_add_u32 s62, s56, 4423808
  buffer_load_dwordx4 v225, s[12:15], s62 offen lds
  v_mfma_f32_32x32x16_bf16 v[96:111], v[196:199], v[176:179], v[96:111]
  s_add_u32 m0, s57, 66560
  s_add_u32 s62, s56, 4497536
  buffer_load_dwordx4 v225, s[12:15], s62 offen lds
  v_cndmask_b32 v132, v132, v148, s[90:91]
  v_cndmask_b32 v133, v133, v149, s[90:91]
  v_cndmask_b32 v134, v134, v150, s[90:91]
  v_mfma_f32_32x32x16_bf16 v[112:127], v[196:199], v[180:183], v[112:127]
  ds_read_b64_tr_b16 v[196:197], v227 offset:12288
  ds_read_b64_tr_b16 v[198:199], v227 offset:12800
  s_add_u32 m0, s57, 67584
  s_add_u32 s62, s56, 4571264
  buffer_load_dwordx4 v225, s[12:15], s62 offen lds
  v_cndmask_b32 v135, v135, v151, s[90:91]
  v_mfma_f32_32x32x16_bf16 v[64:79], v[200:203], v[184:187], v[64:79]
  s_mul_i32 s62, s3, 9216
  s_add_u32 s4, s62, 90112
  s_mov_b32 s5, s62
  s_add_u32 s7, s62, 126976
  v_cndmask_b32 v136, v136, v152, s[90:91]
  v_cndmask_b32 v137, v137, v153, s[90:91]
  v_cndmask_b32 v138, v138, v154, s[90:91]
  v_mfma_f32_32x32x16_bf16 v[80:95], v[200:203], v[188:191], v[80:95]
  ds_read_b64_tr_b16 v[200:201], v226 offset:14336
  ds_read_b64_tr_b16 v[202:203], v226 offset:14848
  s_cmp_ge_u32 s3, 2
  s_cselect_b32 s6, 7168, 0
  s_add_u32 s6, s6, s5
  s_add_u32 s6, s6, 36864
  s_waitcnt lgkmcnt(7)
  v_mfma_f32_32x32x16_bf16 v[96:111], v[204:207], v[184:187], v[96:111]
  s_mul_i32 s62, s3, 36864
  s_add_u32 s79, s79, s62
  v_cndmask_b32 v139, v139, v155, s[90:91]
  ds_write_b128 v238, v[128:131] offset:0
  ds_write_b128 v238, v[132:135] offset:1024
  ds_write_b128 v238, v[136:139] offset:2048
  v_mfma_f32_32x32x16_bf16 v[112:127], v[204:207], v[188:191], v[112:127]
  ds_read_b64_tr_b16 v[204:205], v227 offset:14336
  ds_read_b64_tr_b16 v[206:207], v227 offset:14848
  v_min_u32 v240, 41, v249
  v_lshrrev_b32 v241, 5, v240
  v_and_b32 v240, 31, v240
  v_lshlrev_b32 v240, 2, v240
  s_waitcnt lgkmcnt(9)
  v_mfma_f32_32x32x16_bf16 v[0:15], v[192:195], a[0:3], 0
  v_lshl_add_u32 v240, v241, 9, v240
  v_and_b32 v241, 7, v249
  v_lshlrev_b32 v241, 2, v241
  v_mfma_f32_32x32x16_bf16 v[16:31], v[192:195], a[4:7], 0
  ds_read_b64_tr_b16 v[192:193], v226 offset:16384
  ds_read_b64_tr_b16 v[194:195], v226 offset:16896
  s_waitcnt lgkmcnt(9)
  v_mfma_f32_32x32x16_bf16 v[32:47], v[196:199], a[0:3], 0
  v_mfma_f32_32x32x16_bf16 v[48:63], v[196:199], a[4:7], 0
  ds_read_b64_tr_b16 v[196:197], v227 offset:16384
  ds_read_b64_tr_b16 v[198:199], v227 offset:16896
  s_waitcnt lgkmcnt(9)
  v_mfma_f32_32x32x16_bf16 v[0:15], v[200:203], a[8:11], v[0:15]
  v_mfma_f32_32x32x16_bf16 v[16:31], v[200:203], a[12:15], v[16:31]
  ds_read_b64_tr_b16 v[200:201], v226 offset:18432
  ds_read_b64_tr_b16 v[202:203], v226 offset:18944
  s_waitcnt lgkmcnt(6)
  v_mfma_f32_32x32x16_bf16 v[32:47], v[204:207], a[8:11], v[32:47]
  v_mul_f32 v208, 0xbfb8aa3b, v96
  v_mul_f32 v209, 0xbfb8aa3b, v97
  v_mul_f32 v210, 0xbfb8aa3b, v98
  v_mul_f32 v211, 0xbfb8aa3b, v99
  v_mfma_f32_32x32x16_bf16 v[48:63], v[204:207], a[12:15], v[48:63]
  ds_read_b64_tr_b16 v[204:205], v227 offset:18432
  ds_read_b64_tr_b16 v[206:207], v227 offset:18944
  v_exp_f32 v208, v208
  v_exp_f32 v209, v209
  s_waitcnt lgkmcnt(6)
  v_mfma_f32_32x32x16_bf16 v[0:15], v[192:195], a[16:19], v[0:15]
  v_exp_f32 v210, v210
  v_exp_f32 v211, v211
  v_add_f32 v208, 1.0, v208
  v_mfma_f32_32x32x16_bf16 v[16:31], v[192:195], a[20:23], v[16:31]
  ds_read_b64_tr_b16 v[192:193], v226 offset:20480
  ds_read_b64_tr_b16 v[194:195], v226 offset:20992
  v_add_f32 v209, 1.0, v209
  v_add_f32 v210, 1.0, v210
  v_add_f32 v211, 1.0, v211
  s_waitcnt lgkmcnt(6)
  v_mfma_f32_32x32x16_bf16 v[32:47], v[196:199], a[16:19], v[32:47]
  v_rcp_f32 v208, v208
  v_rcp_f32 v209, v209
  v_mfma_f32_32x32x16_bf16 v[48:63], v[196:199], a[20:23], v[48:63]
  ds_read_b64_tr_b16 v[196:197], v227 offset:20480
  ds_read_b64_tr_b16 v[198:199], v227 offset:20992
  v_rcp_f32 v210, v210
  v_rcp_f32 v211, v211
  s_waitcnt lgkmcnt(6)
  v_mfma_f32_32x32x16_bf16 v[0:15], v[200:203], a[24:27], v[0:15]
  v_mul_f32 v208, v96, v208
  v_mul_f32 v209, v97, v209
  v_mul_f32 v210, v98, v210
  v_mul_f32 v211, v99, v211
  v_cvt_pk_bf16_f32 v144, v208, v209
  v_mfma_f32_32x32x16_bf16 v[16:31], v[200:203], a[28:31], v[16:31]
  ds_read_b64_tr_b16 v[200:201], v226 offset:22528
  ds_read_b64_tr_b16 v[202:203], v226 offset:23040
  v_cvt_pk_bf16_f32 v145, v210, v211
  v_mul_f32 v212, 0xbfb8aa3b, v100
  v_mul_f32 v213, 0xbfb8aa3b, v101
  s_waitcnt lgkmcnt(6)
  v_mfma_f32_32x32x16_bf16 v[32:47], v[204:207], a[24:27], v[32:47]
  v_mul_f32 v214, 0xbfb8aa3b, v102
  v_mul_f32 v215, 0xbfb8aa3b, v103
  v_exp_f32 v212, v212
  v_mfma_f32_32x32x16_bf16 v[48:63], v[204:207], a[28:31], v[48:63]
  ds_read_b64_tr_b16 v[204:205], v227 offset:22528
  ds_read_b64_tr_b16 v[206:207], v227 offset:23040
  v_exp_f32 v213, v213
  v_exp_f32 v214, v214
  s_waitcnt lgkmcnt(6)
  v_mfma_f32_32x32x16_bf16 v[0:15], v[192:195], a[32:35], v[0:15]
  v_exp_f32 v215, v215
  v_add_f32 v212, 1.0, v212
  v_add_f32 v213, 1.0, v213
  v_add_f32 v214, 1.0, v214
  v_mfma_f32_32x32x16_bf16 v[16:31], v[192:195], a[36:39], v[16:31]
  s_waitcnt vmcnt(14)
  s_barrier
  ds_read_b64_tr_b16 v[192:193], v226 offset:24576
  ds_read_b64_tr_b16 v[194:195], v226 offset:25088
  s_add_u32 m0, s57, 77824
  s_add_u32 s62, s60, 0
  buffer_load_dwordx4 v232, s[24:27], s62 offen lds
  s_waitcnt lgkmcnt(6)
  v_mfma_f32_32x32x16_bf16 v[32:47], v[196:199], a[32:35], v[32:47]
  s_add_u32 m0, s57, 78848
  s_add_u32 s62, s60, 294912
  buffer_load_dwordx4 v232, s[24:27], s62 offen lds
  v_add_f32 v215, 1.0, v215
  v_mfma_f32_32x32x16_bf16 v[48:63], v[196:199], a[36:39], v[48:63]
  ds_read_b64_tr_b16 v[196:197], v227 offset:24576
  ds_read_b64_tr_b16 v[198:199], v227 offset:25088
  s_add_u32 m0, s57, 79872
  s_add_u32 s62, s60, 589824
  buffer_load_dwordx4 v232, s[24:27], s62 offen lds
  v_rcp_f32 v212, v212
  s_waitcnt lgkmcnt(6)
  v_mfma_f32_32x32x16_bf16 v[0:15], v[200:203], a[40:43], v[0:15]
  s_min_u32 s62, s3, 2
  s_lshl_b32 s62, s62, 10
  s_add_u32 s62, s62, 145408
  v_add_u32 v239, s62, v224
  v_rcp_f32 v213, v213
  v_mfma_f32_32x32x16_bf16 v[16:31], v[200:203], a[44:47], v[16:31]
  ds_read_b64_tr_b16 v[200:201], v226 offset:26624
  ds_read_b64_tr_b16 v[202:203], v226 offset:27136
  ds_read_b128 v[216:219], v239
  ds_read_b128 v[220:223], v239 offset:3072
  s_waitcnt lgkmcnt(8)
  v_mfma_f32_32x32x16_bf16 v[32:47], v[204:207], a[40:43], v[32:47]
  v_rcp_f32 v214, v214
  v_rcp_f32 v215, v215
  v_mul_f32 v212, v100, v212
  v_mul_f32 v213, v101, v213
  v_mfma_f32_32x32x16_bf16 v[48:63], v[204:207], a[44:47], v[48:63]
  ds_read_b64_tr_b16 v[204:205], v227 offset:26624
  ds_read_b64_tr_b16 v[206:207], v227 offset:27136
  v_mul_f32 v214, v102, v214
  v_mul_f32 v215, v103, v215
  v_cvt_pk_bf16_f32 v146, v212, v213
  s_waitcnt lgkmcnt(8)
  v_mfma_f32_32x32x16_bf16 v[0:15], v[192:195], a[48:51], v[0:15]
  s_waitcnt lgkmcnt(2)
  v_add_f32 v216, v216, v220
  v_add_f32 v217, v217, v221
  v_add_f32 v218, v218, v222
  v_add_f32 v219, v219, v223
  v_cvt_pk_bf16_f32 v147, v214, v215
  v_mul_f32 v208, 0xbfb8aa3b, v104
  v_mfma_f32_32x32x16_bf16 v[16:31], v[192:195], a[52:55], v[16:31]
  ds_read_b64_tr_b16 v[192:193], v226 offset:28672
  ds_read_b64_tr_b16 v[194:195], v226 offset:29184
  ds_read_b128 v[220:223], v239 offset:6144
  v_mul_f32 v209, 0xbfb8aa3b, v105
  v_mul_f32 v210, 0xbfb8aa3b, v106
  v_mfma_f32_32x32x16_bf16 v[32:47], v[196:199], a[48:51], v[32:47]
  v_mul_f32 v211, 0xbfb8aa3b, v107
  v_exp_f32 v208, v208
  v_exp_f32 v209, v209
  v_mfma_f32_32x32x16_bf16 v[48:63], v[196:199], a[52:55], v[48:63]
  ds_read_b64_tr_b16 v[196:197], v227 offset:28672
  ds_read_b64_tr_b16 v[198:199], v227 offset:29184
  v_exp_f32 v210, v210
  v_mfma_f32_32x32x16_bf16 v[0:15], v[200:203], a[56:59], v[0:15]
  s_waitcnt lgkmcnt(2)
  v_add_f32 v216, v216, v220
  v_add_f32 v217, v217, v221
  v_add_f32 v218, v218, v222
  v_add_f32 v219, v219, v223
  v_exp_f32 v211, v211
  v_add_f32 v208, 1.0, v208
  v_mfma_f32_32x32x16_bf16 v[16:31], v[200:203], a[60:63], v[16:31]
  ds_read_b64_tr_b16 v[200:201], v226 offset:30720
  ds_read_b64_tr_b16 v[202:203], v226 offset:31232
  ds_read_b128 v[220:223], v239 offset:9216
  v_add_f32 v209, 1.0, v209
  v_add_f32 v210, 1.0, v210
  v_mfma_f32_32x32x16_bf16 v[32:47], v[204:207], a[56:59], v[32:47]
  v_add_f32 v211, 1.0, v211
  v_rcp_f32 v208, v208
  v_rcp_f32 v209, v209
  v_mfma_f32_32x32x16_bf16 v[48:63], v[204:207], a[60:63], v[48:63]
  ds_read_b64_tr_b16 v[204:205], v227 offset:30720
  ds_read_b64_tr_b16 v[206:207], v227 offset:31232
  v_rcp_f32 v210, v210
  v_mfma_f32_32x32x16_bf16 v[0:15], v[192:195], a[64:67], v[0:15]
  s_waitcnt lgkmcnt(2)
  v_add_f32 v216, v216, v220
  v_add_f32 v217, v217, v221
  v_add_f32 v218, v218, v222
  v_add_f32 v219, v219, v223
  v_rcp_f32 v211, v211
  v_mul_f32 v208, v104, v208
  v_mfma_f32_32x32x16_bf16 v[16:31], v[192:195], a[68:71], v[16:31]
  ds_read_b64_tr_b16 v[192:193], v226 offset:32768
  ds_read_b64_tr_b16 v[194:195], v226 offset:33280
  buffer_store_dwordx4 v[216:219], v224, s[20:23], s74 offen sc1
  v_mul_f32 v209, v105, v209
  v_mul_f32 v210, v106, v210
  v_mfma_f32_32x32x16_bf16 v[32:47], v[196:199], a[64:67], v[32:47]
  buffer_load_dword v243, v241, s[20:23], s71 offen sc1
  v_mul_f32 v211, v107, v211
  v_cvt_pk_bf16_f32 v148, v208, v209
  v_cvt_pk_bf16_f32 v149, v210, v211
  v_mul_f32 v212, 0xbfb8aa3b, v108
  v_mfma_f32_32x32x16_bf16 v[48:63], v[196:199], a[68:71], v[48:63]
  ds_read_b64_tr_b16 v[196:197], v227 offset:32768
  ds_read_b64_tr_b16 v[198:199], v227 offset:33280
  v_mul_f32 v213, 0xbfb8aa3b, v109
  v_mul_f32 v214, 0xbfb8aa3b, v110
  v_mul_f32 v215, 0xbfb8aa3b, v111
  v_mfma_f32_32x32x16_bf16 v[0:15], v[200:203], a[72:75], v[0:15]
  v_exp_f32 v212, v212
  v_exp_f32 v213, v213
  v_mfma_f32_32x32x16_bf16 v[16:31], v[200:203], a[76:79], v[16:31]
  ds_read_b64_tr_b16 v[200:201], v226 offset:34816
  ds_read_b64_tr_b16 v[202:203], v226 offset:35328
  v_exp_f32 v214, v214
  v_exp_f32 v215, v215
  v_add_f32 v212, 1.0, v212
  s_waitcnt lgkmcnt(6)
  v_mfma_f32_32x32x16_bf16 v[32:47], v[204:207], a[72:75], v[32:47]
  v_add_f32 v213, 1.0, v213
  v_add_f32 v214, 1.0, v214
  v_add_f32 v215, 1.0, v215
  v_mfma_f32_32x32x16_bf16 v[48:63], v[204:207], a[76:79], v[48:63]
  ds_read_b64_tr_b16 v[204:205], v227 offset:34816
  ds_read_b64_tr_b16 v[206:207], v227 offset:35328
  v_rcp_f32 v212, v212
  v_rcp_f32 v213, v213
  s_waitcnt lgkmcnt(6)
  v_mfma_f32_32x32x16_bf16 v[0:15], v[192:195], a[80:83], v[0:15]
  v_rcp_f32 v214, v214
  v_rcp_f32 v215, v215
  v_mul_f32 v212, v108, v212
  v_mfma_f32_32x32x16_bf16 v[16:31], v[192:195], a[84:87], v[16:31]
  s_waitcnt vmcnt(15)
  s_barrier
  ds_read_b64_tr_b16 v[192:193], v226 offset:36864
  ds_read_b64_tr_b16 v[194:195], v226 offset:37376
  v_mul_f32 v213, v109, v213
  v_mul_f32 v214, v110, v214
  v_mul_f32 v215, v111, v215
  s_waitcnt lgkmcnt(6)
  v_mfma_f32_32x32x16_bf16 v[32:47], v[196:199], a[80:83], v[32:47]
  v_cvt_pk_bf16_f32 v150, v212, v213
  v_cvt_pk_bf16_f32 v151, v214, v215
  v_mul_f32 v208, 0xbfb8aa3b, v112
  v_mul_f32 v209, 0xbfb8aa3b, v113
  v_mul_f32 v210, 0xbfb8aa3b, v114
  v_mfma_f32_32x32x16_bf16 v[48:63], v[196:199], a[84:87], v[48:63]
  ds_read_b64_tr_b16 v[196:197], v227 offset:36864
  ds_read_b64_tr_b16 v[198:199], v227 offset:37376
  v_mul_f32 v211, 0xbfb8aa3b, v115
  v_exp_f32 v208, v208
  s_waitcnt lgkmcnt(6)
  v_mfma_f32_32x32x16_bf16 v[0:15], v[200:203], a[88:91], v[0:15]
  v_exp_f32 v209, v209
  v_exp_f32 v210, v210
  v_mfma_f32_32x32x16_bf16 v[16:31], v[200:203], a[92:95], v[16:31]
  ds_read_b64_tr_b16 v[200:201], v226 offset:38912
  ds_read_b64_tr_b16 v[202:203], v226 offset:39424
  v_exp_f32 v211, v211
  v_add_f32 v208, 1.0, v208
  v_add_f32 v209, 1.0, v209
  s_waitcnt lgkmcnt(6)
  v_mfma_f32_32x32x16_bf16 v[32:47], v[204:207], a[88:91], v[32:47]
  v_add_f32 v210, 1.0, v210
  v_add_f32 v211, 1.0, v211
  v_rcp_f32 v208, v208
  v_mfma_f32_32x32x16_bf16 v[48:63], v[204:207], a[92:95], v[48:63]
  ds_read_b64_tr_b16 v[204:205], v227 offset:38912
  ds_read_b64_tr_b16 v[206:207], v227 offset:39424
  v_rcp_f32 v209, v209
  v_rcp_f32 v210, v210
  s_waitcnt lgkmcnt(6)
  v_mfma_f32_32x32x16_bf16 v[0:15], v[192:195], a[96:99], v[0:15]
  v_rcp_f32 v211, v211
  v_mul_f32 v208, v112, v208
  v_mul_f32 v209, v113, v209
  v_mul_f32 v210, v114, v210
  v_mfma_f32_32x32x16_bf16 v[16:31], v[192:195], a[100:103], v[16:31]
  ds_read_b64_tr_b16 v[192:193], v226 offset:40960
  ds_read_b64_tr_b16 v[194:195], v226 offset:41472
  v_mul_f32 v211, v115, v211
  v_cvt_pk_bf16_f32 v152, v208, v209
  v_cvt_pk_bf16_f32 v153, v210, v211
  s_waitcnt lgkmcnt(6)
  v_mfma_f32_32x32x16_bf16 v[32:47], v[196:199], a[96:99], v[32:47]
  v_mul_f32 v212, 0xbfb8aa3b, v116
  v_mul_f32 v213, 0xbfb8aa3b, v117
  v_mul_f32 v214, 0xbfb8aa3b, v118
  v_mul_f32 v215, 0xbfb8aa3b, v119
  v_mfma_f32_32x32x16_bf16 v[48:63], v[196:199], a[100:103], v[48:63]
  ds_read_b64_tr_b16 v[196:197], v227 offset:40960
  ds_read_b64_tr_b16 v[198:199], v227 offset:41472
  v_exp_f32 v212, v212
  v_exp_f32 v213, v213
  s_waitcnt lgkmcnt(6)
  v_mfma_f32_32x32x16_bf16 v[0:15], v[200:203], a[104:107], v[0:15]
  v_exp_f32 v214, v214
  v_exp_f32 v215, v215
  v_add_f32 v212, 1.0, v212
  v_mfma_f32_32x32x16_bf16 v[16:31], v[200:203], a[108:111], v[16:31]
  ds_read_b64_tr_b16 v[200:201], v226 offset:43008
  ds_read_b64_tr_b16 v[202:203], v226 offset:43520
  v_add_f32 v213, 1.0, v213
  v_add_f32 v214, 1.0, v214
  v_add_f32 v215, 1.0, v215
  s_waitcnt lgkmcnt(6)
  v_mfma_f32_32x32x16_bf16 v[32:47], v[204:207], a[104:107], v[32:47]
  v_rcp_f32 v212, v212
  v_rcp_f32 v213, v213
  v_mfma_f32_32x32x16_bf16 v[48:63], v[204:207], a[108:111], v[48:63]
  ds_read_b64_tr_b16 v[204:205], v227 offset:43008
  ds_read_b64_tr_b16 v[206:207], v227 offset:43520
  v_rcp_f32 v214, v214
  v_rcp_f32 v215, v215
  s_waitcnt lgkmcnt(6)
  v_mfma_f32_32x32x16_bf16 v[0:15], v[192:195], a[112:115], v[0:15]
  v_mul_f32 v212, v116, v212
  v_mul_f32 v213, v117, v213
  v_mul_f32 v214, v118, v214
  v_mul_f32 v215, v119, v215
  v_cvt_pk_bf16_f32 v154, v212, v213
  v_mfma_f32_32x32x16_bf16 v[16:31], v[192:195], a[116:119], v[16:31]
  ds_read_b64_tr_b16 v[192:193], v226 offset:45056
  ds_read_b64_tr_b16 v[194:195], v226 offset:45568
  v_cvt_pk_bf16_f32 v155, v214, v215
  v_mul_f32 v208, 0xbfb8aa3b, v120
  v_mul_f32 v209, 0xbfb8aa3b, v121
  s_waitcnt lgkmcnt(6)
  v_mfma_f32_32x32x16_bf16 v[32:47], v[196:199], a[112:115], v[32:47]
  v_mul_f32 v210, 0xbfb8aa3b, v122
  v_mul_f32 v211, 0xbfb8aa3b, v123
  v_exp_f32 v208, v208
  v_mfma_f32_32x32x16_bf16 v[48:63], v[196:199], a[116:119], v[48:63]
  ds_read_b64_tr_b16 v[196:197], v227 offset:45056
  ds_read_b64_tr_b16 v[198:199], v227 offset:45568
  v_exp_f32 v209, v209
  v_exp_f32 v210, v210
  s_waitcnt lgkmcnt(6)
  v_mfma_f32_32x32x16_bf16 v[0:15], v[200:203], a[120:123], v[0:15]
  v_exp_f32 v211, v211
  v_add_f32 v208, 1.0, v208
  v_add_f32 v209, 1.0, v209
  v_add_f32 v210, 1.0, v210
  v_mfma_f32_32x32x16_bf16 v[16:31], v[200:203], a[124:127], v[16:31]
  ds_read_b64_tr_b16 v[200:201], v226 offset:47104
  ds_read_b64_tr_b16 v[202:203], v226 offset:47616
  v_add_f32 v211, 1.0, v211
  v_rcp_f32 v208, v208
  s_waitcnt lgkmcnt(6)
  v_mfma_f32_32x32x16_bf16 v[32:47], v[204:207], a[120:123], v[32:47]
  v_rcp_f32 v209, v209
  v_rcp_f32 v210, v210
  v_mfma_f32_32x32x16_bf16 v[48:63], v[204:207], a[124:127], v[48:63]
  ds_read_b64_tr_b16 v[204:205], v227 offset:47104
  ds_read_b64_tr_b16 v[206:207], v227 offset:47616
  v_rcp_f32 v211, v211
  v_mul_f32 v208, v120, v208
  v_mul_f32 v209, v121, v209
  s_waitcnt lgkmcnt(6)
  v_mfma_f32_32x32x16_bf16 v[0:15], v[192:195], a[128:131], v[0:15]
  v_mul_f32 v210, v122, v210
  v_mul_f32 v211, v123, v211
  v_cvt_pk_bf16_f32 v156, v208, v209
  v_cvt_pk_bf16_f32 v157, v210, v211
  v_mul_f32 v212, 0xbfb8aa3b, v124
  v_mfma_f32_32x32x16_bf16 v[16:31], v[192:195], a[132:135], v[16:31]
  s_waitcnt vmcnt(1)
  s_barrier
  ds_read_b64_tr_b16 v[192:193], v226 offset:49152
  ds_read_b64_tr_b16 v[194:195], v226 offset:49664
  buffer_load_dword v252, v240, s[20:23], s72 offen sc1
  v_mul_f32 v213, 0xbfb8aa3b, v125
  s_waitcnt lgkmcnt(6)
  v_mfma_f32_32x32x16_bf16 v[32:47], v[196:199], a[128:131], v[32:47]
  s_lshl_b32 s45, s49, 2
  s_add_u32 s45, s45, s70
  s_mov_b64 exec, 1
  buffer_store_dword v251, off, s[20:23], s45 sc1
  s_mov_b64 exec, -1
  v_mul_f32 v214, 0xbfb8aa3b, v126
  v_mfma_f32_32x32x16_bf16 v[48:63], v[196:199], a[132:135], v[48:63]
  ds_read_b64_tr_b16 v[196:197], v227 offset:49152
  ds_read_b64_tr_b16 v[198:199], v227 offset:49664
  v_mul_f32 v215, 0xbfb8aa3b, v127
  v_exp_f32 v212, v212
  s_waitcnt lgkmcnt(6)
  v_mfma_f32_32x32x16_bf16 v[0:15], v[200:203], a[136:139], v[0:15]
  v_exp_f32 v213, v213
  v_exp_f32 v214, v214
  v_mfma_f32_32x32x16_bf16 v[16:31], v[200:203], a[140:143], v[16:31]
  ds_read_b64_tr_b16 v[200:201], v226 offset:51200
  ds_read_b64_tr_b16 v[202:203], v226 offset:51712
  v_exp_f32 v215, v215
  v_add_f32 v212, 1.0, v212
  v_add_f32 v213, 1.0, v213
  s_waitcnt lgkmcnt(6)
  v_mfma_f32_32x32x16_bf16 v[32:47], v[204:207], a[136:139], v[32:47]
  v_add_f32 v214, 1.0, v214
  v_add_f32 v215, 1.0, v215
  v_rcp_f32 v212, v212
  v_mfma_f32_32x32x16_bf16 v[48:63], v[204:207], a[140:143], v[48:63]
  ds_read_b64_tr_b16 v[204:205], v227 offset:51200
  ds_read_b64_tr_b16 v[206:207], v227 offset:51712
  v_rcp_f32 v213, v213
  v_rcp_f32 v214, v214
  s_waitcnt lgkmcnt(6)
  v_mfma_f32_32x32x16_bf16 v[0:15], v[192:195], a[144:147], v[0:15]
  v_rcp_f32 v215, v215
  v_mul_f32 v212, v124, v212
  v_mul_f32 v213, v125, v213
  v_mul_f32 v214, v126, v214
  v_mfma_f32_32x32x16_bf16 v[16:31], v[192:195], a[148:151], v[16:31]
  ds_read_b64_tr_b16 v[192:193], v226 offset:53248
  ds_read_b64_tr_b16 v[194:195], v226 offset:53760
  v_mul_f32 v215, v127, v215
  v_cvt_pk_bf16_f32 v158, v212, v213
  v_cvt_pk_bf16_f32 v159, v214, v215
  s_waitcnt lgkmcnt(6)
  v_mfma_f32_32x32x16_bf16 v[32:47], v[196:199], a[144:147], v[32:47]
  v_mul_f32 v208, 0xbfb8aa3b, v64
  v_mul_f32 v209, 0xbfb8aa3b, v65
  v_mul_f32 v210, 0xbfb8aa3b, v66
  v_mul_f32 v211, 0xbfb8aa3b, v67
  v_mfma_f32_32x32x16_bf16 v[48:63], v[196:199], a[148:151], v[48:63]
  ds_read_b64_tr_b16 v[196:197], v227 offset:53248
  ds_read_b64_tr_b16 v[198:199], v227 offset:53760
  v_exp_f32 v208, v208
  v_exp_f32 v209, v209
  s_waitcnt lgkmcnt(6)
  v_mfma_f32_32x32x16_bf16 v[0:15], v[200:203], a[152:155], v[0:15]
  v_exp_f32 v210, v210
  v_exp_f32 v211, v211
  v_add_f32 v208, 1.0, v208
  v_mfma_f32_32x32x16_bf16 v[16:31], v[200:203], a[156:159], v[16:31]
  ds_read_b64_tr_b16 v[200:201], v226 offset:55296
  ds_read_b64_tr_b16 v[202:203], v226 offset:55808
  v_add_f32 v209, 1.0, v209
  v_add_f32 v210, 1.0, v210
  v_add_f32 v211, 1.0, v211
  s_waitcnt lgkmcnt(6)
  v_mfma_f32_32x32x16_bf16 v[32:47], v[204:207], a[152:155], v[32:47]
  v_rcp_f32 v208, v208
  v_rcp_f32 v209, v209
  v_mfma_f32_32x32x16_bf16 v[48:63], v[204:207], a[156:159], v[48:63]
  ds_read_b64_tr_b16 v[204:205], v227 offset:55296
  ds_read_b64_tr_b16 v[206:207], v227 offset:55808
  v_rcp_f32 v210, v210
  v_rcp_f32 v211, v211
  s_waitcnt lgkmcnt(6)
  v_mfma_f32_32x32x16_bf16 v[0:15], v[192:195], a[160:163], v[0:15]
  v_mul_f32 v208, v64, v208
  v_mul_f32 v209, v65, v209
  v_mul_f32 v210, v66, v210
  v_mul_f32 v211, v67, v211
  v_cvt_pk_bf16_f32 v128, v208, v209
  v_mfma_f32_32x32x16_bf16 v[16:31], v[192:195], a[164:167], v[16:31]
  ds_read_b64_tr_b16 v[192:193], v226 offset:57344
  ds_read_b64_tr_b16 v[194:195], v226 offset:57856
  v_cvt_pk_bf16_f32 v129, v210, v211
  v_mul_f32 v212, 0xbfb8aa3b, v68
  v_mul_f32 v213, 0xbfb8aa3b, v69
  s_waitcnt lgkmcnt(6)
  v_mfma_f32_32x32x16_bf16 v[32:47], v[196:199], a[160:163], v[32:47]
  v_mul_f32 v214, 0xbfb8aa3b, v70
  v_mul_f32 v215, 0xbfb8aa3b, v71
  v_exp_f32 v212, v212
  v_mfma_f32_32x32x16_bf16 v[48:63], v[196:199], a[164:167], v[48:63]
  ds_read_b64_tr_b16 v[196:197], v227 offset:57344
  ds_read_b64_tr_b16 v[198:199], v227 offset:57856
  v_exp_f32 v213, v213
  v_exp_f32 v214, v214
  s_waitcnt lgkmcnt(6)
  v_mfma_f32_32x32x16_bf16 v[0:15], v[200:203], a[168:171], v[0:15]
  v_exp_f32 v215, v215
  v_add_f32 v212, 1.0, v212
  v_add_f32 v213, 1.0, v213
  v_add_f32 v214, 1.0, v214
  v_mfma_f32_32x32x16_bf16 v[16:31], v[200:203], a[172:175], v[16:31]
  ds_read_b64_tr_b16 v[200:201], v226 offset:59392
  ds_read_b64_tr_b16 v[202:203], v226 offset:59904
  v_add_f32 v215, 1.0, v215
  v_rcp_f32 v212, v212
  s_waitcnt lgkmcnt(6)
  v_mfma_f32_32x32x16_bf16 v[32:47], v[204:207], a[168:171], v[32:47]
  v_rcp_f32 v213, v213
  v_rcp_f32 v214, v214
  v_mfma_f32_32x32x16_bf16 v[48:63], v[204:207], a[172:175], v[48:63]
  ds_read_b64_tr_b16 v[204:205], v227 offset:59392
  ds_read_b64_tr_b16 v[206:207], v227 offset:59904
  v_rcp_f32 v215, v215
  v_mul_f32 v212, v68, v212
  v_mul_f32 v213, v69, v213
  s_waitcnt lgkmcnt(6)
  v_mfma_f32_32x32x16_bf16 v[0:15], v[192:195], a[176:179], v[0:15]
  v_mul_f32 v214, v70, v214
  v_mul_f32 v215, v71, v215
  v_cvt_pk_bf16_f32 v130, v212, v213
  v_cvt_pk_bf16_f32 v131, v214, v215
  v_mul_f32 v208, 0xbfb8aa3b, v72
  v_mfma_f32_32x32x16_bf16 v[16:31], v[192:195], a[180:183], v[16:31]
  s_barrier
  ds_read_b64_tr_b16 v[192:193], v226 offset:0
  ds_read_b64_tr_b16 v[194:195], v226 offset:512
  s_add_u32 m0, s57, 36864
  s_add_u32 s62, s60, 1769472
  buffer_load_dwordx4 v232, s[24:27], s62 offen lds
  s_waitcnt lgkmcnt(6)
  v_mfma_f32_32x32x16_bf16 v[32:47], v[196:199], a[176:179], v[32:47]
  s_add_u32 m0, s57, 37888
  s_add_u32 s62, s60, 2064384
  buffer_load_dwordx4 v232, s[24:27], s62 offen lds
  v_mul_f32 v209, 0xbfb8aa3b, v73
  v_mul_f32 v210, 0xbfb8aa3b, v74
  v_mul_f32 v211, 0xbfb8aa3b, v75
  v_mfma_f32_32x32x16_bf16 v[48:63], v[196:199], a[180:183], v[48:63]
  ds_read_b64_tr_b16 v[196:197], v227 offset:0
  ds_read_b64_tr_b16 v[198:199], v227 offset:512
  s_add_u32 m0, s57, 38912
  s_add_u32 s62, s60, 2359296
  buffer_load_dwordx4 v232, s[24:27], s62 offen lds
  s_waitcnt lgkmcnt(6)
  v_mfma_f32_32x32x16_bf16 v[0:15], v[200:203], a[184:187], v[0:15]
  s_waitcnt vmcnt(4)
  v_cmp_eq_u32 vcc, 1, v252
  s_nop 1
  s_cmp_eq_u64 vcc, exec
  s_cbranch_scc1 L_ok_3
  s_mov_b32 s82, 0
L_spin_4:
  buffer_load_dword v252, v240, s[20:23], s72 offen sc1
  s_add_u32 s82, s82, 1
  s_waitcnt vmcnt(0)
  v_cmp_eq_u32 vcc, 1, v252
  s_nop 4
  s_cmp_ge_u32 s82, 0x40000
  s_cbranch_scc1 L_ok_3
  s_cmp_eq_u64 vcc, exec
  s_cbranch_scc0 L_spin_4
L_ok_3:
  v_exp_f32 v208, v208
  v_mfma_f32_32x32x16_bf16 v[16:31], v[200:203], a[188:191], v[16:31]
  ds_read_b64_tr_b16 v[200:201], v226 offset:2048
  ds_read_b64_tr_b16 v[202:203], v226 offset:2560
  s_add_u32 s62, s79, 0
  v_exp_f32 v209, v209
  s_waitcnt lgkmcnt(6)
  v_mfma_f32_32x32x16_bf16 v[32:47], v[204:207], a[184:187], v[32:47]
  s_add_u32 m0, s4, 0
  v_exp_f32 v210, v210
  v_exp_f32 v211, v211
  v_add_f32 v208, 1.0, v208
  v_mfma_f32_32x32x16_bf16 v[48:63], v[204:207], a[188:191], v[48:63]
  ds_read_b64_tr_b16 v[204:205], v227 offset:2048
  ds_read_b64_tr_b16 v[206:207], v227 offset:2560
  buffer_load_dwordx4 v224, s[20:23], s62 offen offset:0 sc1 lds
  v_add_f32 v209, 1.0, v209
  v_add_f32 v210, 1.0, v210
  v_add_f32 v211, 1.0, v211
  s_waitcnt lgkmcnt(6)
  v_mfma_f32_32x32x16_bf16 v[0:15], v[192:195], a[192:195], v[0:15]
  buffer_load_dwordx4 v224, s[20:23], s62 offen offset:1024 sc1 lds
  v_rcp_f32 v208, v208
  v_rcp_f32 v209, v209
  v_mfma_f32_32x32x16_bf16 v[16:31], v[192:195], a[196:199], v[16:31]
  ds_read_b64_tr_b16 v[192:193], v226 offset:4096
  ds_read_b64_tr_b16 v[194:195], v226 offset:4608
  buffer_load_dwordx4 v224, s[20:23], s62 offen offset:2048 sc1 lds
  v_rcp_f32 v210, v210
  s_waitcnt lgkmcnt(6)
  v_mfma_f32_32x32x16_bf16 v[32:47], v[196:199], a[192:195], v[32:47]
  buffer_load_dwordx4 v224, s[20:23], s62 offen offset:3072 sc1 lds
  v_rcp_f32 v211, v211
  v_mul_f32 v208, v72, v208
  v_mul_f32 v209, v73, v209
  v_mfma_f32_32x32x16_bf16 v[48:63], v[196:199], a[196:199], v[48:63]
  ds_read_b64_tr_b16 v[196:197], v227 offset:4096
  ds_read_b64_tr_b16 v[198:199], v227 offset:4608
  s_add_u32 s62, s79, 4096
  v_mul_f32 v210, v74, v210
  v_mul_f32 v211, v75, v211
  v_cvt_pk_bf16_f32 v132, v208, v209
  s_waitcnt lgkmcnt(6)
  v_mfma_f32_32x32x16_bf16 v[0:15], v[200:203], a[200:203], v[0:15]
  s_add_u32 m0, s4, 4096
  v_cvt_pk_bf16_f32 v133, v210, v211
  v_mul_f32 v212, 0xbfb8aa3b, v76
  v_mul_f32 v213, 0xbfb8aa3b, v77
  v_mul_f32 v214, 0xbfb8aa3b, v78
  v_mfma_f32_32x32x16_bf16 v[16:31], v[200:203], a[204:207], v[16:31]
  ds_read_b64_tr_b16 v[200:201], v226 offset:6144
  ds_read_b64_tr_b16 v[202:203], v226 offset:6656
  buffer_load_dwordx4 v224, s[20:23], s62 offen offset:0 sc1 lds
  v_mul_f32 v215, 0xbfb8aa3b, v79
  s_waitcnt lgkmcnt(6)
  v_mfma_f32_32x32x16_bf16 v[32:47], v[204:207], a[200:203], v[32:47]
  buffer_load_dwordx4 v224, s[20:23], s62 offen offset:1024 sc1 lds
  v_exp_f32 v212, v212
  v_exp_f32 v213, v213
  v_mfma_f32_32x32x16_bf16 v[48:63], v[204:207], a[204:207], v[48:63]
  ds_read_b64_tr_b16 v[204:205], v227 offset:6144
  ds_read_b64_tr_b16 v[206:207], v227 offset:6656
  buffer_load_dwordx4 v224, s[20:23], s62 offen offset:2048 sc1 lds
  v_exp_f32 v214, v214
  s_waitcnt lgkmcnt(6)
  v_mfma_f32_32x32x16_bf16 v[0:15], v[192:195], a[208:211], v[0:15]
  buffer_load_dwordx4 v224, s[20:23], s62 offen offset:3072 sc1 lds
  v_exp_f32 v215, v215
  v_add_f32 v212, 1.0, v212
  v_add_f32 v213, 1.0, v213
  v_add_f32 v214, 1.0, v214
  v_mfma_f32_32x32x16_bf16 v[16:31], v[192:195], a[212:215], v[16:31]
  ds_read_b64_tr_b16 v[192:193], v226 offset:8192
  ds_read_b64_tr_b16 v[194:195], v226 offset:8704
  s_add_u32 s62, s79, 8192
  v_add_f32 v215, 1.0, v215
  v_rcp_f32 v212, v212
  s_waitcnt lgkmcnt(6)
  v_mfma_f32_32x32x16_bf16 v[32:47], v[196:199], a[208:211], v[32:47]
  s_add_u32 m0, s4, 8192
  v_rcp_f32 v213, v213
  v_rcp_f32 v214, v214
  v_mfma_f32_32x32x16_bf16 v[48:63], v[196:199], a[212:215], v[48:63]
  ds_read_b64_tr_b16 v[196:197], v227 offset:8192
  ds_read_b64_tr_b16 v[198:199], v227 offset:8704
  buffer_load_dwordx4 v224, s[20:23], s62 offen offset:0 sc1 lds
  v_rcp_f32 v215, v215
  s_waitcnt lgkmcnt(6)
  v_mfma_f32_32x32x16_bf16 v[0:15], v[200:203], a[216:219], v[0:15]
  v_cmp_eq_u32 vcc, 1, v243
  s_nop 1
  s_cmp_eq_u64 vcc, exec
  s_cbranch_scc1 L_ok_5
  s_mov_b32 s82, 0
L_spin_6:
  buffer_load_dword v243, v241, s[20:23], s71 offen sc1
  s_add_u32 s82, s82, 1
  s_waitcnt vmcnt(0)
  v_cmp_eq_u32 vcc, 1, v243
  s_nop 4
  s_cmp_ge_u32 s82, 0x40000
  s_cbranch_scc1 L_ok_5
  s_cmp_eq_u64 vcc, exec
  s_cbranch_scc0 L_spin_6
L_ok_5:
  v_mul_f32 v212, v76, v212
  v_mul_f32 v213, v77, v213
  v_mul_f32 v214, v78, v214
  v_mfma_f32_32x32x16_bf16 v[16:31], v[200:203], a[220:223], v[16:31]
  ds_read_b64_tr_b16 v[200:201], v226 offset:10240
  ds_read_b64_tr_b16 v[202:203], v226 offset:10752
  v_mul_f32 v215, v79, v215
  v_cvt_pk_bf16_f32 v134, v212, v213
  v_cvt_pk_bf16_f32 v135, v214, v215
  s_waitcnt lgkmcnt(6)
  v_mfma_f32_32x32x16_bf16 v[32:47], v[204:207], a[216:219], v[32:47]
  v_mul_f32 v208, 0xbfb8aa3b, v80
  v_mul_f32 v209, 0xbfb8aa3b, v81
  v_mul_f32 v210, 0xbfb8aa3b, v82
  v_mul_f32 v211, 0xbfb8aa3b, v83
  v_mfma_f32_32x32x16_bf16 v[48:63], v[204:207], a[220:223], v[48:63]
  ds_read_b64_tr_b16 v[204:205], v227 offset:10240
  ds_read_b64_tr_b16 v[206:207], v227 offset:10752
  v_exp_f32 v208, v208
  v_exp_f32 v209, v209
  s_waitcnt lgkmcnt(6)
  v_mfma_f32_32x32x16_bf16 v[0:15], v[192:195], a[224:227], v[0:15]
  v_exp_f32 v210, v210
  v_exp_f32 v211, v211
  v_add_f32 v208, 1.0, v208
  v_mfma_f32_32x32x16_bf16 v[16:31], v[192:195], a[228:231], v[16:31]
  s_barrier
  ds_read_b64_tr_b16 v[192:193], v253 offset:0
  ds_read_b64_tr_b16 v[194:195], v253 offset:512
  s_add_u32 m0, s57, 49152
  s_add_u32 s62, s60, 3538944
  buffer_load_dwordx4 v232, s[24:27], s62 offen lds
  s_waitcnt lgkmcnt(6)
  v_mfma_f32_32x32x16_bf16 v[32:47], v[196:199], a[224:227], v[32:47]
  s_add_u32 m0, s57, 50176
  s_add_u32 s62, s60, 3833856
  buffer_load_dwordx4 v232, s[24:27], s62 offen lds
  v_add_f32 v209, 1.0, v209
  v_add_f32 v210, 1.0, v210
  v_mfma_f32_32x32x16_bf16 v[48:63], v[196:199], a[228:231], v[48:63]
  ds_read_b64_tr_b16 v[196:197], v254 offset:0
  ds_read_b64_tr_b16 v[198:199], v254 offset:512
  s_add_u32 m0, s57, 51200
  s_add_u32 s62, s60, 4128768
  buffer_load_dwordx4 v232, s[24:27], s62 offen lds
  v_add_f32 v211, 1.0, v211
  s_waitcnt lgkmcnt(6)
  v_mfma_f32_32x32x16_bf16 v[0:15], v[200:203], a[232:235], v[0:15]
  v_rcp_f32 v208, v208
  v_rcp_f32 v209, v209
  v_mfma_f32_32x32x16_bf16 v[16:31], v[200:203], a[236:239], v[16:31]
  ds_read_b64_tr_b16 v[200:201], v253 offset:2048
  ds_read_b64_tr_b16 v[202:203], v253 offset:2560
  v_rcp_f32 v210, v210
  v_rcp_f32 v211, v211
  s_waitcnt lgkmcnt(6)
  v_mfma_f32_32x32x16_bf16 v[32:47], v[204:207], a[232:235], v[32:47]
  v_mul_f32 v208, v80, v208
  v_mul_f32 v209, v81, v209
  v_mul_f32 v210, v82, v210
  v_mul_f32 v211, v83, v211
  v_cvt_pk_bf16_f32 v136, v208, v209
  v_mfma_f32_32x32x16_bf16 v[48:63], v[204:207], a[236:239], v[48:63]
  ds_read_b64_tr_b16 v[204:205], v254 offset:2048
  ds_read_b64_tr_b16 v[206:207], v254 offset:2560
  v_cvt_pk_bf16_f32 v137, v210, v211
  v_mul_f32 v212, 0xbfb8aa3b, v84
  v_mul_f32 v213, 0xbfb8aa3b, v85
  s_waitcnt lgkmcnt(6)
  v_mfma_f32_32x32x16_bf16 v[0:15], v[192:195], a[240:243], v[0:15]
  v_mul_f32 v214, 0xbfb8aa3b, v86
  v_mul_f32 v215, 0xbfb8aa3b, v87
  v_exp_f32 v212, v212
  v_mfma_f32_32x32x16_bf16 v[16:31], v[192:195], a[244:247], v[16:31]
  ds_read_b64_tr_b16 v[192:193], v253 offset:4096
  ds_read_b64_tr_b16 v[194:195], v253 offset:4608
  v_exp_f32 v213, v213
  v_exp_f32 v214, v214
  s_waitcnt lgkmcnt(6)
  v_mfma_f32_32x32x16_bf16 v[32:47], v[196:199], a[240:243], v[32:47]
  v_exp_f32 v215, v215
  v_add_f32 v212, 1.0, v212
  v_add_f32 v213, 1.0, v213
  v_add_f32 v214, 1.0, v214
  v_mfma_f32_32x32x16_bf16 v[48:63], v[196:199], a[244:247], v[48:63]
  ds_read_b64_tr_b16 v[196:197], v254 offset:4096
  ds_read_b64_tr_b16 v[198:199], v254 offset:4608
  v_add_f32 v215, 1.0, v215
  v_rcp_f32 v212, v212
  s_waitcnt lgkmcnt(6)
  v_mfma_f32_32x32x16_bf16 v[0:15], v[200:203], a[248:251], v[0:15]
  v_rcp_f32 v213, v213
  v_rcp_f32 v214, v214
  v_mfma_f32_32x32x16_bf16 v[16:31], v[200:203], a[252:255], v[16:31]
  ds_read_b64_tr_b16 v[200:201], v253 offset:6144
  ds_read_b64_tr_b16 v[202:203], v253 offset:6656
  v_rcp_f32 v215, v215
  v_mul_f32 v212, v84, v212
  v_mul_f32 v213, v85, v213
  s_waitcnt lgkmcnt(6)
  v_mfma_f32_32x32x16_bf16 v[32:47], v[204:207], a[248:251], v[32:47]
  v_mul_f32 v214, v86, v214
  v_mul_f32 v215, v87, v215
  v_cvt_pk_bf16_f32 v138, v212, v213
  v_cvt_pk_bf16_f32 v139, v214, v215
  v_mul_f32 v208, 0xbfb8aa3b, v88
  v_mfma_f32_32x32x16_bf16 v[48:63], v[204:207], a[252:255], v[48:63]
  ds_read_b64_tr_b16 v[204:205], v254 offset:6144
  ds_read_b64_tr_b16 v[206:207], v254 offset:6656
  v_mul_f32 v209, 0xbfb8aa3b, v89
  v_mul_f32 v210, 0xbfb8aa3b, v90
  v_mul_f32 v211, 0xbfb8aa3b, v91
  s_waitcnt lgkmcnt(6)
  v_mfma_f32_32x32x16_bf16 v[0:15], v[192:195], v[160:163], v[0:15]
  v_exp_f32 v208, v208
  v_exp_f32 v209, v209
  v_mfma_f32_32x32x16_bf16 v[16:31], v[192:195], v[164:167], v[16:31]
  ds_read_b64_tr_b16 v[192:193], v253 offset:8192
  ds_read_b64_tr_b16 v[194:195], v253 offset:8704
  v_exp_f32 v210, v210
  v_exp_f32 v211, v211
  s_waitcnt lgkmcnt(6)
  v_mfma_f32_32x32x16_bf16 v[32:47], v[196:199], v[160:163], v[32:47]
  v_add_f32 v208, 1.0, v208
  v_add_f32 v209, 1.0, v209
  v_add_f32 v210, 1.0, v210
  v_add_f32 v211, 1.0, v211
  v_mfma_f32_32x32x16_bf16 v[48:63], v[196:199], v[164:167], v[48:63]
  ds_read_b64_tr_b16 v[196:197], v254 offset:8192
  ds_read_b64_tr_b16 v[198:199], v254 offset:8704
  v_rcp_f32 v208, v208
  v_rcp_f32 v209, v209
  s_waitcnt lgkmcnt(6)
  v_mfma_f32_32x32x16_bf16 v[0:15], v[200:203], v[168:171], v[0:15]
  v_rcp_f32 v210, v210
  v_rcp_f32 v211, v211
  v_mul_f32 v208, v88, v208
  v_mfma_f32_32x32x16_bf16 v[16:31], v[200:203], v[172:175], v[16:31]
  ds_read_b64_tr_b16 v[200:201], v253 offset:10240
  ds_read_b64_tr_b16 v[202:203], v253 offset:10752
  v_mul_f32 v209, v89, v209
  v_mul_f32 v210, v90, v210
  v_mul_f32 v211, v91, v211
  s_waitcnt lgkmcnt(6)
  v_mfma_f32_32x32x16_bf16 v[32:47], v[204:207], v[168:171], v[32:47]
  v_cvt_pk_bf16_f32 v140, v208, v209
  v_cvt_pk_bf16_f32 v141, v210, v211
  v_mul_f32 v212, 0xbfb8aa3b, v92
  v_mul_f32 v213, 0xbfb8aa3b, v93
  v_mul_f32 v214, 0xbfb8aa3b, v94
  v_mfma_f32_32x32x16_bf16 v[48:63], v[204:207], v[172:175], v[48:63]
  ds_read_b64_tr_b16 v[204:205], v254 offset:10240
  ds_read_b64_tr_b16 v[206:207], v254 offset:10752
  v_mul_f32 v215, 0xbfb8aa3b, v95
  v_exp_f32 v212, v212
  s_waitcnt lgkmcnt(6)
  v_mfma_f32_32x32x16_bf16 v[0:15], v[192:195], v[176:179], v[0:15]
  v_exp_f32 v213, v213
  v_exp_f32 v214, v214
  v_mfma_f32_32x32x16_bf16 v[16:31], v[192:195], v[180:183], v[16:31]
  s_barrier
  v_add_u32 v253, 0x10000, v233
  v_add_u32 v254, 0x10000, v233
  ds_read_b64_tr_b16 v[192:193], v253 offset:12288
  ds_read_b64_tr_b16 v[194:195], v253 offset:12416
  s_add_u32 s62, s79, 147456
  s_waitcnt lgkmcnt(6)
  v_mfma_f32_32x32x16_bf16 v[32:47], v[196:199], v[176:179], v[32:47]
  s_add_u32 m0, s5, 0
  v_exp_f32 v215, v215
  v_add_f32 v212, 1.0, v212
  v_add_f32 v213, 1.0, v213
  v_add_f32 v214, 1.0, v214
  v_mfma_f32_32x32x16_bf16 v[48:63], v[196:199], v[180:183], v[48:63]
  ds_read_b64_tr_b16 v[196:197], v253 offset:12800
  ds_read_b64_tr_b16 v[198:199], v253 offset:12928
  buffer_load_dwordx4 v224, s[20:23], s62 offen offset:0 sc1 lds
  v_add_f32 v215, 1.0, v215
  s_waitcnt lgkmcnt(6)
  v_mfma_f32_32x32x16_bf16 v[0:15], v[200:203], v[184:187], v[0:15]
  buffer_load_dwordx4 v224, s[20:23], s62 offen offset:1024 sc1 lds
  v_rcp_f32 v212, v212
  v_rcp_f32 v213, v213
  v_mfma_f32_32x32x16_bf16 v[16:31], v[200:203], v[188:191], v[16:31]
  ds_read_b64_tr_b16 v[200:201], v253 offset:13312
  ds_read_b64_tr_b16 v[202:203], v253 offset:13440
  buffer_load_dwordx4 v224, s[20:23], s62 offen offset:2048 sc1 lds
  v_rcp_f32 v214, v214
  v_rcp_f32 v215, v215
  s_waitcnt lgkmcnt(6)
  v_mfma_f32_32x32x16_bf16 v[32:47], v[204:207], v[184:187], v[32:47]
  buffer_load_dwordx4 v224, s[20:23], s62 offen offset:3072 sc1 lds
  v_mul_f32 v212, v92, v212
  v_mul_f32 v213, v93, v213
  v_mul_f32 v214, v94, v214
  v_mul_f32 v215, v95, v215
  v_mfma_f32_32x32x16_bf16 v[48:63], v[204:207], v[188:191], v[48:63]
  ds_read_b64_tr_b16 v[204:205], v253 offset:13824
  ds_read_b64_tr_b16 v[206:207], v253 offset:13952
  s_add_u32 s62, s79, 151552
  v_cvt_pk_bf16_f32 v142, v212, v213
  v_cvt_pk_bf16_f32 v143, v214, v215
  s_waitcnt lgkmcnt(6)
  v_mfma_f32_32x32x16_bf16 v[64:79], v[192:195], a[0:3], 0
  s_add_u32 m0, s5, 4096
  v_mfma_f32_32x32x16_bf16 v[80:95], v[192:195], a[4:7], 0
  ds_read_b64_tr_b16 v[192:193], v253 offset:14336
  ds_read_b64_tr_b16 v[194:195], v253 offset:14464
  buffer_load_dwordx4 v224, s[20:23], s62 offen offset:0 sc1 lds
  s_waitcnt lgkmcnt(6)
  v_mfma_f32_32x32x16_bf16 v[64:79], v[196:199], a[8:11], v[64:79]
  buffer_load_dwordx4 v224, s[20:23], s62 offen offset:1024 sc1 lds
  v_mfma_f32_32x32x16_bf16 v[80:95], v[196:199], a[12:15], v[80:95]
  ds_read_b64_tr_b16 v[196:197], v253 offset:14848
  ds_read_b64_tr_b16 v[198:199], v253 offset:14976
  buffer_load_dwordx4 v224, s[20:23], s62 offen offset:2048 sc1 lds
  s_waitcnt lgkmcnt(6)
  v_mfma_f32_32x32x16_bf16 v[64:79], v[200:203], a[16:19], v[64:79]
  buffer_load_dwordx4 v224, s[20:23], s62 offen offset:3072 sc1 lds
  v_mfma_f32_32x32x16_bf16 v[80:95], v[200:203], a[20:23], v[80:95]
  ds_read_b64_tr_b16 v[200:201], v253 offset:15360
  ds_read_b64_tr_b16 v[202:203], v253 offset:15488
  s_add_u32 s63, s78, 0
  buffer_load_dwordx4 a[0:3], v224, s[20:23], s63 offen sc1
  buffer_load_dwordx4 a[4:7], v224, s[20:23], s63 offen offset:1024 sc1
  s_add_u32 s62, s79, 155648
  s_waitcnt lgkmcnt(6)
  v_mfma_f32_32x32x16_bf16 v[64:79], v[204:207], a[24:27], v[64:79]
  s_add_u32 m0, s5, 8192
  v_mfma_f32_32x32x16_bf16 v[80:95], v[204:207], a[28:31], v[80:95]
  ds_read_b64_tr_b16 v[204:205], v253 offset:15872
  ds_read_b64_tr_b16 v[206:207], v253 offset:16000
  s_add_u32 s63, s78, 2048
  buffer_load_dwordx4 a[8:11], v224, s[20:23], s63 offen sc1
  buffer_load_dwordx4 a[12:15], v224, s[20:23], s63 offen offset:1024 sc1
  buffer_load_dwordx4 v224, s[20:23], s62 offen offset:0 sc1 lds
  s_waitcnt lgkmcnt(6)
  v_mfma_f32_32x32x16_bf16 v[64:79], v[192:195], a[32:35], v[64:79]
  v_mfma_f32_32x32x16_bf16 v[80:95], v[192:195], a[36:39], v[80:95]
  ds_read_b64_tr_b16 v[192:193], v253 offset:16384
  ds_read_b64_tr_b16 v[194:195], v253 offset:16512
  s_add_u32 s63, s78, 4096
  buffer_load_dwordx4 a[16:19], v224, s[20:23], s63 offen sc1
  buffer_load_dwordx4 a[20:23], v224, s[20:23], s63 offen offset:1024 sc1
  s_waitcnt lgkmcnt(6)
  v_mfma_f32_32x32x16_bf16 v[64:79], v[196:199], a[40:43], v[64:79]
  v_mfma_f32_32x32x16_bf16 v[80:95], v[196:199], a[44:47], v[80:95]
  ds_read_b64_tr_b16 v[196:197], v253 offset:16896
  ds_read_b64_tr_b16 v[198:199], v253 offset:17024
  s_add_u32 s63, s78, 6144
  buffer_load_dwordx4 a[24:27], v224, s[20:23], s63 offen sc1
  buffer_load_dwordx4 a[28:31], v224, s[20:23], s63 offen offset:1024 sc1
  s_waitcnt lgkmcnt(6)
  v_mfma_f32_32x32x16_bf16 v[64:79], v[200:203], a[48:51], v[64:79]
  v_lshlrev_b32 v208, 16, v128
  v_and_b32 v209, 0xffff0000, v128
  v_lshlrev_b32 v210, 16, v129
  v_and_b32 v211, 0xffff0000, v129
  v_mul_f32 v208, v208, v0
  v_mfma_f32_32x32x16_bf16 v[80:95], v[200:203], a[52:55], v[80:95]
  ds_read_b64_tr_b16 v[200:201], v253 offset:17408
  ds_read_b64_tr_b16 v[202:203], v253 offset:17536
  v_mul_f32 v209, v209, v1
  v_mul_f32 v210, v210, v2
  v_mul_f32 v211, v211, v3
  s_waitcnt lgkmcnt(6)
  v_mfma_f32_32x32x16_bf16 v[64:79], v[204:207], a[56:59], v[64:79]
  v_cvt_pk_bf16_f32 v216, v208, v209
  v_cvt_pk_bf16_f32 v217, v210, v211
  v_lshlrev_b32 v208, 16, v130
  v_and_b32 v209, 0xffff0000, v130
  v_lshlrev_b32 v210, 16, v131
  v_mfma_f32_32x32x16_bf16 v[80:95], v[204:207], a[60:63], v[80:95]
  ds_read_b64_tr_b16 v[204:205], v253 offset:17920
  ds_read_b64_tr_b16 v[206:207], v253 offset:18048
  v_and_b32 v211, 0xffff0000, v131
  v_mul_f32 v208, v208, v4
  v_mul_f32 v209, v209, v5
  v_mul_f32 v210, v210, v6
  s_waitcnt lgkmcnt(6)
  v_mfma_f32_32x32x16_bf16 v[64:79], v[192:195], a[64:67], v[64:79]
  v_mul_f32 v211, v211, v7
  v_cvt_pk_bf16_f32 v218, v208, v209
  v_cvt_pk_bf16_f32 v219, v210, v211
  s_add_u32 s63, s61, 32768
  buffer_store_dwordx4 v[216:219], v228, s[20:23], s63 offen offset:0 sc1
  v_mfma_f32_32x32x16_bf16 v[80:95], v[192:195], a[68:71], v[80:95]
  s_waitcnt vmcnt(30)
  s_barrier
  ds_read_b64_tr_b16 v[192:193], v233 offset:36864
  ds_read_b64_tr_b16 v[194:195], v233 offset:36992
  buffer_load_dword v242, v241, s[20:23], s70 offen sc1
  v_lshlrev_b32 v208, 16, v132
  s_waitcnt lgkmcnt(6)
  v_mfma_f32_32x32x16_bf16 v[64:79], v[196:199], a[72:75], v[64:79]
  v_and_b32 v209, 0xffff0000, v132
  v_lshlrev_b32 v210, 16, v133
  v_and_b32 v211, 0xffff0000, v133
  v_mul_f32 v208, v208, v8
  v_mul_f32 v209, v209, v9
  v_mfma_f32_32x32x16_bf16 v[80:95], v[196:199], a[76:79], v[80:95]
  ds_read_b64_tr_b16 v[196:197], v233 offset:37376
  ds_read_b64_tr_b16 v[198:199], v233 offset:37504
  v_mul_f32 v210, v210, v10
  v_mul_f32 v211, v211, v11
  v_cvt_pk_bf16_f32 v220, v208, v209
  v_cvt_pk_bf16_f32 v221, v210, v211
  s_waitcnt lgkmcnt(6)
  v_mfma_f32_32x32x16_bf16 v[64:79], v[200:203], a[80:83], v[64:79]
  v_lshlrev_b32 v208, 16, v134
  v_and_b32 v209, 0xffff0000, v134
  v_lshlrev_b32 v210, 16, v135
  v_and_b32 v211, 0xffff0000, v135
  v_mul_f32 v208, v208, v12
  v_mfma_f32_32x32x16_bf16 v[80:95], v[200:203], a[84:87], v[80:95]
  ds_read_b64_tr_b16 v[200:201], v233 offset:37888
  ds_read_b64_tr_b16 v[202:203], v233 offset:38016
  v_mul_f32 v209, v209, v13
  v_mul_f32 v210, v210, v14
  v_mul_f32 v211, v211, v15
  s_waitcnt lgkmcnt(6)
  v_mfma_f32_32x32x16_bf16 v[64:79], v[204:207], a[88:91], v[64:79]
  v_cvt_pk_bf16_f32 v222, v208, v209
  v_cvt_pk_bf16_f32 v223, v210, v211
  s_add_u32 s63, s61, 32768
  buffer_store_dwordx4 v[220:223], v228, s[20:23], s63 offen offset:256 sc1
  v_lshlrev_b32 v208, 16, v136
  v_mfma_f32_32x32x16_bf16 v[80:95], v[204:207], a[92:95], v[80:95]
  ds_read_b64_tr_b16 v[204:205], v233 offset:38400
  ds_read_b64_tr_b16 v[206:207], v233 offset:38528
  v_and_b32 v209, 0xffff0000, v136
  v_lshlrev_b32 v210, 16, v137
  v_and_b32 v211, 0xffff0000, v137
  s_waitcnt lgkmcnt(6)
  v_mfma_f32_32x32x16_bf16 v[64:79], v[192:195], a[96:99], v[64:79]
  v_mul_f32 v208, v208, v16
  v_mul_f32 v209, v209, v17
  v_mul_f32 v210, v210, v18
  v_mul_f32 v211, v211, v19
  v_cvt_pk_bf16_f32 v216, v208, v209
  v_mfma_f32_32x32x16_bf16 v[80:95], v[192:195], a[100:103], v[80:95]
  ds_read_b64_tr_b16 v[192:193], v233 offset:38912
  ds_read_b64_tr_b16 v[194:195], v233 offset:39040
  v_cvt_pk_bf16_f32 v217, v210, v211
  v_lshlrev_b32 v208, 16, v138
  v_and_b32 v209, 0xffff0000, v138
  s_waitcnt lgkmcnt(6)
  v_mfma_f32_32x32x16_bf16 v[64:79], v[196:199], a[104:107], v[64:79]
  v_lshlrev_b32 v210, 16, v139
  v_and_b32 v211, 0xffff0000, v139
  v_mul_f32 v208, v208, v20
  v_mul_f32 v209, v209, v21
  v_mul_f32 v210, v210, v22
  v_mfma_f32_32x32x16_bf16 v[80:95], v[196:199], a[108:111], v[80:95]
  ds_read_b64_tr_b16 v[196:197], v233 offset:39424
  ds_read_b64_tr_b16 v[198:199], v233 offset:39552
  v_mul_f32 v211, v211, v23
  v_cvt_pk_bf16_f32 v218, v208, v209
  v_cvt_pk_bf16_f32 v219, v210, v211
  s_waitcnt lgkmcnt(6)
  v_mfma_f32_32x32x16_bf16 v[64:79], v[200:203], a[112:115], v[64:79]
  s_add_u32 s63, s61, 118784
  buffer_store_dwordx4 v[216:219], v228, s[20:23], s63 offen offset:0 sc1
  v_lshlrev_b32 v208, 16, v140
  v_and_b32 v209, 0xffff0000, v140
  v_lshlrev_b32 v210, 16, v141
  v_and_b32 v211, 0xffff0000, v141
  v_mfma_f32_32x32x16_bf16 v[80:95], v[200:203], a[116:119], v[80:95]
  ds_read_b64_tr_b16 v[200:201], v233 offset:39936
  ds_read_b64_tr_b16 v[202:203], v233 offset:40064
  v_mul_f32 v208, v208, v24
  v_mul_f32 v209, v209, v25
  v_mul_f32 v210, v210, v26
  s_waitcnt lgkmcnt(6)
  v_mfma_f32_32x32x16_bf16 v[64:79], v[204:207], a[120:123], v[64:79]
  v_mul_f32 v211, v211, v27
  v_cvt_pk_bf16_f32 v220, v208, v209
  v_cvt_pk_bf16_f32 v221, v210, v211
  v_lshlrev_b32 v208, 16, v142
  v_and_b32 v209, 0xffff0000, v142
  v_mfma_f32_32x32x16_bf16 v[80:95], v[204:207], a[124:127], v[80:95]
  ds_read_b64_tr_b16 v[204:205], v233 offset:40448
  ds_read_b64_tr_b16 v[206:207], v233 offset:40576
  v_lshlrev_b32 v210, 16, v143
  v_and_b32 v211, 0xffff0000, v143
  v_mul_f32 v208, v208, v28
  s_waitcnt lgkmcnt(6)
  v_mfma_f32_32x32x16_bf16 v[64:79], v[192:195], a[128:131], v[64:79]
  v_mul_f32 v209, v209, v29
  v_mul_f32 v210, v210, v30
  v_mul_f32 v211, v211, v31
  v_cvt_pk_bf16_f32 v222, v208, v209
  v_cvt_pk_bf16_f32 v223, v210, v211
  v_mfma_f32_32x32x16_bf16 v[80:95], v[192:195], a[132:135], v[80:95]
  ds_read_b64_tr_b16 v[192:193], v233 offset:40960
  ds_read_b64_tr_b16 v[194:195], v233 offset:41088
  s_add_u32 s63, s61, 118784
  buffer_store_dwordx4 v[220:223], v228, s[20:23], s63 offen offset:256 sc1
  v_lshlrev_b32 v208, 16, v144
  v_and_b32 v209, 0xffff0000, v144
  s_waitcnt lgkmcnt(6)
  v_mfma_f32_32x32x16_bf16 v[64:79], v[196:199], a[136:139], v[64:79]
  v_lshlrev_b32 v210, 16, v145
  v_and_b32 v211, 0xffff0000, v145
  v_mul_f32 v208, v208, v32
  v_mul_f32 v209, v209, v33
  v_mul_f32 v210, v210, v34
  v_mfma_f32_32x32x16_bf16 v[80:95], v[196:199], a[140:143], v[80:95]
  ds_read_b64_tr_b16 v[196:197], v233 offset:41472
  ds_read_b64_tr_b16 v[198:199], v233 offset:41600
  v_mul_f32 v211, v211, v35
  v_cvt_pk_bf16_f32 v216, v208, v209
  v_cvt_pk_bf16_f32 v217, v210, v211
  s_waitcnt lgkmcnt(6)
  v_mfma_f32_32x32x16_bf16 v[64:79], v[200:203], a[144:147], v[64:79]
  v_lshlrev_b32 v208, 16, v146
  v_and_b32 v209, 0xffff0000, v146
  v_lshlrev_b32 v210, 16, v147
  v_and_b32 v211, 0xffff0000, v147
  v_mul_f32 v208, v208, v36
  v_mfma_f32_32x32x16_bf16 v[80:95], v[200:203], a[148:151], v[80:95]
  ds_read_b64_tr_b16 v[200:201], v233 offset:41984
  ds_read_b64_tr_b16 v[202:203], v233 offset:42112
  v_mul_f32 v209, v209, v37
  v_mul_f32 v210, v210, v38
  v_mul_f32 v211, v211, v39
  s_waitcnt lgkmcnt(6)
  v_mfma_f32_32x32x16_bf16 v[64:79], v[204:207], a[152:155], v[64:79]
  v_cvt_pk_bf16_f32 v218, v208, v209
  v_cvt_pk_bf16_f32 v219, v210, v211
  s_add_u32 s63, s61, 34816
  buffer_store_dwordx4 v[216:219], v228, s[20:23], s63 offen offset:0 sc1
  v_lshlrev_b32 v208, 16, v148
  v_mfma_f32_32x32x16_bf16 v[80:95], v[204:207], a[156:159], v[80:95]
  ds_read_b64_tr_b16 v[204:205], v233 offset:42496
  ds_read_b64_tr_b16 v[206:207], v233 offset:42624
  v_and_b32 v209, 0xffff0000, v148
  v_lshlrev_b32 v210, 16, v149
  v_and_b32 v211, 0xffff0000, v149
  v_mul_f32 v208, v208, v40
  s_waitcnt lgkmcnt(6)
  v_mfma_f32_32x32x16_bf16 v[64:79], v[192:195], a[160:163], v[64:79]
  v_mul_f32 v209, v209, v41
  v_mul_f32 v210, v210, v42
  v_mul_f32 v211, v211, v43
  v_cvt_pk_bf16_f32 v220, v208, v209
  v_cvt_pk_bf16_f32 v221, v210, v211
  v_mfma_f32_32x32x16_bf16 v[80:95], v[192:195], a[164:167], v[80:95]
  s_waitcnt vmcnt(23)
  s_barrier
  ds_read_b64_tr_b16 v[192:193], v233 offset:49152
  ds_read_b64_tr_b16 v[194:195], v233 offset:49280
  s_mul_i32 s62, s50, 3
  v_lshrrev_b32 v214, 5, v249
  v_add_u32 v214, s62, v214
  v_lshrrev_b32 v215, 2, v214
  v_lshlrev_b32 v215, 11, v215
  s_waitcnt lgkmcnt(6)
  v_mfma_f32_32x32x16_bf16 v[64:79], v[196:199], a[168:171], v[64:79]
  v_and_b32 v214, 3, v214
  v_lshl_add_u32 v214, v214, 8, v215
  v_and_b32 v215, 0xfffffdff, v228
  v_add_u32 v240, v214, v215
  v_lshlrev_b32 v208, 16, v150
  v_mfma_f32_32x32x16_bf16 v[80:95], v[196:199], a[172:175], v[80:95]
  ds_read_b64_tr_b16 v[196:197], v233 offset:49664
  ds_read_b64_tr_b16 v[198:199], v233 offset:49792
  s_add_u32 s62, s62, 0
  s_mul_i32 s62, s50, 3
  s_add_u32 s62, s62, 2
  s_lshr_b32 s45, s62, 2
  s_lshl_b32 s45, s45, 11
  s_and_b32 s62, s62, 3
  s_lshl_b32 s62, s62, 8
  s_add_u32 s62, s62, s45
  v_add_u32 v244, s62, v215
  s_waitcnt lgkmcnt(6)
  v_mfma_f32_32x32x16_bf16 v[64:79], v[200:203], a[176:179], v[64:79]
  v_and_b32 v209, 0xffff0000, v150
  v_lshlrev_b32 v210, 16, v151
  v_and_b32 v211, 0xffff0000, v151
  v_mul_f32 v208, v208, v44
  v_mul_f32 v209, v209, v45
  v_mfma_f32_32x32x16_bf16 v[80:95], v[200:203], a[180:183], v[80:95]
  ds_read_b64_tr_b16 v[200:201], v233 offset:50176
  ds_read_b64_tr_b16 v[202:203], v233 offset:50304
  v_mul_f32 v210, v210, v46
  v_mul_f32 v211, v211, v47
  v_cvt_pk_bf16_f32 v222, v208, v209
  v_cvt_pk_bf16_f32 v223, v210, v211
  s_waitcnt lgkmcnt(6)
  v_mfma_f32_32x32x16_bf16 v[64:79], v[204:207], a[184:187], v[64:79]
  s_add_u32 s63, s61, 34816
  buffer_store_dwordx4 v[220:223], v228, s[20:23], s63 offen offset:256 sc1
  v_lshlrev_b32 v208, 16, v152
  v_and_b32 v209, 0xffff0000, v152
  v_mfma_f32_32x32x16_bf16 v[80:95], v[204:207], a[188:191], v[80:95]
  ds_read_b64_tr_b16 v[204:205], v233 offset:50688
  ds_read_b64_tr_b16 v[206:207], v233 offset:50816
  v_lshlrev_b32 v210, 16, v153
  v_and_b32 v211, 0xffff0000, v153
  v_mul_f32 v208, v208, v48
  v_mul_f32 v209, v209, v49
  s_waitcnt lgkmcnt(6)
  v_mfma_f32_32x32x16_bf16 v[64:79], v[192:195], a[192:195], v[64:79]
  v_mul_f32 v210, v210, v50
  v_mul_f32 v211, v211, v51
  v_cvt_pk_bf16_f32 v216, v208, v209
  v_cvt_pk_bf16_f32 v217, v210, v211
  v_lshlrev_b32 v208, 16, v154
  v_mfma_f32_32x32x16_bf16 v[80:95], v[192:195], a[196:199], v[80:95]
  ds_read_b64_tr_b16 v[192:193], v233 offset:51200
  ds_read_b64_tr_b16 v[194:195], v233 offset:51328
  v_and_b32 v209, 0xffff0000, v154
  v_lshlrev_b32 v210, 16, v155
  v_and_b32 v211, 0xffff0000, v155
  s_waitcnt lgkmcnt(6)
  v_mfma_f32_32x32x16_bf16 v[64:79], v[196:199], a[200:203], v[64:79]
  v_mul_f32 v208, v208, v52
  v_mul_f32 v209, v209, v53
  v_mul_f32 v210, v210, v54
  v_mul_f32 v211, v211, v55
  v_cvt_pk_bf16_f32 v218, v208, v209
  v_mfma_f32_32x32x16_bf16 v[80:95], v[196:199], a[204:207], v[80:95]
  ds_read_b64_tr_b16 v[196:197], v233 offset:51712
  ds_read_b64_tr_b16 v[198:199], v233 offset:51840
  v_cvt_pk_bf16_f32 v219, v210, v211
  s_add_u32 s63, s61, 120832
  buffer_store_dwordx4 v[216:219], v228, s[20:23], s63 offen offset:0 sc1
  s_waitcnt lgkmcnt(6)
  v_mfma_f32_32x32x16_bf16 v[64:79], v[200:203], a[208:211], v[64:79]
  v_lshlrev_b32 v208, 16, v156
  v_and_b32 v209, 0xffff0000, v156
  v_lshlrev_b32 v210, 16, v157
  v_and_b32 v211, 0xffff0000, v157
  v_mul_f32 v208, v208, v56
  v_mfma_f32_32x32x16_bf16 v[80:95], v[200:203], a[212:215], v[80:95]
  ds_read_b64_tr_b16 v[200:201], v233 offset:52224
  ds_read_b64_tr_b16 v[202:203], v233 offset:52352
  v_mul_f32 v209, v209, v57
  v_mul_f32 v210, v210, v58
  v_mul_f32 v211, v211, v59
  v_cvt_pk_bf16_f32 v220, v208, v209
  s_waitcnt lgkmcnt(6)
  v_mfma_f32_32x32x16_bf16 v[64:79], v[204:207], a[216:219], v[64:79]
  v_cvt_pk_bf16_f32 v221, v210, v211
  v_lshlrev_b32 v208, 16, v158
  v_and_b32 v209, 0xffff0000, v158
  v_lshlrev_b32 v210, 16, v159
  v_and_b32 v211, 0xffff0000, v159
  v_mfma_f32_32x32x16_bf16 v[80:95], v[204:207], a[220:223], v[80:95]
  ds_read_b64_tr_b16 v[204:205], v233 offset:52736
  ds_read_b64_tr_b16 v[206:207], v233 offset:52864
  v_mul_f32 v208, v208, v60
  v_mul_f32 v209, v209, v61
  v_mul_f32 v210, v210, v62
  s_waitcnt lgkmcnt(6)
  v_mfma_f32_32x32x16_bf16 v[64:79], v[192:195], a[224:227], v[64:79]
  v_mul_f32 v211, v211, v63
  v_cvt_pk_bf16_f32 v222, v208, v209
  v_cvt_pk_bf16_f32 v223, v210, v211
  s_add_u32 s63, s61, 120832
  buffer_store_dwordx4 v[220:223], v228, s[20:23], s63 offen offset:256 sc1
  v_mfma_f32_32x32x16_bf16 v[80:95], v[192:195], a[228:231], v[80:95]
  ds_read_b64_tr_b16 v[192:193], v233 offset:53248
  ds_read_b64_tr_b16 v[194:195], v233 offset:53376
  s_waitcnt lgkmcnt(6)
  v_mfma_f32_32x32x16_bf16 v[64:79], v[196:199], a[232:235], v[64:79]
  v_mfma_f32_32x32x16_bf16 v[80:95], v[196:199], a[236:239], v[80:95]
  ds_read_b64_tr_b16 v[196:197], v233 offset:53760
  ds_read_b64_tr_b16 v[198:199], v233 offset:53888
  s_waitcnt lgkmcnt(6)
  v_mfma_f32_32x32x16_bf16 v[64:79], v[200:203], a[240:243], v[64:79]
  v_mfma_f32_32x32x16_bf16 v[80:95], v[200:203], a[244:247], v[80:95]
  ds_read_b64_tr_b16 v[200:201], v233 offset:54272
  ds_read_b64_tr_b16 v[202:203], v233 offset:54400
  s_waitcnt lgkmcnt(6)
  v_mfma_f32_32x32x16_bf16 v[64:79], v[204:207], a[248:251], v[64:79]
  v_mfma_f32_32x32x16_bf16 v[80:95], v[204:207], a[252:255], v[80:95]
  ds_read_b64_tr_b16 v[204:205], v233 offset:54784
  ds_read_b64_tr_b16 v[206:207], v233 offset:54912
  s_waitcnt lgkmcnt(6)
  v_mfma_f32_32x32x16_bf16 v[64:79], v[192:195], v[160:163], v[64:79]
  v_mfma_f32_32x32x16_bf16 v[80:95], v[192:195], v[164:167], v[80:95]
  s_waitcnt lgkmcnt(4)
  v_mfma_f32_32x32x16_bf16 v[64:79], v[196:199], v[168:171], v[64:79]
  v_mfma_f32_32x32x16_bf16 v[80:95], v[196:199], v[172:175], v[80:95]
  s_waitcnt lgkmcnt(2)
  v_mfma_f32_32x32x16_bf16 v[64:79], v[200:203], v[176:179], v[64:79]
  v_mfma_f32_32x32x16_bf16 v[80:95], v[200:203], v[180:183], v[80:95]
  s_waitcnt lgkmcnt(0)
  v_mfma_f32_32x32x16_bf16 v[64:79], v[204:207], v[184:187], v[64:79]
  v_mfma_f32_32x32x16_bf16 v[80:95], v[204:207], v[188:191], v[80:95]
L_p2_w0:
  v_add_u32 v253, 0x10000, v224
  v_add_u32 v254, 0x20000, v224
  s_barrier
  ds_read_b128 v[144:147], v253 offset:24576
  ds_read_b128 v[148:151], v253 offset:25600
  ds_read_b128 v[152:155], v253 offset:26624
  ds_read_b128 v[156:159], v253 offset:27648
  ds_read_b128 v[160:163], v253 offset:28672
  ds_read_b128 v[164:167], v253 offset:29696
  ds_read_b128 v[168:171], v253 offset:30720
  ds_read_b128 v[172:175], v253 offset:31744
  s_add_u32 s100, s71, 32
  s_add_u32 s101, s71, 64
  s_waitcnt vmcnt(17) lgkmcnt(7)
  v_mfma_f32_16x16x32_bf16 v[0:3], v[144:147], a[0:3], 0
  s_add_u32 s62, s79, 294912
  s_add_u32 m0, s6, 0
  s_waitcnt vmcnt(16)
  v_mfma_f32_16x16x32_bf16 v[4:7], v[144:147], a[4:7], 0
  buffer_load_dwordx4 v224, s[20:23], s62 offen offset:0 sc1 lds
  ds_read_b128 v[144:147], v253 offset:32768
  s_waitcnt lgkmcnt(7)
  v_mfma_f32_16x16x32_bf16 v[8:11], v[148:151], a[0:3], 0
  ds_read_b64_tr_b16 v[176:177], v248 offset:0
  ds_read_b64_tr_b16 v[178:179], v248 offset:1088
  v_mfma_f32_16x16x32_bf16 v[12:15], v[148:151], a[4:7], 0
  buffer_load_dwordx4 v224, s[20:23], s62 offen offset:1024 sc1 lds
  ds_read_b128 v[148:151], v253 offset:33792
  s_waitcnt lgkmcnt(9)
  v_mfma_f32_16x16x32_bf16 v[16:19], v[152:155], a[0:3], 0
  ds_read_b64_tr_b16 v[180:181], v248 offset:2176
  ds_read_b64_tr_b16 v[182:183], v248 offset:3264
  v_mfma_f32_16x16x32_bf16 v[20:23], v[152:155], a[4:7], 0
  buffer_load_dwordx4 v224, s[20:23], s62 offen offset:2048 sc1 lds
  ds_read_b128 v[152:155], v253 offset:34816
  s_waitcnt lgkmcnt(11)
  v_mfma_f32_16x16x32_bf16 v[24:27], v[156:159], a[0:3], 0
  ds_read_b64_tr_b16 v[184:185], v248 offset:64
  ds_read_b64_tr_b16 v[186:187], v248 offset:1152
  v_mfma_f32_16x16x32_bf16 v[28:31], v[156:159], a[4:7], 0
  ds_read_b128 v[156:159], v253 offset:35840
  ds_read_b64_tr_b16 v[188:189], v248 offset:2240
  s_waitcnt lgkmcnt(14)
  v_mfma_f32_16x16x32_bf16 v[32:35], v[160:163], a[0:3], 0
  ds_read_b64_tr_b16 v[190:191], v248 offset:3328
  s_lshl_b32 s63, s3, 8
  s_add_u32 s63, s63, 61440
  v_and_b32 v238, 31, v249
  v_lshlrev_b32 v238, 2, v238
  v_add_u32 v238, s63, v238
  v_mfma_f32_16x16x32_bf16 v[36:39], v[160:163], a[4:7], 0
  buffer_load_dwordx4 v224, s[20:23], s62 offen offset:3072 sc1 lds
  ds_read_b128 v[160:163], v253 offset:36864
  s_waitcnt lgkmcnt(15)
  v_mfma_f32_16x16x32_bf16 v[40:43], v[164:167], a[0:3], 0
  s_add_u32 s62, s79, 299008
  s_add_u32 m0, s6, 4096
  v_mfma_f32_16x16x32_bf16 v[44:47], v[164:167], a[4:7], 0
  ds_read_b128 v[164:167], v253 offset:37888
  ds_read_b32 v200, v238
  s_waitcnt lgkmcnt(15)
  v_mfma_f32_16x16x32_bf16 v[48:51], v[168:171], a[0:3], 0
  ds_read_b32 v201, v238 offset:128
  s_waitcnt vmcnt(11)
  v_cmp_eq_u32 vcc, 1, v242
  s_nop 1
  s_cmp_eq_u64 vcc, exec
  s_cbranch_scc1 L_ok_7
  s_mov_b32 s82, 0
L_spin_8:
  buffer_load_dword v242, v241, s[20:23], s70 offen sc1
  s_add_u32 s82, s82, 1
  s_waitcnt vmcnt(0)
  v_cmp_eq_u32 vcc, 1, v242
  s_nop 4
  s_cmp_ge_u32 s82, 0x40000
  s_cbranch_scc1 L_ok_7
  s_cmp_eq_u64 vcc, exec
  s_cbranch_scc0 L_spin_8
L_ok_7:
  v_mfma_f32_16x16x32_bf16 v[52:55], v[168:171], a[4:7], 0
  buffer_load_dwordx4 v224, s[20:23], s62 offen offset:0 sc1 lds
  ds_read_b128 v[168:171], v253 offset:38912
  v_mfma_f32_16x16x32_bf16 v[56:59], v[172:175], a[0:3], 0
  s_add_u32 s63, s75, 0
  buffer_load_dwordx4 v[96:99], v224, s[20:23], s63 offen sc1
  v_mfma_f32_16x16x32_bf16 v[60:63], v[172:175], a[4:7], 0
  ds_read_b128 v[172:175], v253 offset:39936
  s_add_u32 s63, s75, 3072
  buffer_load_dwordx4 v[100:103], v224, s[20:23], s63 offen sc1
  s_waitcnt lgkmcnt(15)
  v_mfma_f32_16x16x32_bf16 v[128:131], v[144:147], a[0:3], 0
  s_add_u32 s63, s75, 6144
  buffer_load_dwordx4 v[104:107], v224, s[20:23], s63 offen sc1
  v_mfma_f32_16x16x32_bf16 v[132:135], v[144:147], a[4:7], 0
  buffer_load_dwordx4 v224, s[20:23], s62 offen offset:1024 sc1 lds
  ds_read_b128 v[144:147], v253 offset:40960
  s_waitcnt lgkmcnt(15)
  v_mfma_f32_16x16x32_bf16 v[0:3], v[148:151], a[8:11], v[0:3]
  s_add_u32 s63, s75, 9216
  buffer_load_dwordx4 v[108:111], v224, s[20:23], s63 offen sc1
  v_mfma_f32_16x16x32_bf16 v[4:7], v[148:151], a[12:15], v[4:7]
  ds_read_b128 v[148:151], v253 offset:41984
  s_add_u32 s63, s75, 12288
  buffer_load_dwordx4 v[112:115], v224, s[20:23], s63 offen sc1
  s_waitcnt lgkmcnt(13)
  v_mfma_f32_16x16x32_bf16 v[8:11], v[152:155], a[8:11], v[8:11]
  s_add_u32 s63, s75, 15360
  buffer_load_dwordx4 v[116:119], v224, s[20:23], s63 offen sc1
  v_mfma_f32_16x16x32_bf16 v[12:15], v[152:155], a[12:15], v[12:15]
  buffer_load_dwordx4 v224, s[20:23], s62 offen offset:2048 sc1 lds
  ds_read_b128 v[152:155], v253 offset:43008
  s_waitcnt lgkmcnt(11)
  v_mfma_f32_16x16x32_bf16 v[16:19], v[156:159], a[8:11], v[16:19]
  s_add_u32 s63, s75, 18432
  buffer_load_dwordx4 v[120:123], v224, s[20:23], s63 offen sc1
  v_mfma_f32_16x16x32_bf16 v[20:23], v[156:159], a[12:15], v[20:23]
  ds_read_b128 v[156:159], v253 offset:44032
  s_add_u32 s63, s75, 21504
  buffer_load_dwordx4 v[124:127], v224, s[20:23], s63 offen sc1
  s_waitcnt lgkmcnt(9)
  v_mfma_f32_16x16x32_bf16 v[24:27], v[160:163], a[8:11], v[24:27]
  v_mul_f32 v208, 0xbfb8aa3b, v64
  v_mul_f32 v209, 0xbfb8aa3b, v65
  v_mfma_f32_16x16x32_bf16 v[28:31], v[160:163], a[12:15], v[28:31]
  buffer_load_dwordx4 v224, s[20:23], s62 offen offset:3072 sc1 lds
  ds_read_b128 v[160:163], v253 offset:45056
  s_waitcnt lgkmcnt(9)
  v_mfma_f32_16x16x32_bf16 v[32:35], v[164:167], a[8:11], v[32:35]
  s_add_u32 s62, s79, 303104
  s_add_u32 m0, s6, 8192
  v_mfma_f32_16x16x32_bf16 v[36:39], v[164:167], a[12:15], v[36:39]
  ds_read_b128 v[164:167], v253 offset:46080
  v_mul_f32 v210, 0xbfb8aa3b, v66
  s_waitcnt lgkmcnt(7)
  v_mfma_f32_16x16x32_bf16 v[40:43], v[168:171], a[8:11], v[40:43]
  v_mul_f32 v211, 0xbfb8aa3b, v67
  v_exp_f32 v208, v208
  v_mfma_f32_16x16x32_bf16 v[44:47], v[168:171], a[12:15], v[44:47]
  buffer_load_dwordx4 v224, s[20:23], s62 offen offset:0 sc1 lds
  ds_read_b128 v[168:171], v253 offset:47104
  s_waitcnt lgkmcnt(7)
  v_mfma_f32_16x16x32_bf16 v[48:51], v[172:175], a[8:11], v[48:51]
  s_add_u32 s0, s78, 8192
  v_mfma_f32_16x16x32_bf16 v[52:55], v[172:175], a[12:15], v[52:55]
  ds_read_b128 v[172:175], v253 offset:48128
  v_exp_f32 v209, v209
  s_waitcnt lgkmcnt(7)
  v_mfma_f32_16x16x32_bf16 v[56:59], v[144:147], a[8:11], v[56:59]
  v_exp_f32 v210, v210
  v_exp_f32 v211, v211
  v_mfma_f32_16x16x32_bf16 v[60:63], v[144:147], a[12:15], v[60:63]
  buffer_load_dwordx4 a[32:35], v224, s[20:23], s0 offen sc1
  ds_read_b128 v[144:147], v253 offset:49152
  s_waitcnt lgkmcnt(7)
  v_mfma_f32_16x16x32_bf16 v[128:131], v[148:151], a[8:11], v[128:131]
  v_add_f32 v208, 1.0, v208
  v_add_f32 v209, 1.0, v209
  v_mfma_f32_16x16x32_bf16 v[132:135], v[148:151], a[12:15], v[132:135]
  ds_read_b128 v[148:151], v253 offset:50176
  v_add_f32 v210, 1.0, v210
  s_waitcnt lgkmcnt(7)
  v_mfma_f32_16x16x32_bf16 v[0:3], v[152:155], a[16:19], v[0:3]
  v_add_f32 v211, 1.0, v211
  v_rcp_f32 v208, v208
  v_mfma_f32_16x16x32_bf16 v[4:7], v[152:155], a[20:23], v[4:7]
  buffer_load_dwordx4 a[36:39], v224, s[20:23], s0 offen offset:1024 sc1
  ds_read_b128 v[152:155], v253 offset:51200
  s_waitcnt lgkmcnt(7)
  v_mfma_f32_16x16x32_bf16 v[8:11], v[156:159], a[16:19], v[8:11]
  s_add_u32 s0, s78, 10240
  v_mfma_f32_16x16x32_bf16 v[12:15], v[156:159], a[20:23], v[12:15]
  ds_read_b128 v[156:159], v253 offset:52224
  v_rcp_f32 v209, v209
  s_waitcnt lgkmcnt(7)
  v_mfma_f32_16x16x32_bf16 v[16:19], v[160:163], a[16:19], v[16:19]
  v_rcp_f32 v210, v210
  v_rcp_f32 v211, v211
  v_mfma_f32_16x16x32_bf16 v[20:23], v[160:163], a[20:23], v[20:23]
  buffer_load_dwordx4 a[40:43], v224, s[20:23], s0 offen sc1
  ds_read_b128 v[160:163], v253 offset:53248
  s_waitcnt lgkmcnt(7)
  v_mfma_f32_16x16x32_bf16 v[24:27], v[164:167], a[16:19], v[24:27]
  v_mul_f32 v208, v64, v208
  v_mul_f32 v209, v65, v209
  v_mfma_f32_16x16x32_bf16 v[28:31], v[164:167], a[20:23], v[28:31]
  ds_read_b128 v[164:167], v253 offset:54272
  v_mul_f32 v210, v66, v210
  s_waitcnt lgkmcnt(7)
  v_mfma_f32_16x16x32_bf16 v[32:35], v[168:171], a[16:19], v[32:35]
  v_mul_f32 v211, v67, v211
  v_mul_f32 v208, v208, v72
  v_mfma_f32_16x16x32_bf16 v[36:39], v[168:171], a[20:23], v[36:39]
  buffer_load_dwordx4 a[44:47], v224, s[20:23], s0 offen offset:1024 sc1
  ds_read_b128 v[168:171], v253 offset:55296
  s_waitcnt lgkmcnt(7)
  v_mfma_f32_16x16x32_bf16 v[40:43], v[172:175], a[16:19], v[40:43]
  s_add_u32 s0, s78, 12288
  v_mfma_f32_16x16x32_bf16 v[44:47], v[172:175], a[20:23], v[44:47]
  ds_read_b128 v[172:175], v253 offset:56320
  v_mul_f32 v209, v209, v73
  s_waitcnt lgkmcnt(7)
  v_mfma_f32_16x16x32_bf16 v[48:51], v[144:147], a[16:19], v[48:51]
  v_mul_f32 v210, v210, v74
  v_mul_f32 v211, v211, v75
  v_mfma_f32_16x16x32_bf16 v[52:55], v[144:147], a[20:23], v[52:55]
  buffer_load_dwordx4 a[48:51], v224, s[20:23], s0 offen sc1
  ds_read_b128 v[144:147], v253 offset:57344
  s_waitcnt lgkmcnt(7)
  v_mfma_f32_16x16x32_bf16 v[56:59], v[148:151], a[16:19], v[56:59]
  v_cvt_pk_bf16_f32 v216, v208, v209
  v_cvt_pk_bf16_f32 v217, v210, v211
  v_mfma_f32_16x16x32_bf16 v[60:63], v[148:151], a[20:23], v[60:63]
  ds_read_b128 v[148:151], v253 offset:58368
  v_mul_f32 v208, 0xbfb8aa3b, v68
  s_waitcnt lgkmcnt(7)
  v_mfma_f32_16x16x32_bf16 v[128:131], v[152:155], a[16:19], v[128:131]
  v_mul_f32 v209, 0xbfb8aa3b, v69
  v_mul_f32 v210, 0xbfb8aa3b, v70
  v_mfma_f32_16x16x32_bf16 v[132:135], v[152:155], a[20:23], v[132:135]
  buffer_load_dwordx4 a[52:55], v224, s[20:23], s0 offen offset:1024 sc1
  ds_read_b128 v[152:155], v253 offset:59392
  s_waitcnt lgkmcnt(7)
  v_mfma_f32_16x16x32_bf16 v[0:3], v[156:159], a[24:27], v[0:3]
  s_add_u32 s0, s78, 14336
  v_mfma_f32_16x16x32_bf16 v[4:7], v[156:159], a[28:31], v[4:7]
  ds_read_b128 v[156:159], v253 offset:60416
  v_mul_f32 v211, 0xbfb8aa3b, v71
  s_waitcnt lgkmcnt(7)
  v_mfma_f32_16x16x32_bf16 v[8:11], v[160:163], a[24:27], v[8:11]
  v_exp_f32 v208, v208
  v_exp_f32 v209, v209
  v_mfma_f32_16x16x32_bf16 v[12:15], v[160:163], a[28:31], v[12:15]
  buffer_load_dwordx4 a[56:59], v224, s[20:23], s0 offen sc1
  s_waitcnt vmcnt(24)
  s_barrier
  ds_read_b128 v[160:163], v224 offset:0
  s_waitcnt lgkmcnt(7)
  v_mfma_f32_16x16x32_bf16 v[16:19], v[164:167], a[24:27], v[16:19]
  s_lshl_b32 s45, s50, 2
  s_add_u32 s45, s45, s71
  s_add_u32 s45, s45, 32
  s_mov_b64 exec, 1
  buffer_store_dword v251, off, s[20:23], s45 sc1
  s_mov_b64 exec, -1
  v_exp_f32 v210, v210
  v_mfma_f32_16x16x32_bf16 v[20:23], v[164:167], a[28:31], v[20:23]
  buffer_load_dwordx4 a[60:63], v224, s[20:23], s0 offen offset:1024 sc1
  ds_read_b128 v[164:167], v224 offset:1024
  s_waitcnt lgkmcnt(7)
  v_mfma_f32_16x16x32_bf16 v[24:27], v[168:171], a[24:27], v[24:27]
  s_add_u32 s62, s79, 442368
  s_add_u32 m0, s7, 0
  v_mfma_f32_16x16x32_bf16 v[28:31], v[168:171], a[28:31], v[28:31]
  buffer_load_dwordx4 v224, s[20:23], s62 offen offset:0 sc1 lds
  ds_read_b128 v[168:171], v224 offset:2048
  s_waitcnt lgkmcnt(7)
  v_mfma_f32_16x16x32_bf16 v[32:35], v[172:175], a[24:27], v[32:35]
  v_exp_f32 v211, v211
  v_add_f32 v208, 1.0, v208
  v_mfma_f32_16x16x32_bf16 v[36:39], v[172:175], a[28:31], v[36:39]
  ds_read_b128 v[172:175], v224 offset:3072
  v_add_f32 v209, 1.0, v209
  s_waitcnt lgkmcnt(7)
  v_mfma_f32_16x16x32_bf16 v[40:43], v[144:147], a[24:27], v[40:43]
  v_add_f32 v210, 1.0, v210
  v_add_f32 v211, 1.0, v211
  v_mfma_f32_16x16x32_bf16 v[44:47], v[144:147], a[28:31], v[44:47]
  buffer_load_dwordx4 v224, s[20:23], s62 offen offset:1024 sc1 lds
  ds_read_b128 v[144:147], v224 offset:4096
  s_waitcnt lgkmcnt(7)
  v_mfma_f32_16x16x32_bf16 v[48:51], v[148:151], a[24:27], v[48:51]
  v_rcp_f32 v208, v208
  v_rcp_f32 v209, v209
  v_mfma_f32_16x16x32_bf16 v[52:55], v[148:151], a[28:31], v[52:55]
  ds_read_b128 v[148:151], v224 offset:5120
  v_rcp_f32 v210, v210
  s_waitcnt lgkmcnt(7)
  v_mfma_f32_16x16x32_bf16 v[56:59], v[152:155], a[24:27], v[56:59]
  v_rcp_f32 v211, v211
  v_mul_f32 v208, v68, v208
  v_mfma_f32_16x16x32_bf16 v[60:63], v[152:155], a[28:31], v[60:63]
  buffer_load_dwordx4 v224, s[20:23], s62 offen offset:2048 sc1 lds
  ds_read_b128 v[152:155], v224 offset:6144
  s_waitcnt lgkmcnt(7)
  v_mfma_f32_16x16x32_bf16 v[128:131], v[156:159], a[24:27], v[128:131]
  v_mul_f32 v209, v69, v209
  v_mul_f32 v210, v70, v210
  v_mfma_f32_16x16x32_bf16 v[132:135], v[156:159], a[28:31], v[132:135]
  ds_read_b128 v[156:159], v224 offset:7168
  v_mul_f32 v211, v71, v211
  s_waitcnt vmcnt(11) lgkmcnt(7)
  v_mfma_f32_16x16x32_bf16 v[0:3], v[160:163], a[32:35], v[0:3]
  v_add_f32 v96, v96, v100
  v_add_f32 v97, v97, v101
  s_waitcnt vmcnt(10)
  v_mfma_f32_16x16x32_bf16 v[4:7], v[160:163], a[36:39], v[4:7]
  buffer_load_dwordx4 v224, s[20:23], s62 offen offset:3072 sc1 lds
  ds_read_b128 v[160:163], v224 offset:8192
  s_waitcnt lgkmcnt(7)
  v_mfma_f32_16x16x32_bf16 v[8:11], v[164:167], a[32:35], v[8:11]
  s_add_u32 s62, s79, 446464
  s_add_u32 m0, s7, 4096
  v_mfma_f32_16x16x32_bf16 v[12:15], v[164:167], a[36:39], v[12:15]
  ds_read_b128 v[164:167], v224 offset:9216
  v_add_f32 v98, v98, v102
  s_waitcnt lgkmcnt(7)
  v_mfma_f32_16x16x32_bf16 v[16:19], v[168:171], a[32:35], v[16:19]
  v_add_f32 v99, v99, v103
  v_add_f32 v96, v96, v104
  v_mfma_f32_16x16x32_bf16 v[20:23], v[168:171], a[36:39], v[20:23]
  buffer_load_dwordx4 v224, s[20:23], s62 offen offset:0 sc1 lds
  ds_read_b128 v[168:171], v224 offset:10240
  s_waitcnt lgkmcnt(7)
  v_mfma_f32_16x16x32_bf16 v[24:27], v[172:175], a[32:35], v[24:27]
  v_add_f32 v97, v97, v105
  v_add_f32 v98, v98, v106
  v_mfma_f32_16x16x32_bf16 v[28:31], v[172:175], a[36:39], v[28:31]
  ds_read_b128 v[172:175], v224 offset:11264
  v_add_f32 v99, v99, v107
  s_waitcnt lgkmcnt(7)
  v_mfma_f32_16x16x32_bf16 v[32:35], v[144:147], a[32:35], v[32:35]
  v_add_f32 v96, v96, v108
  v_add_f32 v97, v97, v109
  v_mfma_f32_16x16x32_bf16 v[36:39], v[144:147], a[36:39], v[36:39]
  buffer_load_dwordx4 v224, s[20:23], s62 offen offset:1024 sc1 lds
  ds_read_b128 v[144:147], v224 offset:12288
  s_waitcnt lgkmcnt(7)
  v_mfma_f32_16x16x32_bf16 v[40:43], v[148:151], a[32:35], v[40:43]
  v_add_f32 v98, v98, v110
  v_add_f32 v99, v99, v111
  v_mfma_f32_16x16x32_bf16 v[44:47], v[148:151], a[36:39], v[44:47]
  ds_read_b128 v[148:151], v224 offset:13312
  v_add_f32 v96, v96, v112
  s_waitcnt lgkmcnt(7)
  v_mfma_f32_16x16x32_bf16 v[48:51], v[152:155], a[32:35], v[48:51]
  v_add_f32 v97, v97, v113
  v_add_f32 v98, v98, v114
  v_mfma_f32_16x16x32_bf16 v[52:55], v[152:155], a[36:39], v[52:55]
  buffer_load_dwordx4 v224, s[20:23], s62 offen offset:2048 sc1 lds
  ds_read_b128 v[152:155], v224 offset:14336
  s_waitcnt lgkmcnt(7)
  v_mfma_f32_16x16x32_bf16 v[56:59], v[156:159], a[32:35], v[56:59]
  v_add_f32 v99, v99, v115
  v_add_f32 v96, v96, v116
  v_mfma_f32_16x16x32_bf16 v[60:63], v[156:159], a[36:39], v[60:63]
  ds_read_b128 v[156:159], v224 offset:15360
  v_add_f32 v97, v97, v117
  s_waitcnt lgkmcnt(7)
  v_mfma_f32_16x16x32_bf16 v[128:131], v[160:163], a[32:35], v[128:131]
  v_add_f32 v98, v98, v118
  v_add_f32 v99, v99, v119
  v_mfma_f32_16x16x32_bf16 v[132:135], v[160:163], a[36:39], v[132:135]
  buffer_load_dwordx4 v224, s[20:23], s62 offen offset:3072 sc1 lds
  ds_read_b128 v[160:163], v224 offset:16384
  s_waitcnt vmcnt(14) lgkmcnt(7)
  v_mfma_f32_16x16x32_bf16 v[0:3], v[164:167], a[40:43], v[0:3]
  s_add_u32 s62, s79, 450560
  s_add_u32 m0, s7, 8192
  s_waitcnt vmcnt(13)
  v_mfma_f32_16x16x32_bf16 v[4:7], v[164:167], a[44:47], v[4:7]
  ds_read_b128 v[164:167], v224 offset:17408
  v_add_f32 v96, v96, v120
  s_waitcnt lgkmcnt(7)
  v_mfma_f32_16x16x32_bf16 v[8:11], v[168:171], a[40:43], v[8:11]
  v_add_f32 v97, v97, v121
  v_add_f32 v98, v98, v122
  v_mfma_f32_16x16x32_bf16 v[12:15], v[168:171], a[44:47], v[12:15]
  buffer_load_dwordx4 v224, s[20:23], s62 offen offset:0 sc1 lds
  ds_read_b128 v[168:171], v224 offset:18432
  s_waitcnt lgkmcnt(7)
  v_mfma_f32_16x16x32_bf16 v[16:19], v[172:175], a[40:43], v[16:19]
  s_add_u32 s0, s78, 16384
  v_mfma_f32_16x16x32_bf16 v[20:23], v[172:175], a[44:47], v[20:23]
  ds_read_b128 v[172:175], v224 offset:19456
  v_add_f32 v99, v99, v123
  s_waitcnt lgkmcnt(7)
  v_mfma_f32_16x16x32_bf16 v[24:27], v[144:147], a[40:43], v[24:27]
  v_add_f32 v96, v96, v124
  v_add_f32 v97, v97, v125
  v_mfma_f32_16x16x32_bf16 v[28:31], v[144:147], a[44:47], v[28:31]
  buffer_load_dwordx4 a[64:67], v224, s[20:23], s0 offen sc1
  ds_read_b128 v[144:147], v224 offset:20480
  s_waitcnt lgkmcnt(7)
  v_mfma_f32_16x16x32_bf16 v[32:35], v[148:151], a[40:43], v[32:35]
  v_add_f32 v98, v98, v126
  v_add_f32 v99, v99, v127
  v_mfma_f32_16x16x32_bf16 v[36:39], v[148:151], a[44:47], v[36:39]
  ds_read_b128 v[148:151], v224 offset:21504
  s_min_u32 s63, s3, 2
  s_lshl_b32 s63, s63, 10
  s_add_u32 s63, s63, 80896
  v_add_u32 v239, s63, v224
  ds_write_b128 v239, v[96:99]
  s_waitcnt lgkmcnt(8)
  v_mfma_f32_16x16x32_bf16 v[40:43], v[152:155], a[40:43], v[40:43]
  v_mul_f32 v208, v208, v76
  v_mul_f32 v209, v209, v77
  v_mfma_f32_16x16x32_bf16 v[44:47], v[152:155], a[44:47], v[44:47]
  buffer_load_dwordx4 a[68:71], v224, s[20:23], s0 offen offset:1024 sc1
  ds_read_b128 v[152:155], v224 offset:22528
  s_waitcnt lgkmcnt(8)
  v_mfma_f32_16x16x32_bf16 v[48:51], v[156:159], a[40:43], v[48:51]
  s_add_u32 s0, s78, 18432
  v_mfma_f32_16x16x32_bf16 v[52:55], v[156:159], a[44:47], v[52:55]
  ds_read_b128 v[156:159], v224 offset:23552
  v_mul_f32 v210, v210, v78
  s_waitcnt lgkmcnt(8)
  v_mfma_f32_16x16x32_bf16 v[56:59], v[160:163], a[40:43], v[56:59]
  v_mul_f32 v211, v211, v79
  v_cvt_pk_bf16_f32 v218, v208, v209
  v_mfma_f32_16x16x32_bf16 v[60:63], v[160:163], a[44:47], v[60:63]
  buffer_load_dwordx4 a[72:75], v224, s[20:23], s0 offen sc1
  ds_read_b128 v[160:163], v224 offset:24576
  s_waitcnt lgkmcnt(8)
  v_mfma_f32_16x16x32_bf16 v[128:131], v[164:167], a[40:43], v[128:131]
  v_cvt_pk_bf16_f32 v219, v210, v211
  s_add_u32 s63, s76, 0
  buffer_store_dwordx4 v[216:219], v234, s[20:23], s63 offen sc1
  v_mfma_f32_16x16x32_bf16 v[132:135], v[164:167], a[44:47], v[132:135]
  ds_read_b128 v[164:167], v224 offset:25600
  v_mul_f32 v208, 0xbfb8aa3b, v80
  s_waitcnt vmcnt(17) lgkmcnt(8)
  v_mfma_f32_16x16x32_bf16 v[0:3], v[168:171], a[48:51], v[0:3]
  v_mul_f32 v209, 0xbfb8aa3b, v81
  v_mul_f32 v210, 0xbfb8aa3b, v82
  s_waitcnt vmcnt(16)
  v_mfma_f32_16x16x32_bf16 v[4:7], v[168:171], a[52:55], v[4:7]
  buffer_load_dwordx4 a[76:79], v224, s[20:23], s0 offen offset:1024 sc1
  ds_read_b128 v[168:171], v224 offset:26624
  s_waitcnt lgkmcnt(8)
  v_mfma_f32_16x16x32_bf16 v[8:11], v[172:175], a[48:51], v[8:11]
  s_add_u32 s0, s78, 20480
  v_mfma_f32_16x16x32_bf16 v[12:15], v[172:175], a[52:55], v[12:15]
  ds_read_b128 v[172:175], v224 offset:27648
  v_mul_f32 v211, 0xbfb8aa3b, v83
  s_waitcnt lgkmcnt(8)
  v_mfma_f32_16x16x32_bf16 v[16:19], v[144:147], a[48:51], v[16:19]
  v_exp_f32 v208, v208
  v_exp_f32 v209, v209
  v_mfma_f32_16x16x32_bf16 v[20:23], v[144:147], a[52:55], v[20:23]
  buffer_load_dwordx4 a[80:83], v224, s[20:23], s0 offen sc1
  ds_read_b128 v[144:147], v224 offset:28672
  s_waitcnt lgkmcnt(8)
  v_mfma_f32_16x16x32_bf16 v[24:27], v[148:151], a[48:51], v[24:27]
  v_exp_f32 v210, v210
  v_exp_f32 v211, v211
  v_mfma_f32_16x16x32_bf16 v[28:31], v[148:151], a[52:55], v[28:31]
  ds_read_b128 v[148:151], v224 offset:29696
  v_add_f32 v208, 1.0, v208
  s_waitcnt lgkmcnt(7)
  v_mfma_f32_16x16x32_bf16 v[32:35], v[152:155], a[48:51], v[32:35]
  v_add_f32 v209, 1.0, v209
  v_add_f32 v210, 1.0, v210
  v_mfma_f32_16x16x32_bf16 v[36:39], v[152:155], a[52:55], v[36:39]
  buffer_load_dwordx4 a[84:87], v224, s[20:23], s0 offen offset:1024 sc1
  ds_read_b128 v[152:155], v224 offset:30720
  s_waitcnt lgkmcnt(7)
  v_mfma_f32_16x16x32_bf16 v[40:43], v[156:159], a[48:51], v[40:43]
  v_add_f32 v211, 1.0, v211
  v_rcp_f32 v208, v208
  v_mfma_f32_16x16x32_bf16 v[44:47], v[156:159], a[52:55], v[44:47]
  ds_read_b128 v[156:159], v224 offset:31744
  v_rcp_f32 v209, v209
  s_waitcnt lgkmcnt(7)
  v_mfma_f32_16x16x32_bf16 v[48:51], v[160:163], a[48:51], v[48:51]
  v_rcp_f32 v210, v210
  v_rcp_f32 v211, v211
  v_mfma_f32_16x16x32_bf16 v[52:55], v[160:163], a[52:55], v[52:55]
  ds_read_b128 v[160:163], v224 offset:32768
  v_mul_f32 v208, v80, v208
  s_waitcnt lgkmcnt(7)
  v_mfma_f32_16x16x32_bf16 v[56:59], v[164:167], a[48:51], v[56:59]
  v_mul_f32 v209, v81, v209
  v_mul_f32 v210, v82, v210
  v_mfma_f32_16x16x32_bf16 v[60:63], v[164:167], a[52:55], v[60:63]
  ds_read_b128 v[164:167], v224 offset:33792
  v_mul_f32 v211, v83, v211
  s_waitcnt lgkmcnt(7)
  v_mfma_f32_16x16x32_bf16 v[128:131], v[168:171], a[48:51], v[128:131]
  v_mul_f32 v208, v208, v88
  v_mul_f32 v209, v209, v89
  v_mfma_f32_16x16x32_bf16 v[132:135], v[168:171], a[52:55], v[132:135]
  ds_read_b128 v[168:171], v224 offset:34816
  v_mul_f32 v210, v210, v90
  s_waitcnt vmcnt(18) lgkmcnt(7)
  v_mfma_f32_16x16x32_bf16 v[0:3], v[172:175], a[56:59], v[0:3]
  s_add_u32 s0, s78, 22528
  s_waitcnt vmcnt(16)
  v_mfma_f32_16x16x32_bf16 v[4:7], v[172:175], a[60:63], v[4:7]
  ds_read_b128 v[172:175], v224 offset:35840
  v_mul_f32 v211, v211, v91
  s_waitcnt lgkmcnt(7)
  v_mfma_f32_16x16x32_bf16 v[8:11], v[144:147], a[56:59], v[8:11]
  v_cvt_pk_bf16_f32 v220, v208, v209
  v_cvt_pk_bf16_f32 v221, v210, v211
  v_mfma_f32_16x16x32_bf16 v[12:15], v[144:147], a[60:63], v[12:15]
  buffer_load_dwordx4 a[88:91], v224, s[20:23], s0 offen sc1
  s_barrier
  ds_read_b128 v[144:147], v224 offset:36864
  s_waitcnt lgkmcnt(7)
  v_mfma_f32_16x16x32_bf16 v[16:19], v[148:151], a[56:59], v[16:19]
  v_mul_f32 v208, 0xbfb8aa3b, v84
  v_mul_f32 v209, 0xbfb8aa3b, v85
  v_mfma_f32_16x16x32_bf16 v[20:23], v[148:151], a[60:63], v[20:23]
  buffer_load_dwordx4 a[92:95], v224, s[20:23], s0 offen offset:1024 sc1
  ds_read_b128 v[148:151], v224 offset:37888
  s_waitcnt lgkmcnt(7)
  v_mfma_f32_16x16x32_bf16 v[24:27], v[152:155], a[56:59], v[24:27]
  s_add_u32 s62, s79, 589824
  s_add_u32 m0, s4, 0
  v_mfma_f32_16x16x32_bf16 v[28:31], v[152:155], a[60:63], v[28:31]
  buffer_load_dwordx4 v224, s[20:23], s62 offen offset:0 sc1 lds
  ds_read_b128 v[152:155], v224 offset:38912
  s_waitcnt lgkmcnt(7)
  v_mfma_f32_16x16x32_bf16 v[32:35], v[156:159], a[56:59], v[32:35]
  v_mul_f32 v210, 0xbfb8aa3b, v86
  v_mul_f32 v211, 0xbfb8aa3b, v87
  v_mfma_f32_16x16x32_bf16 v[36:39], v[156:159], a[60:63], v[36:39]
  ds_read_b128 v[156:159], v224 offset:39936
  v_exp_f32 v208, v208
  s_waitcnt lgkmcnt(7)
  v_mfma_f32_16x16x32_bf16 v[40:43], v[160:163], a[56:59], v[40:43]
  v_exp_f32 v209, v209
  v_exp_f32 v210, v210
  v_mfma_f32_16x16x32_bf16 v[44:47], v[160:163], a[60:63], v[44:47]
  buffer_load_dwordx4 v224, s[20:23], s62 offen offset:1024 sc1 lds
  ds_read_b128 v[160:163], v224 offset:40960
  s_waitcnt lgkmcnt(7)
  v_mfma_f32_16x16x32_bf16 v[48:51], v[164:167], a[56:59], v[48:51]
  v_exp_f32 v211, v211
  v_add_f32 v208, 1.0, v208
  v_mfma_f32_16x16x32_bf16 v[52:55], v[164:167], a[60:63], v[52:55]
  ds_read_b128 v[164:167], v224 offset:41984
  v_add_f32 v209, 1.0, v209
  s_waitcnt lgkmcnt(7)
  v_mfma_f32_16x16x32_bf16 v[56:59], v[168:171], a[56:59], v[56:59]
  v_add_f32 v210, 1.0, v210
  v_add_f32 v211, 1.0, v211
  v_mfma_f32_16x16x32_bf16 v[60:63], v[168:171], a[60:63], v[60:63]
  buffer_load_dwordx4 v224, s[20:23], s62 offen offset:2048 sc1 lds
  ds_read_b128 v[168:171], v224 offset:43008
  s_waitcnt lgkmcnt(7)
  v_mfma_f32_16x16x32_bf16 v[128:131], v[172:175], a[56:59], v[128:131]
  v_rcp_f32 v208, v208
  v_rcp_f32 v209, v209
  v_mfma_f32_16x16x32_bf16 v[132:135], v[172:175], a[60:63], v[132:135]
  ds_read_b128 v[172:175], v224 offset:44032
  v_rcp_f32 v210, v210
  s_waitcnt vmcnt(11) lgkmcnt(7)
  v_mfma_f32_16x16x32_bf16 v[0:3], v[144:147], a[64:67], v[0:3]
  v_rcp_f32 v211, v211
  v_mul_f32 v208, v84, v208
  s_waitcnt vmcnt(10)
  v_mfma_f32_16x16x32_bf16 v[4:7], v[144:147], a[68:71], v[4:7]
  buffer_load_dwordx4 v224, s[20:23], s62 offen offset:3072 sc1 lds
  ds_read_b128 v[144:147], v224 offset:45056
  s_waitcnt lgkmcnt(7)
  v_mfma_f32_16x16x32_bf16 v[8:11], v[148:151], a[64:67], v[8:11]
  s_add_u32 s62, s79, 593920
  s_add_u32 m0, s4, 4096
  v_mfma_f32_16x16x32_bf16 v[12:15], v[148:151], a[68:71], v[12:15]
  ds_read_b128 v[148:151], v224 offset:46080
  v_mul_f32 v209, v85, v209
  s_waitcnt lgkmcnt(7)
  v_mfma_f32_16x16x32_bf16 v[16:19], v[152:155], a[64:67], v[16:19]
  v_mul_f32 v210, v86, v210
  v_mul_f32 v211, v87, v211
  v_mfma_f32_16x16x32_bf16 v[20:23], v[152:155], a[68:71], v[20:23]
  buffer_load_dwordx4 v224, s[20:23], s62 offen offset:0 sc1 lds
  ds_read_b128 v[152:155], v224 offset:47104
  s_waitcnt lgkmcnt(7)
  v_mfma_f32_16x16x32_bf16 v[24:27], v[156:159], a[64:67], v[24:27]
  v_mul_f32 v208, v208, v92
  v_mul_f32 v209, v209, v93
  v_mfma_f32_16x16x32_bf16 v[28:31], v[156:159], a[68:71], v[28:31]
  ds_read_b128 v[156:159], v224 offset:48128
  v_mul_f32 v210, v210, v94
  s_waitcnt lgkmcnt(7)
  v_mfma_f32_16x16x32_bf16 v[32:35], v[160:163], a[64:67], v[32:35]
  v_mul_f32 v211, v211, v95
  v_cvt_pk_bf16_f32 v222, v208, v209
  v_mfma_f32_16x16x32_bf16 v[36:39], v[160:163], a[68:71], v[36:39]
  buffer_load_dwordx4 v224, s[20:23], s62 offen offset:1024 sc1 lds
  ds_read_b128 v[160:163], v224 offset:49152
  s_waitcnt lgkmcnt(7)
  v_mfma_f32_16x16x32_bf16 v[40:43], v[164:167], a[64:67], v[40:43]
  v_cvt_pk_bf16_f32 v223, v210, v211
  s_add_u32 s63, s76, 86016
  buffer_store_dwordx4 v[220:223], v234, s[20:23], s63 offen sc1
  v_mfma_f32_16x16x32_bf16 v[44:47], v[164:167], a[68:71], v[44:47]
  ds_read_b128 v[164:167], v224 offset:50176
  v_add_u32 v239, 80896, v224
  s_waitcnt lgkmcnt(7)
  v_mfma_f32_16x16x32_bf16 v[48:51], v[168:171], a[64:67], v[48:51]
  ds_read_b128 v[96:99], v239 offset:0
  ds_read_b128 v[100:103], v239 offset:1024
  v_mfma_f32_16x16x32_bf16 v[52:55], v[168:171], a[68:71], v[52:55]
  buffer_load_dwordx4 v224, s[20:23], s62 offen offset:2048 sc1 lds
  ds_read_b128 v[168:171], v224 offset:51200
  s_waitcnt lgkmcnt(9)
  v_mfma_f32_16x16x32_bf16 v[56:59], v[172:175], a[64:67], v[56:59]
  ds_read_b128 v[104:107], v239 offset:2048
  v_mov_b32 v198, 0
  v_mfma_f32_16x16x32_bf16 v[60:63], v[172:175], a[68:71], v[60:63]
  ds_read_b128 v[172:175], v224 offset:52224
  v_mov_b32 v199, 0
  s_waitcnt lgkmcnt(10)
  v_mfma_f32_16x16x32_bf16 v[128:131], v[144:147], a[64:67], v[128:131]
  v_mfma_f32_16x16x32_bf16 v[132:135], v[144:147], a[68:71], v[132:135]
  buffer_load_dwordx4 v224, s[20:23], s62 offen offset:3072 sc1 lds
  ds_read_b128 v[144:147], v224 offset:53248
  s_waitcnt vmcnt(15) lgkmcnt(10)
  v_mfma_f32_16x16x32_bf16 v[0:3], v[148:151], a[72:75], v[0:3]
  s_add_u32 s62, s79, 598016
  s_add_u32 m0, s4, 8192
  s_waitcnt vmcnt(13)
  v_mfma_f32_16x16x32_bf16 v[4:7], v[148:151], a[76:79], v[4:7]
  ds_read_b128 v[148:151], v224 offset:54272
  s_waitcnt lgkmcnt(6)
  v_cvt_pk_bf16_f32 v192, v96, v97
  v_mfma_f32_16x16x32_bf16 v[8:11], v[152:155], a[72:75], v[8:11]
  v_cvt_pk_bf16_f32 v193, v98, v99
  s_waitcnt lgkmcnt(5)
  v_cvt_pk_bf16_f32 v194, v100, v101
  v_mfma_f32_16x16x32_bf16 v[12:15], v[152:155], a[76:79], v[12:15]
  buffer_load_dwordx4 v224, s[20:23], s62 offen offset:0 sc1 lds
  ds_read_b128 v[152:155], v224 offset:62464
  v_mfma_f32_16x16x32_bf16 v[16:19], v[156:159], a[72:75], v[16:19]
  s_add_u32 s0, s78, 24576
  v_mfma_f32_16x16x32_bf16 v[20:23], v[156:159], a[76:79], v[20:23]
  ds_read_b128 v[156:159], v224 offset:63488
  v_cvt_pk_bf16_f32 v195, v102, v103
  v_mfma_f32_16x16x32_bf16 v[24:27], v[160:163], a[72:75], v[24:27]
  s_waitcnt lgkmcnt(5)
  v_cvt_pk_bf16_f32 v196, v104, v105
  v_cvt_pk_bf16_f32 v197, v106, v107
  v_mfma_f32_16x16x32_bf16 v[28:31], v[160:163], a[76:79], v[28:31]
  buffer_load_dwordx4 a[96:99], v224, s[20:23], s0 offen sc1
  ds_read_b128 v[160:163], v224 offset:64512
  v_mfma_f32_16x16x32_bf16 v[32:35], v[164:167], a[72:75], v[32:35]
  v_mfma_f32_16x16x32_bf16 v[36:39], v[164:167], a[76:79], v[36:39]
  ds_read_b128 v[164:167], v253 offset:0
  v_mfma_f32_32x32x16_bf16 v[64:79], v[192:195], v[176:179], 0
  v_mfma_f32_16x16x32_bf16 v[40:43], v[168:171], a[72:75], v[40:43]
  v_mfma_f32_32x32x16_bf16 v[80:95], v[192:195], v[184:187], 0
  v_mfma_f32_16x16x32_bf16 v[44:47], v[168:171], a[76:79], v[44:47]
  buffer_load_dwordx4 a[100:103], v224, s[20:23], s0 offen offset:1024 sc1
  ds_read_b128 v[168:171], v253 offset:1024
  s_waitcnt lgkmcnt(7)
  v_mfma_f32_16x16x32_bf16 v[48:51], v[172:175], a[72:75], v[48:51]
  s_add_u32 s0, s78, 26624
  v_mfma_f32_16x16x32_bf16 v[52:55], v[172:175], a[76:79], v[52:55]
  ds_read_b128 v[172:175], v253 offset:2048
  s_waitcnt lgkmcnt(7)
  v_mfma_f32_16x16x32_bf16 v[56:59], v[144:147], a[72:75], v[56:59]
  v_mfma_f32_32x32x16_bf16 v[64:79], v[196:199], v[180:183], v[64:79]
  v_mfma_f32_16x16x32_bf16 v[60:63], v[144:147], a[76:79], v[60:63]
  buffer_load_dwordx4 a[104:107], v224, s[20:23], s0 offen sc1
  ds_read_b128 v[144:147], v253 offset:3072
  s_waitcnt lgkmcnt(7)
  v_mfma_f32_16x16x32_bf16 v[128:131], v[148:151], a[72:75], v[128:131]
  v_mfma_f32_32x32x16_bf16 v[80:95], v[196:199], v[188:191], v[80:95]
  v_mfma_f32_16x16x32_bf16 v[132:135], v[148:151], a[76:79], v[132:135]
  ds_read_b128 v[148:151], v253 offset:4096
  s_waitcnt vmcnt(16) lgkmcnt(7)
  v_mfma_f32_16x16x32_bf16 v[0:3], v[152:155], a[80:83], v[0:3]
  buffer_load_dword v242, v241, s[20:23], s100 offen sc1
  s_waitcnt vmcnt(16)
  v_mfma_f32_16x16x32_bf16 v[4:7], v[152:155], a[84:87], v[4:7]
  buffer_load_dwordx4 a[108:111], v224, s[20:23], s0 offen offset:1024 sc1
  ds_read_b128 v[152:155], v253 offset:5120
  s_waitcnt lgkmcnt(7)
  v_mfma_f32_16x16x32_bf16 v[8:11], v[156:159], a[80:83], v[8:11]
  s_add_u32 s0, s78, 28672
  v_mfma_f32_16x16x32_bf16 v[12:15], v[156:159], a[84:87], v[12:15]
  ds_read_b128 v[156:159], v253 offset:6144
  s_waitcnt lgkmcnt(7)
  v_mfma_f32_16x16x32_bf16 v[16:19], v[160:163], a[80:83], v[16:19]
  v_mfma_f32_16x16x32_bf16 v[20:23], v[160:163], a[84:87], v[20:23]
  buffer_load_dwordx4 a[112:115], v224, s[20:23], s0 offen sc1
  ds_read_b128 v[160:163], v253 offset:7168
  s_waitcnt lgkmcnt(7)
  v_mfma_f32_16x16x32_bf16 v[24:27], v[164:167], a[80:83], v[24:27]
  v_cndmask_b32 v202, v72, v74, s[92:93]
  v_mfma_f32_16x16x32_bf16 v[28:31], v[164:167], a[84:87], v[28:31]
  ds_read_b128 v[164:167], v253 offset:8192
  v_add_f32 v202, 0x358637bd, v202
  s_waitcnt lgkmcnt(7)
  v_mfma_f32_16x16x32_bf16 v[32:35], v[168:171], a[80:83], v[32:35]
  v_rcp_f32 v202, v202
  v_mov_b32 v113, 0
  v_mfma_f32_16x16x32_bf16 v[36:39], v[168:171], a[84:87], v[36:39]
  buffer_load_dwordx4 a[116:119], v224, s[20:23], s0 offen offset:1024 sc1
  ds_read_b128 v[168:171], v253 offset:9216
  s_waitcnt lgkmcnt(7)
  v_mfma_f32_16x16x32_bf16 v[40:43], v[172:175], a[80:83], v[40:43]
  v_mul_f32 v202, v202, v200
  v_mul_f32 v208, v202, v64
  v_mfma_f32_16x16x32_bf16 v[44:47], v[172:175], a[84:87], v[44:47]
  ds_read_b128 v[172:175], v253 offset:10240
  v_mul_f32 v209, v202, v65
  s_waitcnt lgkmcnt(7)
  v_mfma_f32_16x16x32_bf16 v[48:51], v[144:147], a[80:83], v[48:51]
  v_mul_f32 v210, v202, v66
  v_mul_f32 v211, v202, v67
  v_mfma_f32_16x16x32_bf16 v[52:55], v[144:147], a[84:87], v[52:55]
  ds_read_b128 v[144:147], v253 offset:11264
  v_cvt_pk_bf16_f32 v108, v208, v209
  s_waitcnt lgkmcnt(7)
  v_mfma_f32_16x16x32_bf16 v[56:59], v[148:151], a[80:83], v[56:59]
  v_cvt_pk_bf16_f32 v109, v210, v211
  v_mul_f32 v208, v202, v68
  v_mfma_f32_16x16x32_bf16 v[60:63], v[148:151], a[84:87], v[60:63]
  ds_read_b128 v[148:151], v253 offset:12288
  v_mul_f32 v209, v202, v69
  s_waitcnt lgkmcnt(7)
  v_mfma_f32_16x16x32_bf16 v[128:131], v[152:155], a[80:83], v[128:131]
  v_mul_f32 v210, v202, v70
  v_mul_f32 v211, v202, v71
  v_mfma_f32_16x16x32_bf16 v[132:135], v[152:155], a[84:87], v[132:135]
  ds_read_b128 v[152:155], v253 offset:13312
  v_cvt_pk_bf16_f32 v110, v208, v209
  s_waitcnt vmcnt(18) lgkmcnt(7)
  v_mfma_f32_16x16x32_bf16 v[0:3], v[156:159], a[88:91], v[0:3]
  s_add_u32 s0, s78, 30720
  s_waitcnt vmcnt(17)
  v_mfma_f32_16x16x32_bf16 v[4:7], v[156:159], a[92:95], v[4:7]
  ds_read_b128 v[156:159], v253 offset:14336
  v_cvt_pk_bf16_f32 v111, v210, v211
  s_waitcnt lgkmcnt(7)
  v_mfma_f32_16x16x32_bf16 v[8:11], v[160:163], a[88:91], v[8:11]
  v_mul_f32 v208, v202, v72
  v_mul_f32 v209, v202, v73
  v_mfma_f32_16x16x32_bf16 v[12:15], v[160:163], a[92:95], v[12:15]
  buffer_load_dwordx4 a[120:123], v224, s[20:23], s0 offen sc1
  s_barrier
  ds_read_b128 v[160:163], v253 offset:61440
  s_waitcnt lgkmcnt(7)
  v_mfma_f32_16x16x32_bf16 v[16:19], v[164:167], a[88:91], v[16:19]
  v_mov_b32 v114, 0
  v_mov_b32 v115, 0
  v_mfma_f32_16x16x32_bf16 v[20:23], v[164:167], a[92:95], v[20:23]
  buffer_load_dwordx4 a[124:127], v224, s[20:23], s0 offen offset:1024 sc1
  ds_read_b128 v[164:167], v253 offset:62464
  s_waitcnt lgkmcnt(7)
  v_mfma_f32_16x16x32_bf16 v[24:27], v[168:171], a[88:91], v[24:27]
  s_add_u32 s62, s79, 737280
  s_add_u32 m0, s5, 0
  v_mfma_f32_16x16x32_bf16 v[28:31], v[168:171], a[92:95], v[28:31]
  buffer_load_dwordx4 v224, s[20:23], s62 offen offset:0 sc1 lds
  ds_read_b128 v[168:171], v253 offset:63488
  s_waitcnt lgkmcnt(7)
  v_mfma_f32_16x16x32_bf16 v[32:35], v[172:175], a[88:91], v[32:35]
  v_cvt_pk_bf16_f32 v112, v208, v209
  v_permlane32_swap_b32 v108, v110
  v_mfma_f32_16x16x32_bf16 v[36:39], v[172:175], a[92:95], v[36:39]
  ds_read_b128 v[172:175], v253 offset:64512
  v_permlane32_swap_b32 v109, v111
  s_waitcnt lgkmcnt(7)
  v_mfma_f32_16x16x32_bf16 v[40:43], v[144:147], a[88:91], v[40:43]
  s_add_u32 s63, s77, 73728
  buffer_store_dwordx4 v[108:111], v240, s[20:23], s63 offen sc1
  v_mfma_f32_16x16x32_bf16 v[44:47], v[144:147], a[92:95], v[44:47]
  buffer_load_dwordx4 v224, s[20:23], s62 offen offset:1024 sc1 lds
  ds_read_b128 v[144:147], v254 offset:0
  s_waitcnt lgkmcnt(7)
  v_mfma_f32_16x16x32_bf16 v[48:51], v[148:151], a[88:91], v[48:51]
  s_add_u32 s63, s77, 73728
  s_mov_b32 exec_hi, 0
  buffer_store_dwordx4 v[112:115], v244, s[20:23], s63 offen sc1
  s_mov_b64 exec, -1
  v_mfma_f32_16x16x32_bf16 v[52:55], v[148:151], a[92:95], v[52:55]
  ds_read_b128 v[148:151], v254 offset:1024
  v_cndmask_b32 v202, v88, v90, s[92:93]
  s_waitcnt lgkmcnt(7)
  v_mfma_f32_16x16x32_bf16 v[56:59], v[152:155], a[88:91], v[56:59]
  v_add_f32 v202, 0x358637bd, v202
  v_rcp_f32 v202, v202
  v_mfma_f32_16x16x32_bf16 v[60:63], v[152:155], a[92:95], v[60:63]
  buffer_load_dwordx4 v224, s[20:23], s62 offen offset:2048 sc1 lds
  ds_read_b128 v[152:155], v254 offset:2048
  s_waitcnt lgkmcnt(7)
  v_mfma_f32_16x16x32_bf16 v[128:131], v[156:159], a[88:91], v[128:131]
  v_mov_b32 v121, 0
  v_mul_f32 v202, v202, v201
  v_mfma_f32_16x16x32_bf16 v[132:135], v[156:159], a[92:95], v[132:135]
  ds_read_b128 v[156:159], v254 offset:3072
  v_mul_f32 v208, v202, v80
  s_waitcnt vmcnt(13) lgkmcnt(7)
  v_mfma_f32_16x16x32_bf16 v[0:3], v[160:163], a[96:99], v[0:3]
  v_mul_f32 v209, v202, v81
  v_mul_f32 v210, v202, v82
  s_waitcnt vmcnt(12)
  v_mfma_f32_16x16x32_bf16 v[4:7], v[160:163], a[100:103], v[4:7]
  buffer_load_dwordx4 v224, s[20:23], s62 offen offset:3072 sc1 lds
  ds_read_b128 v[160:163], v254 offset:4096
  s_waitcnt lgkmcnt(7)
  v_mfma_f32_16x16x32_bf16 v[8:11], v[164:167], a[96:99], v[8:11]
  s_add_u32 s62, s79, 741376
  s_add_u32 m0, s5, 4096
  v_mfma_f32_16x16x32_bf16 v[12:15], v[164:167], a[100:103], v[12:15]
  ds_read_b128 v[164:167], v254 offset:5120
  v_mul_f32 v211, v202, v83
  s_waitcnt lgkmcnt(7)
  v_mfma_f32_16x16x32_bf16 v[16:19], v[168:171], a[96:99], v[16:19]
  v_cvt_pk_bf16_f32 v116, v208, v209
  v_cvt_pk_bf16_f32 v117, v210, v211
  v_mfma_f32_16x16x32_bf16 v[20:23], v[168:171], a[100:103], v[20:23]
  buffer_load_dwordx4 v224, s[20:23], s62 offen offset:0 sc1 lds
  ds_read_b128 v[168:171], v254 offset:6144
  s_waitcnt lgkmcnt(7)
  v_mfma_f32_16x16x32_bf16 v[24:27], v[172:175], a[96:99], v[24:27]
  v_mul_f32 v208, v202, v84
  v_mul_f32 v209, v202, v85
  v_mfma_f32_16x16x32_bf16 v[28:31], v[172:175], a[100:103], v[28:31]
  ds_read_b128 v[172:175], v254 offset:7168
  v_mul_f32 v210, v202, v86
  s_waitcnt lgkmcnt(7)
  v_mfma_f32_16x16x32_bf16 v[32:35], v[144:147], a[96:99], v[32:35]
  v_mul_f32 v211, v202, v87
  v_cvt_pk_bf16_f32 v118, v208, v209
  v_mfma_f32_16x16x32_bf16 v[36:39], v[144:147], a[100:103], v[36:39]
  buffer_load_dwordx4 v224, s[20:23], s62 offen offset:1024 sc1 lds
  ds_read_b128 v[144:147], v254 offset:8192
  s_waitcnt lgkmcnt(7)
  v_mfma_f32_16x16x32_bf16 v[40:43], v[148:151], a[96:99], v[40:43]
  v_cvt_pk_bf16_f32 v119, v210, v211
  v_mul_f32 v208, v202, v88
  v_mfma_f32_16x16x32_bf16 v[44:47], v[148:151], a[100:103], v[44:47]
  ds_read_b128 v[148:151], v254 offset:9216
  v_mul_f32 v209, v202, v89
  s_waitcnt lgkmcnt(7)
  v_mfma_f32_16x16x32_bf16 v[48:51], v[152:155], a[96:99], v[48:51]
  v_mov_b32 v122, 0
  v_mov_b32 v123, 0
  v_mfma_f32_16x16x32_bf16 v[52:55], v[152:155], a[100:103], v[52:55]
  buffer_load_dwordx4 v224, s[20:23], s62 offen offset:2048 sc1 lds
  ds_read_b128 v[152:155], v254 offset:10240
  s_waitcnt lgkmcnt(7)
  v_mfma_f32_16x16x32_bf16 v[56:59], v[156:159], a[96:99], v[56:59]
  v_cvt_pk_bf16_f32 v120, v208, v209
  v_permlane32_swap_b32 v116, v118
  v_mfma_f32_16x16x32_bf16 v[60:63], v[156:159], a[100:103], v[60:63]
  ds_read_b128 v[156:159], v254 offset:11264
  v_permlane32_swap_b32 v117, v119
  s_waitcnt lgkmcnt(7)
  v_mfma_f32_16x16x32_bf16 v[128:131], v[160:163], a[96:99], v[128:131]
  s_add_u32 s63, s77, 159744
  buffer_store_dwordx4 v[116:119], v240, s[20:23], s63 offen sc1
  v_mfma_f32_16x16x32_bf16 v[132:135], v[160:163], a[100:103], v[132:135]
  buffer_load_dwordx4 v224, s[20:23], s62 offen offset:3072 sc1 lds
  ds_read_b128 v[160:163], v254 offset:12288
  s_waitcnt vmcnt(17) lgkmcnt(7)
  v_mfma_f32_16x16x32_bf16 v[0:3], v[164:167], a[104:107], v[0:3]
  s_add_u32 s62, s79, 745472
  s_add_u32 m0, s5, 8192
  s_waitcnt vmcnt(15)
  v_mfma_f32_16x16x32_bf16 v[4:7], v[164:167], a[108:111], v[4:7]
  ds_read_b128 v[164:167], v254 offset:13312
  s_add_u32 s63, s77, 159744
  s_mov_b32 exec_hi, 0
  buffer_store_dwordx4 v[120:123], v244, s[20:23], s63 offen sc1
  s_mov_b64 exec, -1
  s_waitcnt lgkmcnt(7)
  v_mfma_f32_16x16x32_bf16 v[8:11], v[168:171], a[104:107], v[8:11]
  v_mfma_f32_16x16x32_bf16 v[12:15], v[168:171], a[108:111], v[12:15]
  buffer_load_dwordx4 v224, s[20:23], s62 offen offset:0 sc1 lds
  ds_read_b128 v[168:171], v254 offset:14336
  s_waitcnt lgkmcnt(7)
  v_mfma_f32_16x16x32_bf16 v[16:19], v[172:175], a[104:107], v[16:19]
  v_cmp_eq_u32 vcc, 1, v242
  s_nop 1
  s_cmp_eq_u64 vcc, exec
  s_cbranch_scc1 L_ok_9
  s_mov_b32 s82, 0
L_spin_10:
  buffer_load_dword v242, v241, s[20:23], s100 offen sc1
  s_add_u32 s82, s82, 1
  s_waitcnt vmcnt(0)
  v_cmp_eq_u32 vcc, 1, v242
  s_nop 4
  s_cmp_ge_u32 s82, 0x40000
  s_cbranch_scc1 L_ok_9
  s_cmp_eq_u64 vcc, exec
  s_cbranch_scc0 L_spin_10
L_ok_9:
  v_mfma_f32_16x16x32_bf16 v[20:23], v[172:175], a[108:111], v[20:23]
  s_add_u32 s0, s78, 32768
  ds_read_b128 v[172:175], v254 offset:15360
  s_waitcnt lgkmcnt(7)
  v_mfma_f32_16x16x32_bf16 v[24:27], v[144:147], a[104:107], v[24:27]
  v_mfma_f32_16x16x32_bf16 v[28:31], v[144:147], a[108:111], v[28:31]
  buffer_load_dwordx4 a[0:3], v224, s[20:23], s0 offen sc1
  ds_read_b128 v[144:147], v254 offset:16384
  s_waitcnt lgkmcnt(7)
  v_mfma_f32_16x16x32_bf16 v[32:35], v[148:151], a[104:107], v[32:35]
  v_mfma_f32_16x16x32_bf16 v[36:39], v[148:151], a[108:111], v[36:39]
  ds_read_b128 v[148:151], v254 offset:17408
  s_waitcnt lgkmcnt(7)
  v_mfma_f32_16x16x32_bf16 v[40:43], v[152:155], a[104:107], v[40:43]
  v_mfma_f32_16x16x32_bf16 v[44:47], v[152:155], a[108:111], v[44:47]
  buffer_load_dwordx4 a[4:7], v224, s[20:23], s0 offen offset:1024 sc1
  ds_read_b128 v[152:155], v254 offset:18432
  s_waitcnt lgkmcnt(7)
  v_mfma_f32_16x16x32_bf16 v[48:51], v[156:159], a[104:107], v[48:51]
  s_add_u32 s0, s78, 34816
  v_mfma_f32_16x16x32_bf16 v[52:55], v[156:159], a[108:111], v[52:55]
  ds_read_b128 v[156:159], v254 offset:19456
  s_waitcnt lgkmcnt(7)
  v_mfma_f32_16x16x32_bf16 v[56:59], v[160:163], a[104:107], v[56:59]
  v_mfma_f32_16x16x32_bf16 v[60:63], v[160:163], a[108:111], v[60:63]
  buffer_load_dwordx4 a[8:11], v224, s[20:23], s0 offen sc1
  ds_read_b128 v[160:163], v254 offset:20480
  s_waitcnt lgkmcnt(7)
  v_mfma_f32_16x16x32_bf16 v[128:131], v[164:167], a[104:107], v[128:131]
  v_mfma_f32_16x16x32_bf16 v[132:135], v[164:167], a[108:111], v[132:135]
  ds_read_b128 v[164:167], v254 offset:21504
  s_waitcnt vmcnt(19) lgkmcnt(7)
  v_mfma_f32_16x16x32_bf16 v[0:3], v[168:171], a[112:115], v[0:3]
  s_waitcnt vmcnt(18)
  v_mfma_f32_16x16x32_bf16 v[4:7], v[168:171], a[116:119], v[4:7]
  buffer_load_dwordx4 a[12:15], v224, s[20:23], s0 offen offset:1024 sc1
  ds_read_b128 v[168:171], v254 offset:22528
  s_waitcnt lgkmcnt(7)
  v_mfma_f32_16x16x32_bf16 v[8:11], v[172:175], a[112:115], v[8:11]
  s_add_u32 s0, s78, 36864
  v_mfma_f32_16x16x32_bf16 v[12:15], v[172:175], a[116:119], v[12:15]
  ds_read_b128 v[172:175], v254 offset:23552
  s_waitcnt lgkmcnt(7)
  v_mfma_f32_16x16x32_bf16 v[16:19], v[144:147], a[112:115], v[16:19]
  v_mfma_f32_16x16x32_bf16 v[20:23], v[144:147], a[116:119], v[20:23]
  buffer_load_dwordx4 a[16:19], v224, s[20:23], s0 offen sc1
  ds_read_b128 v[144:147], v254 offset:24576
  s_waitcnt lgkmcnt(7)
  v_mfma_f32_16x16x32_bf16 v[24:27], v[148:151], a[112:115], v[24:27]
  v_mfma_f32_16x16x32_bf16 v[28:31], v[148:151], a[116:119], v[28:31]
  ds_read_b128 v[148:151], v254 offset:25600
  s_waitcnt lgkmcnt(7)
  v_mfma_f32_16x16x32_bf16 v[32:35], v[152:155], a[112:115], v[32:35]
  v_mfma_f32_16x16x32_bf16 v[36:39], v[152:155], a[116:119], v[36:39]
  buffer_load_dwordx4 a[20:23], v224, s[20:23], s0 offen offset:1024 sc1
  ds_read_b128 v[152:155], v254 offset:26624
  s_waitcnt lgkmcnt(7)
  v_mfma_f32_16x16x32_bf16 v[40:43], v[156:159], a[112:115], v[40:43]
  v_mfma_f32_16x16x32_bf16 v[44:47], v[156:159], a[116:119], v[44:47]
  ds_read_b128 v[156:159], v254 offset:27648
  s_waitcnt lgkmcnt(7)
  v_mfma_f32_16x16x32_bf16 v[48:51], v[160:163], a[112:115], v[48:51]
  v_mfma_f32_16x16x32_bf16 v[52:55], v[160:163], a[116:119], v[52:55]
  ds_read_b128 v[160:163], v254 offset:28672
  s_waitcnt lgkmcnt(7)
  v_mfma_f32_16x16x32_bf16 v[56:59], v[164:167], a[112:115], v[56:59]
  v_mfma_f32_16x16x32_bf16 v[60:63], v[164:167], a[116:119], v[60:63]
  ds_read_b128 v[164:167], v254 offset:29696
  s_waitcnt lgkmcnt(7)
  v_mfma_f32_16x16x32_bf16 v[128:131], v[168:171], a[112:115], v[128:131]
  v_mfma_f32_16x16x32_bf16 v[132:135], v[168:171], a[116:119], v[132:135]
  ds_read_b128 v[168:171], v254 offset:30720
  s_waitcnt vmcnt(20) lgkmcnt(7)
  v_mfma_f32_16x16x32_bf16 v[0:3], v[172:175], a[120:123], v[0:3]
  s_add_u32 s0, s78, 38912
  s_waitcnt vmcnt(19)
  v_mfma_f32_16x16x32_bf16 v[4:7], v[172:175], a[124:127], v[4:7]
  ds_read_b128 v[172:175], v254 offset:31744
  s_waitcnt lgkmcnt(7)
  v_mfma_f32_16x16x32_bf16 v[8:11], v[144:147], a[120:123], v[8:11]
  v_mfma_f32_16x16x32_bf16 v[12:15], v[144:147], a[124:127], v[12:15]
  buffer_load_dwordx4 a[24:27], v224, s[20:23], s0 offen sc1
  s_barrier
  ds_read_b128 v[144:147], v253 offset:24576
  s_waitcnt lgkmcnt(7)
  v_mfma_f32_16x16x32_bf16 v[16:19], v[148:151], a[120:123], v[16:19]
  v_mfma_f32_16x16x32_bf16 v[20:23], v[148:151], a[124:127], v[20:23]
  buffer_load_dwordx4 a[28:31], v224, s[20:23], s0 offen offset:1024 sc1
  ds_read_b128 v[148:151], v253 offset:25600
  s_waitcnt lgkmcnt(7)
  v_mfma_f32_16x16x32_bf16 v[24:27], v[152:155], a[120:123], v[24:27]
  s_add_u32 s62, s79, 884736
  s_add_u32 m0, s6, 0
  v_mfma_f32_16x16x32_bf16 v[28:31], v[152:155], a[124:127], v[28:31]
  buffer_load_dwordx4 v224, s[20:23], s62 offen offset:0 sc1 lds
  ds_read_b128 v[152:155], v253 offset:26624
  s_waitcnt lgkmcnt(7)
  v_mfma_f32_16x16x32_bf16 v[32:35], v[156:159], a[120:123], v[32:35]
  v_mfma_f32_16x16x32_bf16 v[36:39], v[156:159], a[124:127], v[36:39]
  ds_read_b128 v[156:159], v253 offset:27648
  s_waitcnt lgkmcnt(7)
  v_mfma_f32_16x16x32_bf16 v[40:43], v[160:163], a[120:123], v[40:43]
  v_mfma_f32_16x16x32_bf16 v[44:47], v[160:163], a[124:127], v[44:47]
  buffer_load_dwordx4 v224, s[20:23], s62 offen offset:1024 sc1 lds
  ds_read_b128 v[160:163], v253 offset:28672
  s_waitcnt lgkmcnt(7)
  v_mfma_f32_16x16x32_bf16 v[48:51], v[164:167], a[120:123], v[48:51]
  v_mfma_f32_16x16x32_bf16 v[52:55], v[164:167], a[124:127], v[52:55]
  ds_read_b128 v[164:167], v253 offset:29696
  s_waitcnt lgkmcnt(7)
  v_mfma_f32_16x16x32_bf16 v[56:59], v[168:171], a[120:123], v[56:59]
  v_mfma_f32_16x16x32_bf16 v[60:63], v[168:171], a[124:127], v[60:63]
  buffer_load_dwordx4 v224, s[20:23], s62 offen offset:2048 sc1 lds
  ds_read_b128 v[168:171], v253 offset:30720
  s_waitcnt lgkmcnt(7)
  v_mfma_f32_16x16x32_bf16 v[128:131], v[172:175], a[120:123], v[128:131]
  v_mfma_f32_16x16x32_bf16 v[132:135], v[172:175], a[124:127], v[132:135]
  ds_read_b128 v[172:175], v253 offset:31744
  s_waitcnt vmcnt(10) lgkmcnt(7)
  v_mfma_f32_16x16x32_bf16 v[0:3], v[144:147], a[0:3], v[0:3]
  s_waitcnt vmcnt(9)
  v_mfma_f32_16x16x32_bf16 v[4:7], v[144:147], a[4:7], v[4:7]
  buffer_load_dwordx4 v224, s[20:23], s62 offen offset:3072 sc1 lds
  ds_read_b128 v[144:147], v253 offset:32768
  s_waitcnt lgkmcnt(7)
  v_mfma_f32_16x16x32_bf16 v[8:11], v[148:151], a[0:3], v[8:11]
  s_add_u32 s62, s79, 888832
  s_add_u32 m0, s6, 4096
  v_mfma_f32_16x16x32_bf16 v[12:15], v[148:151], a[4:7], v[12:15]
  ds_read_b128 v[148:151], v253 offset:33792
  s_waitcnt lgkmcnt(7)
  v_mfma_f32_16x16x32_bf16 v[16:19], v[152:155], a[0:3], v[16:19]
  v_mfma_f32_16x16x32_bf16 v[20:23], v[152:155], a[4:7], v[20:23]
  buffer_load_dwordx4 v224, s[20:23], s62 offen offset:0 sc1 lds
  ds_read_b128 v[152:155], v253 offset:34816
  s_waitcnt lgkmcnt(7)
  v_mfma_f32_16x16x32_bf16 v[24:27], v[156:159], a[0:3], v[24:27]
  v_mfma_f32_16x16x32_bf16 v[28:31], v[156:159], a[4:7], v[28:31]
  ds_read_b128 v[156:159], v253 offset:35840
  s_waitcnt lgkmcnt(7)
  v_mfma_f32_16x16x32_bf16 v[32:35], v[160:163], a[0:3], v[32:35]
  v_mfma_f32_16x16x32_bf16 v[36:39], v[160:163], a[4:7], v[36:39]
  buffer_load_dwordx4 v224, s[20:23], s62 offen offset:1024 sc1 lds
  ds_read_b128 v[160:163], v253 offset:36864
  s_waitcnt lgkmcnt(7)
  v_mfma_f32_16x16x32_bf16 v[40:43], v[164:167], a[0:3], v[40:43]
  v_mfma_f32_16x16x32_bf16 v[44:47], v[164:167], a[4:7], v[44:47]
  ds_read_b128 v[164:167], v253 offset:37888
  s_waitcnt lgkmcnt(7)
  v_mfma_f32_16x16x32_bf16 v[48:51], v[168:171], a[0:3], v[48:51]
  v_mfma_f32_16x16x32_bf16 v[52:55], v[168:171], a[4:7], v[52:55]
  buffer_load_dwordx4 v224, s[20:23], s62 offen offset:2048 sc1 lds
  ds_read_b128 v[168:171], v253 offset:38912
  s_waitcnt lgkmcnt(7)
  v_mfma_f32_16x16x32_bf16 v[56:59], v[172:175], a[0:3], v[56:59]
  v_mfma_f32_16x16x32_bf16 v[60:63], v[172:175], a[4:7], v[60:63]
  ds_read_b128 v[172:175], v253 offset:39936
  s_waitcnt lgkmcnt(7)
  v_mfma_f32_16x16x32_bf16 v[128:131], v[144:147], a[0:3], v[128:131]
  v_mfma_f32_16x16x32_bf16 v[132:135], v[144:147], a[4:7], v[132:135]
  buffer_load_dwordx4 v224, s[20:23], s62 offen offset:3072 sc1 lds
  ds_read_b128 v[144:147], v253 offset:40960
  s_waitcnt vmcnt(13) lgkmcnt(7)
  v_mfma_f32_16x16x32_bf16 v[0:3], v[148:151], a[8:11], v[0:3]
  s_add_u32 s62, s79, 892928
  s_add_u32 m0, s6, 8192
  s_waitcnt vmcnt(12)
  v_mfma_f32_16x16x32_bf16 v[4:7], v[148:151], a[12:15], v[4:7]
  ds_read_b128 v[148:151], v253 offset:41984
  s_waitcnt lgkmcnt(7)
  v_mfma_f32_16x16x32_bf16 v[8:11], v[152:155], a[8:11], v[8:11]
  v_mfma_f32_16x16x32_bf16 v[12:15], v[152:155], a[12:15], v[12:15]
  buffer_load_dwordx4 v224, s[20:23], s62 offen offset:0 sc1 lds
  ds_read_b128 v[152:155], v253 offset:43008
  s_waitcnt lgkmcnt(7)
  v_mfma_f32_16x16x32_bf16 v[16:19], v[156:159], a[8:11], v[16:19]
  s_add_u32 s0, s78, 40960
  v_mfma_f32_16x16x32_bf16 v[20:23], v[156:159], a[12:15], v[20:23]
  ds_read_b128 v[156:159], v253 offset:44032
  s_waitcnt lgkmcnt(7)
  v_mfma_f32_16x16x32_bf16 v[24:27], v[160:163], a[8:11], v[24:27]
  v_mfma_f32_16x16x32_bf16 v[28:31], v[160:163], a[12:15], v[28:31]
  buffer_load_dwordx4 a[32:35], v224, s[20:23], s0 offen sc1
  ds_read_b128 v[160:163], v253 offset:45056
  s_waitcnt lgkmcnt(7)
  v_mfma_f32_16x16x32_bf16 v[32:35], v[164:167], a[8:11], v[32:35]
  v_mfma_f32_16x16x32_bf16 v[36:39], v[164:167], a[12:15], v[36:39]
  ds_read_b128 v[164:167], v253 offset:46080
  s_waitcnt lgkmcnt(7)
  v_mfma_f32_16x16x32_bf16 v[40:43], v[168:171], a[8:11], v[40:43]
  v_mfma_f32_16x16x32_bf16 v[44:47], v[168:171], a[12:15], v[44:47]
  buffer_load_dwordx4 a[36:39], v224, s[20:23], s0 offen offset:1024 sc1
  ds_read_b128 v[168:171], v253 offset:47104
  s_waitcnt lgkmcnt(7)
  v_mfma_f32_16x16x32_bf16 v[48:51], v[172:175], a[8:11], v[48:51]
  s_add_u32 s0, s78, 43008
  v_mfma_f32_16x16x32_bf16 v[52:55], v[172:175], a[12:15], v[52:55]
  ds_read_b128 v[172:175], v253 offset:48128
  s_waitcnt lgkmcnt(7)
  v_mfma_f32_16x16x32_bf16 v[56:59], v[144:147], a[8:11], v[56:59]
  v_mfma_f32_16x16x32_bf16 v[60:63], v[144:147], a[12:15], v[60:63]
  buffer_load_dwordx4 a[40:43], v224, s[20:23], s0 offen sc1
  ds_read_b128 v[144:147], v253 offset:49152
  s_waitcnt lgkmcnt(7)
  v_mfma_f32_16x16x32_bf16 v[128:131], v[148:151], a[8:11], v[128:131]
  v_mfma_f32_16x16x32_bf16 v[132:135], v[148:151], a[12:15], v[132:135]
  ds_read_b128 v[148:151], v253 offset:50176
  s_waitcnt vmcnt(15) lgkmcnt(7)
  v_mfma_f32_16x16x32_bf16 v[0:3], v[152:155], a[16:19], v[0:3]
  s_waitcnt vmcnt(14)
  v_mfma_f32_16x16x32_bf16 v[4:7], v[152:155], a[20:23], v[4:7]
  buffer_load_dwordx4 a[44:47], v224, s[20:23], s0 offen offset:1024 sc1
  ds_read_b128 v[152:155], v253 offset:51200
  s_waitcnt lgkmcnt(7)
  v_mfma_f32_16x16x32_bf16 v[8:11], v[156:159], a[16:19], v[8:11]
  s_add_u32 s0, s78, 45056
  v_mfma_f32_16x16x32_bf16 v[12:15], v[156:159], a[20:23], v[12:15]
  ds_read_b128 v[156:159], v253 offset:52224
  s_waitcnt lgkmcnt(7)
  v_mfma_f32_16x16x32_bf16 v[16:19], v[160:163], a[16:19], v[16:19]
  v_mfma_f32_16x16x32_bf16 v[20:23], v[160:163], a[20:23], v[20:23]
  buffer_load_dwordx4 a[48:51], v224, s[20:23], s0 offen sc1
  ds_read_b128 v[160:163], v253 offset:53248
  s_waitcnt lgkmcnt(7)
  v_mfma_f32_16x16x32_bf16 v[24:27], v[164:167], a[16:19], v[24:27]
  v_mfma_f32_16x16x32_bf16 v[28:31], v[164:167], a[20:23], v[28:31]
  ds_read_b128 v[164:167], v253 offset:54272
  s_waitcnt lgkmcnt(7)
  v_mfma_f32_16x16x32_bf16 v[32:35], v[168:171], a[16:19], v[32:35]
  v_mfma_f32_16x16x32_bf16 v[36:39], v[168:171], a[20:23], v[36:39]
  buffer_load_dwordx4 a[52:55], v224, s[20:23], s0 offen offset:1024 sc1
  ds_read_b128 v[168:171], v253 offset:55296
  s_waitcnt lgkmcnt(7)
  v_mfma_f32_16x16x32_bf16 v[40:43], v[172:175], a[16:19], v[40:43]
  v_mfma_f32_16x16x32_bf16 v[44:47], v[172:175], a[20:23], v[44:47]
  ds_read_b128 v[172:175], v253 offset:56320
  s_waitcnt lgkmcnt(7)
  v_mfma_f32_16x16x32_bf16 v[48:51], v[144:147], a[16:19], v[48:51]
  v_mfma_f32_16x16x32_bf16 v[52:55], v[144:147], a[20:23], v[52:55]
  ds_read_b128 v[144:147], v253 offset:57344
  s_waitcnt lgkmcnt(7)
  v_mfma_f32_16x16x32_bf16 v[56:59], v[148:151], a[16:19], v[56:59]
  v_mfma_f32_16x16x32_bf16 v[60:63], v[148:151], a[20:23], v[60:63]
  ds_read_b128 v[148:151], v253 offset:58368
  s_waitcnt lgkmcnt(7)
  v_mfma_f32_16x16x32_bf16 v[128:131], v[152:155], a[16:19], v[128:131]
  v_mfma_f32_16x16x32_bf16 v[132:135], v[152:155], a[20:23], v[132:135]
  ds_read_b128 v[152:155], v253 offset:59392
  s_waitcnt vmcnt(16) lgkmcnt(7)
  v_mfma_f32_16x16x32_bf16 v[0:3], v[156:159], a[24:27], v[0:3]
  s_add_u32 s0, s78, 47104
  s_waitcnt vmcnt(15)
  v_mfma_f32_16x16x32_bf16 v[4:7], v[156:159], a[28:31], v[4:7]
  ds_read_b128 v[156:159], v253 offset:60416
  s_waitcnt lgkmcnt(7)
  v_mfma_f32_16x16x32_bf16 v[8:11], v[160:163], a[24:27], v[8:11]
  v_mfma_f32_16x16x32_bf16 v[12:15], v[160:163], a[28:31], v[12:15]
  buffer_load_dwordx4 a[56:59], v224, s[20:23], s0 offen sc1
  s_barrier
  ds_read_b128 v[160:163], v224 offset:0
  s_waitcnt lgkmcnt(7)
  v_mfma_f32_16x16x32_bf16 v[16:19], v[164:167], a[24:27], v[16:19]
  s_lshl_b32 s45, s50, 2
  s_add_u32 s45, s45, s71
  s_add_u32 s45, s45, 64
  s_mov_b64 exec, 1
  buffer_store_dword v251, off, s[20:23], s45 sc1
  s_mov_b64 exec, -1
  v_mfma_f32_16x16x32_bf16 v[20:23], v[164:167], a[28:31], v[20:23]
  buffer_load_dwordx4 a[60:63], v224, s[20:23], s0 offen offset:1024 sc1
  ds_read_b128 v[164:167], v224 offset:1024
  s_waitcnt lgkmcnt(7)
  v_mfma_f32_16x16x32_bf16 v[24:27], v[168:171], a[24:27], v[24:27]
  s_add_u32 s62, s79, 1032192
  s_add_u32 m0, s7, 0
  v_mfma_f32_16x16x32_bf16 v[28:31], v[168:171], a[28:31], v[28:31]
  buffer_load_dwordx4 v224, s[20:23], s62 offen offset:0 sc1 lds
  ds_read_b128 v[168:171], v224 offset:2048
  s_waitcnt lgkmcnt(7)
  v_mfma_f32_16x16x32_bf16 v[32:35], v[172:175], a[24:27], v[32:35]
  v_mfma_f32_16x16x32_bf16 v[36:39], v[172:175], a[28:31], v[36:39]
  ds_read_b128 v[172:175], v224 offset:3072
  s_waitcnt lgkmcnt(7)
  v_mfma_f32_16x16x32_bf16 v[40:43], v[144:147], a[24:27], v[40:43]
  v_mfma_f32_16x16x32_bf16 v[44:47], v[144:147], a[28:31], v[44:47]
  buffer_load_dwordx4 v224, s[20:23], s62 offen offset:1024 sc1 lds
  ds_read_b128 v[144:147], v224 offset:4096
  s_waitcnt lgkmcnt(7)
  v_mfma_f32_16x16x32_bf16 v[48:51], v[148:151], a[24:27], v[48:51]
  v_mfma_f32_16x16x32_bf16 v[52:55], v[148:151], a[28:31], v[52:55]
  ds_read_b128 v[148:151], v224 offset:5120
  s_waitcnt lgkmcnt(7)
  v_mfma_f32_16x16x32_bf16 v[56:59], v[152:155], a[24:27], v[56:59]
  v_mfma_f32_16x16x32_bf16 v[60:63], v[152:155], a[28:31], v[60:63]
  buffer_load_dwordx4 v224, s[20:23], s62 offen offset:2048 sc1 lds
  ds_read_b128 v[152:155], v224 offset:6144
  s_waitcnt lgkmcnt(7)
  v_mfma_f32_16x16x32_bf16 v[128:131], v[156:159], a[24:27], v[128:131]
  v_mfma_f32_16x16x32_bf16 v[132:135], v[156:159], a[28:31], v[132:135]
  ds_read_b128 v[156:159], v224 offset:7168
  s_waitcnt vmcnt(11) lgkmcnt(7)
  v_mfma_f32_16x16x32_bf16 v[0:3], v[160:163], a[32:35], v[0:3]
  s_waitcnt vmcnt(10)
  v_mfma_f32_16x16x32_bf16 v[4:7], v[160:163], a[36:39], v[4:7]
  buffer_load_dwordx4 v224, s[20:23], s62 offen offset:3072 sc1 lds
  ds_read_b128 v[160:163], v224 offset:8192
  s_waitcnt lgkmcnt(7)
  v_mfma_f32_16x16x32_bf16 v[8:11], v[164:167], a[32:35], v[8:11]
  s_add_u32 s62, s79, 1036288
  s_add_u32 m0, s7, 4096
  v_mfma_f32_16x16x32_bf16 v[12:15], v[164:167], a[36:39], v[12:15]
  ds_read_b128 v[164:167], v224 offset:9216
  s_and_b32 s45, s50, 1
  s_lshl_b32 s45, s45, 9
  s_lshl_b32 s63, s3, 7
  s_add_u32 s45, s45, s63
  s_add_u32 s45, s45, 61440
  s_waitcnt lgkmcnt(7)
  v_mfma_f32_16x16x32_bf16 v[16:19], v[168:171], a[32:35], v[16:19]
  v_and_b32 v208, 15, v249
  v_lshlrev_b32 v208, 2, v208
  v_add_u32 v208, s45, v208
  v_mfma_f32_16x16x32_bf16 v[20:23], v[168:171], a[36:39], v[20:23]
  buffer_load_dwordx4 v224, s[20:23], s62 offen offset:0 sc1 lds
  ds_read_b128 v[168:171], v224 offset:10240
  s_waitcnt lgkmcnt(7)
  v_mfma_f32_16x16x32_bf16 v[24:27], v[172:175], a[32:35], v[24:27]
  ds_read_b32 v203, v208
  ds_read_b32 v204, v208 offset:64
  v_mfma_f32_16x16x32_bf16 v[28:31], v[172:175], a[36:39], v[28:31]
  ds_read_b128 v[172:175], v224 offset:11264
  s_waitcnt lgkmcnt(9)
  v_mfma_f32_16x16x32_bf16 v[32:35], v[144:147], a[32:35], v[32:35]
  v_mfma_f32_16x16x32_bf16 v[36:39], v[144:147], a[36:39], v[36:39]
  buffer_load_dwordx4 v224, s[20:23], s62 offen offset:1024 sc1 lds
  ds_read_b128 v[144:147], v224 offset:12288
  s_waitcnt lgkmcnt(9)
  v_mfma_f32_16x16x32_bf16 v[40:43], v[148:151], a[32:35], v[40:43]
  s_waitcnt lgkmcnt(3)
  v_sub_f32 v203, 1.0, v203
  s_waitcnt lgkmcnt(2)
  v_sub_f32 v204, 1.0, v204
  v_mfma_f32_16x16x32_bf16 v[44:47], v[148:151], a[36:39], v[44:47]
  ds_read_b128 v[148:151], v224 offset:13312
  v_mfma_f32_16x16x32_bf16 v[48:51], v[152:155], a[32:35], v[48:51]
  v_mfma_f32_16x16x32_bf16 v[52:55], v[152:155], a[36:39], v[52:55]
  buffer_load_dwordx4 v224, s[20:23], s62 offen offset:2048 sc1 lds
  ds_read_b128 v[152:155], v224 offset:14336
  v_mfma_f32_16x16x32_bf16 v[56:59], v[156:159], a[32:35], v[56:59]
  v_mfma_f32_16x16x32_bf16 v[60:63], v[156:159], a[36:39], v[60:63]
  ds_read_b128 v[156:159], v224 offset:15360
  v_mfma_f32_16x16x32_bf16 v[128:131], v[160:163], a[32:35], v[128:131]
  v_mfma_f32_16x16x32_bf16 v[132:135], v[160:163], a[36:39], v[132:135]
  buffer_load_dwordx4 v224, s[20:23], s62 offen offset:3072 sc1 lds
  ds_read_b128 v[160:163], v224 offset:16384
  s_waitcnt vmcnt(14)
  v_mfma_f32_16x16x32_bf16 v[0:3], v[164:167], a[40:43], v[0:3]
  s_add_u32 s62, s79, 1040384
  s_add_u32 m0, s7, 8192
  s_waitcnt vmcnt(13)
  v_mfma_f32_16x16x32_bf16 v[4:7], v[164:167], a[44:47], v[4:7]
  ds_read_b128 v[164:167], v224 offset:17408
  v_mfma_f32_16x16x32_bf16 v[8:11], v[168:171], a[40:43], v[8:11]
  v_mfma_f32_16x16x32_bf16 v[12:15], v[168:171], a[44:47], v[12:15]
  buffer_load_dwordx4 v224, s[20:23], s62 offen offset:0 sc1 lds
  ds_read_b128 v[168:171], v224 offset:18432
  s_waitcnt lgkmcnt(7)
  v_mfma_f32_16x16x32_bf16 v[16:19], v[172:175], a[40:43], v[16:19]
  s_add_u32 s0, s78, 49152
  v_mfma_f32_16x16x32_bf16 v[20:23], v[172:175], a[44:47], v[20:23]
  ds_read_b128 v[172:175], v224 offset:19456
  s_waitcnt lgkmcnt(7)
  v_mfma_f32_16x16x32_bf16 v[24:27], v[144:147], a[40:43], v[24:27]
  v_mfma_f32_16x16x32_bf16 v[28:31], v[144:147], a[44:47], v[28:31]
  buffer_load_dwordx4 a[64:67], v224, s[20:23], s0 offen sc1
  ds_read_b128 v[144:147], v224 offset:20480
  s_waitcnt lgkmcnt(7)
  v_mfma_f32_16x16x32_bf16 v[32:35], v[148:151], a[40:43], v[32:35]
  v_mfma_f32_16x16x32_bf16 v[36:39], v[148:151], a[44:47], v[36:39]
  ds_read_b128 v[148:151], v224 offset:21504
  s_waitcnt lgkmcnt(7)
  v_mfma_f32_16x16x32_bf16 v[40:43], v[152:155], a[40:43], v[40:43]
  v_mfma_f32_16x16x32_bf16 v[44:47], v[152:155], a[44:47], v[44:47]
  buffer_load_dwordx4 a[68:71], v224, s[20:23], s0 offen offset:1024 sc1
  ds_read_b128 v[152:155], v224 offset:22528
  s_waitcnt lgkmcnt(7)
  v_mfma_f32_16x16x32_bf16 v[48:51], v[156:159], a[40:43], v[48:51]
  s_add_u32 s0, s78, 51200
  v_mfma_f32_16x16x32_bf16 v[52:55], v[156:159], a[44:47], v[52:55]
  ds_read_b128 v[156:159], v224 offset:23552
  s_waitcnt lgkmcnt(7)
  v_mfma_f32_16x16x32_bf16 v[56:59], v[160:163], a[40:43], v[56:59]
  v_mfma_f32_16x16x32_bf16 v[60:63], v[160:163], a[44:47], v[60:63]
  buffer_load_dwordx4 a[72:75], v224, s[20:23], s0 offen sc1
  ds_read_b128 v[160:163], v224 offset:24576
  s_waitcnt lgkmcnt(7)
  v_mfma_f32_16x16x32_bf16 v[128:131], v[164:167], a[40:43], v[128:131]
  v_mfma_f32_16x16x32_bf16 v[132:135], v[164:167], a[44:47], v[132:135]
  ds_read_b128 v[164:167], v224 offset:25600
  s_waitcnt vmcnt(16) lgkmcnt(7)
  v_mfma_f32_16x16x32_bf16 v[0:3], v[168:171], a[48:51], v[0:3]
  s_waitcnt vmcnt(15)
  v_mfma_f32_16x16x32_bf16 v[4:7], v[168:171], a[52:55], v[4:7]
  buffer_load_dwordx4 a[76:79], v224, s[20:23], s0 offen offset:1024 sc1
  ds_read_b128 v[168:171], v224 offset:26624
  s_waitcnt lgkmcnt(7)
  v_mfma_f32_16x16x32_bf16 v[8:11], v[172:175], a[48:51], v[8:11]
  s_add_u32 s0, s78, 53248
  v_mfma_f32_16x16x32_bf16 v[12:15], v[172:175], a[52:55], v[12:15]
  ds_read_b128 v[172:175], v224 offset:27648
  s_waitcnt lgkmcnt(7)
  v_mfma_f32_16x16x32_bf16 v[16:19], v[144:147], a[48:51], v[16:19]
  v_mfma_f32_16x16x32_bf16 v[20:23], v[144:147], a[52:55], v[20:23]
  buffer_load_dwordx4 a[80:83], v224, s[20:23], s0 offen sc1
  ds_read_b128 v[144:147], v224 offset:28672
  s_waitcnt lgkmcnt(7)
  v_mfma_f32_16x16x32_bf16 v[24:27], v[148:151], a[48:51], v[24:27]
  v_mfma_f32_16x16x32_bf16 v[28:31], v[148:151], a[52:55], v[28:31]
  ds_read_b128 v[148:151], v224 offset:29696
  s_waitcnt lgkmcnt(7)
  v_mfma_f32_16x16x32_bf16 v[32:35], v[152:155], a[48:51], v[32:35]
  v_mfma_f32_16x16x32_bf16 v[36:39], v[152:155], a[52:55], v[36:39]
  buffer_load_dwordx4 a[84:87], v224, s[20:23], s0 offen offset:1024 sc1
  ds_read_b128 v[152:155], v224 offset:30720
  s_waitcnt lgkmcnt(7)
  v_mfma_f32_16x16x32_bf16 v[40:43], v[156:159], a[48:51], v[40:43]
  v_mfma_f32_16x16x32_bf16 v[44:47], v[156:159], a[52:55], v[44:47]
  ds_read_b128 v[156:159], v224 offset:31744
  s_waitcnt lgkmcnt(7)
  v_mfma_f32_16x16x32_bf16 v[48:51], v[160:163], a[48:51], v[48:51]
  v_mfma_f32_16x16x32_bf16 v[52:55], v[160:163], a[52:55], v[52:55]
  ds_read_b128 v[160:163], v224 offset:32768
  s_waitcnt lgkmcnt(7)
  v_mfma_f32_16x16x32_bf16 v[56:59], v[164:167], a[48:51], v[56:59]
  v_mfma_f32_16x16x32_bf16 v[60:63], v[164:167], a[52:55], v[60:63]
  ds_read_b128 v[164:167], v224 offset:33792
  s_waitcnt lgkmcnt(7)
  v_mfma_f32_16x16x32_bf16 v[128:131], v[168:171], a[48:51], v[128:131]
  v_mfma_f32_16x16x32_bf16 v[132:135], v[168:171], a[52:55], v[132:135]
  ds_read_b128 v[168:171], v224 offset:34816
  s_waitcnt vmcnt(17) lgkmcnt(7)
  v_mfma_f32_16x16x32_bf16 v[0:3], v[172:175], a[56:59], v[0:3]
  s_add_u32 s0, s78, 55296
  s_waitcnt vmcnt(15)
  v_mfma_f32_16x16x32_bf16 v[4:7], v[172:175], a[60:63], v[4:7]
  ds_read_b128 v[172:175], v224 offset:35840
  s_waitcnt lgkmcnt(7)
  v_mfma_f32_16x16x32_bf16 v[8:11], v[144:147], a[56:59], v[8:11]
  v_mfma_f32_16x16x32_bf16 v[12:15], v[144:147], a[60:63], v[12:15]
  buffer_load_dwordx4 a[88:91], v224, s[20:23], s0 offen sc1
  s_barrier
  ds_read_b128 v[144:147], v224 offset:36864
  s_waitcnt lgkmcnt(7)
  v_mfma_f32_16x16x32_bf16 v[16:19], v[148:151], a[56:59], v[16:19]
  v_mfma_f32_16x16x32_bf16 v[20:23], v[148:151], a[60:63], v[20:23]
  buffer_load_dwordx4 a[92:95], v224, s[20:23], s0 offen offset:1024 sc1
  ds_read_b128 v[148:151], v224 offset:37888
  s_waitcnt lgkmcnt(7)
  v_mfma_f32_16x16x32_bf16 v[24:27], v[152:155], a[56:59], v[24:27]
  s_add_u32 s62, s79, 1179648
  s_add_u32 m0, s4, 0
  v_mfma_f32_16x16x32_bf16 v[28:31], v[152:155], a[60:63], v[28:31]
  buffer_load_dwordx4 v224, s[20:23], s62 offen offset:0 sc1 lds
  ds_read_b128 v[152:155], v224 offset:38912
  s_waitcnt lgkmcnt(7)
  v_mfma_f32_16x16x32_bf16 v[32:35], v[156:159], a[56:59], v[32:35]
  v_mfma_f32_16x16x32_bf16 v[36:39], v[156:159], a[60:63], v[36:39]
  ds_read_b128 v[156:159], v224 offset:39936
  s_waitcnt lgkmcnt(7)
  v_mfma_f32_16x16x32_bf16 v[40:43], v[160:163], a[56:59], v[40:43]
  v_mfma_f32_16x16x32_bf16 v[44:47], v[160:163], a[60:63], v[44:47]
  buffer_load_dwordx4 v224, s[20:23], s62 offen offset:1024 sc1 lds
  ds_read_b128 v[160:163], v224 offset:40960
  s_waitcnt lgkmcnt(7)
  v_mfma_f32_16x16x32_bf16 v[48:51], v[164:167], a[56:59], v[48:51]
  v_mfma_f32_16x16x32_bf16 v[52:55], v[164:167], a[60:63], v[52:55]
  ds_read_b128 v[164:167], v224 offset:41984
  s_waitcnt lgkmcnt(7)
  v_mfma_f32_16x16x32_bf16 v[56:59], v[168:171], a[56:59], v[56:59]
  v_mfma_f32_16x16x32_bf16 v[60:63], v[168:171], a[60:63], v[60:63]
  buffer_load_dwordx4 v224, s[20:23], s62 offen offset:2048 sc1 lds
  ds_read_b128 v[168:171], v224 offset:43008
  s_waitcnt lgkmcnt(7)
  v_mfma_f32_16x16x32_bf16 v[128:131], v[172:175], a[56:59], v[128:131]
  v_mfma_f32_16x16x32_bf16 v[132:135], v[172:175], a[60:63], v[132:135]
  ds_read_b128 v[172:175], v224 offset:44032
  s_waitcnt vmcnt(10) lgkmcnt(7)
  v_mfma_f32_16x16x32_bf16 v[0:3], v[144:147], a[64:67], v[0:3]
  s_waitcnt vmcnt(9)
  v_mfma_f32_16x16x32_bf16 v[4:7], v[144:147], a[68:71], v[4:7]
  buffer_load_dwordx4 v224, s[20:23], s62 offen offset:3072 sc1 lds
  ds_read_b128 v[144:147], v224 offset:45056
  s_waitcnt lgkmcnt(7)
  v_mfma_f32_16x16x32_bf16 v[8:11], v[148:151], a[64:67], v[8:11]
  s_add_u32 s62, s79, 1183744
  s_add_u32 m0, s4, 4096
  v_mfma_f32_16x16x32_bf16 v[12:15], v[148:151], a[68:71], v[12:15]
  ds_read_b128 v[148:151], v224 offset:46080
  s_waitcnt lgkmcnt(7)
  v_mfma_f32_16x16x32_bf16 v[16:19], v[152:155], a[64:67], v[16:19]
  v_mfma_f32_16x16x32_bf16 v[20:23], v[152:155], a[68:71], v[20:23]
  buffer_load_dwordx4 v224, s[20:23], s62 offen offset:0 sc1 lds
  ds_read_b128 v[152:155], v224 offset:47104
  s_waitcnt lgkmcnt(7)
  v_mfma_f32_16x16x32_bf16 v[24:27], v[156:159], a[64:67], v[24:27]
  v_mfma_f32_16x16x32_bf16 v[28:31], v[156:159], a[68:71], v[28:31]
  ds_read_b128 v[156:159], v224 offset:48128
  s_waitcnt lgkmcnt(7)
  v_mfma_f32_16x16x32_bf16 v[32:35], v[160:163], a[64:67], v[32:35]
  v_mfma_f32_16x16x32_bf16 v[36:39], v[160:163], a[68:71], v[36:39]
  buffer_load_dwordx4 v224, s[20:23], s62 offen offset:1024 sc1 lds
  ds_read_b128 v[160:163], v224 offset:49152
  s_waitcnt lgkmcnt(7)
  v_mfma_f32_16x16x32_bf16 v[40:43], v[164:167], a[64:67], v[40:43]
  v_mfma_f32_16x16x32_bf16 v[44:47], v[164:167], a[68:71], v[44:47]
  ds_read_b128 v[164:167], v224 offset:50176
  s_waitcnt lgkmcnt(7)
  v_mfma_f32_16x16x32_bf16 v[48:51], v[168:171], a[64:67], v[48:51]
  v_mfma_f32_16x16x32_bf16 v[52:55], v[168:171], a[68:71], v[52:55]
  buffer_load_dwordx4 v224, s[20:23], s62 offen offset:2048 sc1 lds
  ds_read_b128 v[168:171], v224 offset:51200
  s_waitcnt lgkmcnt(7)
  v_mfma_f32_16x16x32_bf16 v[56:59], v[172:175], a[64:67], v[56:59]
  v_mfma_f32_16x16x32_bf16 v[60:63], v[172:175], a[68:71], v[60:63]
  ds_read_b128 v[172:175], v224 offset:52224
  s_waitcnt lgkmcnt(7)
  v_mfma_f32_16x16x32_bf16 v[128:131], v[144:147], a[64:67], v[128:131]
  v_mfma_f32_16x16x32_bf16 v[132:135], v[144:147], a[68:71], v[132:135]
  buffer_load_dwordx4 v224, s[20:23], s62 offen offset:3072 sc1 lds
  ds_read_b128 v[144:147], v224 offset:53248
  s_waitcnt vmcnt(13) lgkmcnt(7)
  v_mfma_f32_16x16x32_bf16 v[0:3], v[148:151], a[72:75], v[0:3]
  s_add_u32 s62, s79, 1187840
  s_add_u32 m0, s4, 8192
  s_waitcnt vmcnt(12)
  v_mfma_f32_16x16x32_bf16 v[4:7], v[148:151], a[76:79], v[4:7]
  ds_read_b128 v[148:151], v224 offset:54272
  s_waitcnt lgkmcnt(7)
  v_mfma_f32_16x16x32_bf16 v[8:11], v[152:155], a[72:75], v[8:11]
  buffer_load_dword v242, v241, s[20:23], s101 offen sc1
  v_mfma_f32_16x16x32_bf16 v[12:15], v[152:155], a[76:79], v[12:15]
  buffer_load_dwordx4 v224, s[20:23], s62 offen offset:0 sc1 lds
  ds_read_b128 v[152:155], v224 offset:62464
  s_waitcnt lgkmcnt(7)
  v_mfma_f32_16x16x32_bf16 v[16:19], v[156:159], a[72:75], v[16:19]
  s_add_u32 s0, s78, 57344
  v_mfma_f32_16x16x32_bf16 v[20:23], v[156:159], a[76:79], v[20:23]
  ds_read_b128 v[156:159], v224 offset:63488
  s_waitcnt lgkmcnt(7)
  v_mfma_f32_16x16x32_bf16 v[24:27], v[160:163], a[72:75], v[24:27]
  v_mfma_f32_16x16x32_bf16 v[28:31], v[160:163], a[76:79], v[28:31]
  buffer_load_dwordx4 a[96:99], v224, s[20:23], s0 offen sc1
  ds_read_b128 v[160:163], v224 offset:64512
  s_waitcnt lgkmcnt(7)
  v_mfma_f32_16x16x32_bf16 v[32:35], v[164:167], a[72:75], v[32:35]
  v_mfma_f32_16x16x32_bf16 v[36:39], v[164:167], a[76:79], v[36:39]
  ds_read_b128 v[164:167], v253 offset:0
  s_waitcnt lgkmcnt(7)
  v_mfma_f32_16x16x32_bf16 v[40:43], v[168:171], a[72:75], v[40:43]
  v_mfma_f32_16x16x32_bf16 v[44:47], v[168:171], a[76:79], v[44:47]
  buffer_load_dwordx4 a[100:103], v224, s[20:23], s0 offen offset:1024 sc1
  ds_read_b128 v[168:171], v253 offset:1024
  s_waitcnt lgkmcnt(7)
  v_mfma_f32_16x16x32_bf16 v[48:51], v[172:175], a[72:75], v[48:51]
  s_add_u32 s0, s78, 59392
  v_mfma_f32_16x16x32_bf16 v[52:55], v[172:175], a[76:79], v[52:55]
  ds_read_b128 v[172:175], v253 offset:2048
  s_waitcnt lgkmcnt(7)
  v_mfma_f32_16x16x32_bf16 v[56:59], v[144:147], a[72:75], v[56:59]
  v_mfma_f32_16x16x32_bf16 v[60:63], v[144:147], a[76:79], v[60:63]
  buffer_load_dwordx4 a[104:107], v224, s[20:23], s0 offen sc1
  ds_read_b128 v[144:147], v253 offset:3072
  s_waitcnt lgkmcnt(7)
  v_mfma_f32_16x16x32_bf16 v[128:131], v[148:151], a[72:75], v[128:131]
  v_mfma_f32_16x16x32_bf16 v[132:135], v[148:151], a[76:79], v[132:135]
  ds_read_b128 v[148:151], v253 offset:4096
  s_waitcnt vmcnt(16) lgkmcnt(7)
  v_mfma_f32_16x16x32_bf16 v[0:3], v[152:155], a[80:83], v[0:3]
  s_waitcnt vmcnt(15)
  v_mfma_f32_16x16x32_bf16 v[4:7], v[152:155], a[84:87], v[4:7]
  buffer_load_dwordx4 a[108:111], v224, s[20:23], s0 offen offset:1024 sc1
  ds_read_b128 v[152:155], v253 offset:5120
  s_waitcnt lgkmcnt(7)
  v_mfma_f32_16x16x32_bf16 v[8:11], v[156:159], a[80:83], v[8:11]
  s_add_u32 s0, s78, 61440
  v_mfma_f32_16x16x32_bf16 v[12:15], v[156:159], a[84:87], v[12:15]
  ds_read_b128 v[156:159], v253 offset:6144
  s_waitcnt lgkmcnt(7)
  v_mfma_f32_16x16x32_bf16 v[16:19], v[160:163], a[80:83], v[16:19]
  v_mfma_f32_16x16x32_bf16 v[20:23], v[160:163], a[84:87], v[20:23]
  buffer_load_dwordx4 a[112:115], v224, s[20:23], s0 offen sc1
  ds_read_b128 v[160:163], v253 offset:7168
  s_waitcnt lgkmcnt(7)
  v_mfma_f32_16x16x32_bf16 v[24:27], v[164:167], a[80:83], v[24:27]
  v_mfma_f32_16x16x32_bf16 v[28:31], v[164:167], a[84:87], v[28:31]
  ds_read_b128 v[164:167], v253 offset:8192
  s_waitcnt lgkmcnt(7)
  v_mfma_f32_16x16x32_bf16 v[32:35], v[168:171], a[80:83], v[32:35]
  v_mfma_f32_16x16x32_bf16 v[36:39], v[168:171], a[84:87], v[36:39]
  buffer_load_dwordx4 a[116:119], v224, s[20:23], s0 offen offset:1024 sc1
  ds_read_b128 v[168:171], v253 offset:9216
  s_waitcnt lgkmcnt(7)
  v_mfma_f32_16x16x32_bf16 v[40:43], v[172:175], a[80:83], v[40:43]
  v_mfma_f32_16x16x32_bf16 v[44:47], v[172:175], a[84:87], v[44:47]
  ds_read_b128 v[172:175], v253 offset:10240
  s_waitcnt lgkmcnt(7)
  v_mfma_f32_16x16x32_bf16 v[48:51], v[144:147], a[80:83], v[48:51]
  v_mfma_f32_16x16x32_bf16 v[52:55], v[144:147], a[84:87], v[52:55]
  ds_read_b128 v[144:147], v253 offset:11264
  s_waitcnt lgkmcnt(7)
  v_mfma_f32_16x16x32_bf16 v[56:59], v[148:151], a[80:83], v[56:59]
  v_mfma_f32_16x16x32_bf16 v[60:63], v[148:151], a[84:87], v[60:63]
  ds_read_b128 v[148:151], v253 offset:12288
  s_waitcnt lgkmcnt(7)
  v_mfma_f32_16x16x32_bf16 v[128:131], v[152:155], a[80:83], v[128:131]
  v_mfma_f32_16x16x32_bf16 v[132:135], v[152:155], a[84:87], v[132:135]
  ds_read_b128 v[152:155], v253 offset:13312
  s_waitcnt vmcnt(17) lgkmcnt(7)
  v_mfma_f32_16x16x32_bf16 v[0:3], v[156:159], a[88:91], v[0:3]
  s_add_u32 s0, s78, 63488
  s_waitcnt vmcnt(16)
  v_mfma_f32_16x16x32_bf16 v[4:7], v[156:159], a[92:95], v[4:7]
  ds_read_b128 v[156:159], v253 offset:14336
  s_waitcnt lgkmcnt(7)
  v_mfma_f32_16x16x32_bf16 v[8:11], v[160:163], a[88:91], v[8:11]
  v_mfma_f32_16x16x32_bf16 v[12:15], v[160:163], a[92:95], v[12:15]
  buffer_load_dwordx4 a[120:123], v224, s[20:23], s0 offen sc1
  s_barrier
  ds_read_b128 v[160:163], v253 offset:61440
  s_waitcnt lgkmcnt(7)
  v_mfma_f32_16x16x32_bf16 v[16:19], v[164:167], a[88:91], v[16:19]
  v_mfma_f32_16x16x32_bf16 v[20:23], v[164:167], a[92:95], v[20:23]
  buffer_load_dwordx4 a[124:127], v224, s[20:23], s0 offen offset:1024 sc1
  ds_read_b128 v[164:167], v253 offset:62464
  s_waitcnt lgkmcnt(7)
  v_mfma_f32_16x16x32_bf16 v[24:27], v[168:171], a[88:91], v[24:27]
  s_add_u32 s62, s79, 1327104
  s_add_u32 m0, s5, 0
  v_mfma_f32_16x16x32_bf16 v[28:31], v[168:171], a[92:95], v[28:31]
  buffer_load_dwordx4 v224, s[20:23], s62 offen offset:0 sc1 lds
  ds_read_b128 v[168:171], v253 offset:63488
  s_waitcnt lgkmcnt(7)
  v_mfma_f32_16x16x32_bf16 v[32:35], v[172:175], a[88:91], v[32:35]
  v_mfma_f32_16x16x32_bf16 v[36:39], v[172:175], a[92:95], v[36:39]
  ds_read_b128 v[172:175], v253 offset:64512
  s_waitcnt lgkmcnt(7)
  v_mfma_f32_16x16x32_bf16 v[40:43], v[144:147], a[88:91], v[40:43]
  v_mfma_f32_16x16x32_bf16 v[44:47], v[144:147], a[92:95], v[44:47]
  buffer_load_dwordx4 v224, s[20:23], s62 offen offset:1024 sc1 lds
  ds_read_b128 v[144:147], v254 offset:0
  s_waitcnt lgkmcnt(7)
  v_mfma_f32_16x16x32_bf16 v[48:51], v[148:151], a[88:91], v[48:51]
  v_mfma_f32_16x16x32_bf16 v[52:55], v[148:151], a[92:95], v[52:55]
  ds_read_b128 v[148:151], v254 offset:1024
  s_waitcnt lgkmcnt(7)
  v_mfma_f32_16x16x32_bf16 v[56:59], v[152:155], a[88:91], v[56:59]
  v_mfma_f32_16x16x32_bf16 v[60:63], v[152:155], a[92:95], v[60:63]
  buffer_load_dwordx4 v224, s[20:23], s62 offen offset:2048 sc1 lds
  ds_read_b128 v[152:155], v254 offset:2048
  s_waitcnt lgkmcnt(7)
  v_mfma_f32_16x16x32_bf16 v[128:131], v[156:159], a[88:91], v[128:131]
  v_mfma_f32_16x16x32_bf16 v[132:135], v[156:159], a[92:95], v[132:135]
  ds_read_b128 v[156:159], v254 offset:3072
  s_waitcnt vmcnt(10) lgkmcnt(7)
  v_mfma_f32_16x16x32_bf16 v[0:3], v[160:163], a[96:99], v[0:3]
  s_waitcnt vmcnt(9)
  v_mfma_f32_16x16x32_bf16 v[4:7], v[160:163], a[100:103], v[4:7]
  buffer_load_dwordx4 v224, s[20:23], s62 offen offset:3072 sc1 lds
  ds_read_b128 v[160:163], v254 offset:4096
  s_waitcnt lgkmcnt(7)
  v_mfma_f32_16x16x32_bf16 v[8:11], v[164:167], a[96:99], v[8:11]
  s_add_u32 s62, s79, 1331200
  s_add_u32 m0, s5, 4096
  v_mfma_f32_16x16x32_bf16 v[12:15], v[164:167], a[100:103], v[12:15]
  ds_read_b128 v[164:167], v254 offset:5120
  s_waitcnt lgkmcnt(7)
  v_mfma_f32_16x16x32_bf16 v[16:19], v[168:171], a[96:99], v[16:19]
  v_mfma_f32_16x16x32_bf16 v[20:23], v[168:171], a[100:103], v[20:23]
  buffer_load_dwordx4 v224, s[20:23], s62 offen offset:0 sc1 lds
  ds_read_b128 v[168:171], v254 offset:6144
  s_waitcnt lgkmcnt(7)
  v_mfma_f32_16x16x32_bf16 v[24:27], v[172:175], a[96:99], v[24:27]
  v_mfma_f32_16x16x32_bf16 v[28:31], v[172:175], a[100:103], v[28:31]
  ds_read_b128 v[172:175], v254 offset:7168
  s_waitcnt lgkmcnt(7)
  v_mfma_f32_16x16x32_bf16 v[32:35], v[144:147], a[96:99], v[32:35]
  v_mfma_f32_16x16x32_bf16 v[36:39], v[144:147], a[100:103], v[36:39]
  buffer_load_dwordx4 v224, s[20:23], s62 offen offset:1024 sc1 lds
  ds_read_b128 v[144:147], v254 offset:8192
  s_waitcnt lgkmcnt(7)
  v_mfma_f32_16x16x32_bf16 v[40:43], v[148:151], a[96:99], v[40:43]
  v_mfma_f32_16x16x32_bf16 v[44:47], v[148:151], a[100:103], v[44:47]
  ds_read_b128 v[148:151], v254 offset:9216
  s_waitcnt lgkmcnt(7)
  v_mfma_f32_16x16x32_bf16 v[48:51], v[152:155], a[96:99], v[48:51]
  v_mfma_f32_16x16x32_bf16 v[52:55], v[152:155], a[100:103], v[52:55]
  buffer_load_dwordx4 v224, s[20:23], s62 offen offset:2048 sc1 lds
  ds_read_b128 v[152:155], v254 offset:10240
  s_waitcnt lgkmcnt(7)
  v_mfma_f32_16x16x32_bf16 v[56:59], v[156:159], a[96:99], v[56:59]
  v_mfma_f32_16x16x32_bf16 v[60:63], v[156:159], a[100:103], v[60:63]
  ds_read_b128 v[156:159], v254 offset:11264
  s_waitcnt lgkmcnt(7)
  v_mfma_f32_16x16x32_bf16 v[128:131], v[160:163], a[96:99], v[128:131]
  v_mfma_f32_16x16x32_bf16 v[132:135], v[160:163], a[100:103], v[132:135]
  buffer_load_dwordx4 v224, s[20:23], s62 offen offset:3072 sc1 lds
  ds_read_b128 v[160:163], v254 offset:12288
  s_waitcnt vmcnt(13) lgkmcnt(7)
  v_mfma_f32_16x16x32_bf16 v[0:3], v[164:167], a[104:107], v[0:3]
  s_add_u32 s62, s79, 1335296
  s_add_u32 m0, s5, 8192
  s_waitcnt vmcnt(12)
  v_mfma_f32_16x16x32_bf16 v[4:7], v[164:167], a[108:111], v[4:7]
  ds_read_b128 v[164:167], v254 offset:13312
  s_waitcnt lgkmcnt(7)
  v_mfma_f32_16x16x32_bf16 v[8:11], v[168:171], a[104:107], v[8:11]
  v_mfma_f32_16x16x32_bf16 v[12:15], v[168:171], a[108:111], v[12:15]
  buffer_load_dwordx4 v224, s[20:23], s62 offen offset:0 sc1 lds
  ds_read_b128 v[168:171], v254 offset:14336
  s_waitcnt lgkmcnt(7)
  v_mfma_f32_16x16x32_bf16 v[16:19], v[172:175], a[104:107], v[16:19]
  v_cmp_eq_u32 vcc, 1, v242
  s_nop 1
  s_cmp_eq_u64 vcc, exec
  s_cbranch_scc1 L_ok_11
  s_mov_b32 s82, 0
L_spin_12:
  buffer_load_dword v242, v241, s[20:23], s101 offen sc1
  s_add_u32 s82, s82, 1
  s_waitcnt vmcnt(0)
  v_cmp_eq_u32 vcc, 1, v242
  s_nop 4
  s_cmp_ge_u32 s82, 0x40000
  s_cbranch_scc1 L_ok_11
  s_cmp_eq_u64 vcc, exec
  s_cbranch_scc0 L_spin_12
L_ok_11:
  v_mfma_f32_16x16x32_bf16 v[20:23], v[172:175], a[108:111], v[20:23]
  s_add_u32 s0, s78, 65536
  ds_read_b128 v[172:175], v254 offset:15360
  s_waitcnt lgkmcnt(7)
  v_mfma_f32_16x16x32_bf16 v[24:27], v[144:147], a[104:107], v[24:27]
  v_mfma_f32_16x16x32_bf16 v[28:31], v[144:147], a[108:111], v[28:31]
  buffer_load_dwordx4 a[0:3], v224, s[20:23], s0 offen sc1
  ds_read_b128 v[144:147], v254 offset:16384
  s_waitcnt lgkmcnt(7)
  v_mfma_f32_16x16x32_bf16 v[32:35], v[148:151], a[104:107], v[32:35]
  v_mfma_f32_16x16x32_bf16 v[36:39], v[148:151], a[108:111], v[36:39]
  ds_read_b128 v[148:151], v254 offset:17408
  s_waitcnt lgkmcnt(7)
  v_mfma_f32_16x16x32_bf16 v[40:43], v[152:155], a[104:107], v[40:43]
  v_mfma_f32_16x16x32_bf16 v[44:47], v[152:155], a[108:111], v[44:47]
  buffer_load_dwordx4 a[4:7], v224, s[20:23], s0 offen offset:1024 sc1
  ds_read_b128 v[152:155], v254 offset:18432
  s_waitcnt lgkmcnt(7)
  v_mfma_f32_16x16x32_bf16 v[48:51], v[156:159], a[104:107], v[48:51]
  s_add_u32 s0, s78, 73728
  v_mfma_f32_16x16x32_bf16 v[52:55], v[156:159], a[108:111], v[52:55]
  ds_read_b128 v[156:159], v254 offset:19456
  s_waitcnt lgkmcnt(7)
  v_mfma_f32_16x16x32_bf16 v[56:59], v[160:163], a[104:107], v[56:59]
  v_mfma_f32_16x16x32_bf16 v[60:63], v[160:163], a[108:111], v[60:63]
  buffer_load_dwordx4 a[32:35], v224, s[20:23], s0 offen sc1
  ds_read_b128 v[160:163], v254 offset:20480
  s_waitcnt lgkmcnt(7)
  v_mfma_f32_16x16x32_bf16 v[128:131], v[164:167], a[104:107], v[128:131]
  v_mfma_f32_16x16x32_bf16 v[132:135], v[164:167], a[108:111], v[132:135]
  ds_read_b128 v[164:167], v254 offset:21504
  s_waitcnt vmcnt(15) lgkmcnt(7)
  v_mfma_f32_16x16x32_bf16 v[0:3], v[168:171], a[112:115], v[0:3]
  s_waitcnt vmcnt(14)
  v_mfma_f32_16x16x32_bf16 v[4:7], v[168:171], a[116:119], v[4:7]
  buffer_load_dwordx4 a[36:39], v224, s[20:23], s0 offen offset:1024 sc1
  ds_read_b128 v[168:171], v254 offset:22528
  s_waitcnt lgkmcnt(7)
  v_mfma_f32_16x16x32_bf16 v[8:11], v[172:175], a[112:115], v[8:11]
  s_add_u32 s0, s78, 67584
  v_mfma_f32_16x16x32_bf16 v[12:15], v[172:175], a[116:119], v[12:15]
  ds_read_b128 v[172:175], v254 offset:23552
  s_waitcnt lgkmcnt(7)
  v_mfma_f32_16x16x32_bf16 v[16:19], v[144:147], a[112:115], v[16:19]
  v_mfma_f32_16x16x32_bf16 v[20:23], v[144:147], a[116:119], v[20:23]
  buffer_load_dwordx4 a[8:11], v224, s[20:23], s0 offen sc1
  ds_read_b128 v[144:147], v254 offset:24576
  s_waitcnt lgkmcnt(7)
  v_mfma_f32_16x16x32_bf16 v[24:27], v[148:151], a[112:115], v[24:27]
  v_mfma_f32_16x16x32_bf16 v[28:31], v[148:151], a[116:119], v[28:31]
  ds_read_b128 v[148:151], v254 offset:25600
  s_waitcnt lgkmcnt(7)
  v_mfma_f32_16x16x32_bf16 v[32:35], v[152:155], a[112:115], v[32:35]
  v_mfma_f32_16x16x32_bf16 v[36:39], v[152:155], a[116:119], v[36:39]
  buffer_load_dwordx4 a[12:15], v224, s[20:23], s0 offen offset:1024 sc1
  ds_read_b128 v[152:155], v254 offset:26624
  s_waitcnt lgkmcnt(7)
  v_mfma_f32_16x16x32_bf16 v[40:43], v[156:159], a[112:115], v[40:43]
  s_add_u32 s0, s78, 75776
  v_mfma_f32_16x16x32_bf16 v[44:47], v[156:159], a[116:119], v[44:47]
  ds_read_b128 v[156:159], v254 offset:27648
  s_waitcnt lgkmcnt(7)
  v_mfma_f32_16x16x32_bf16 v[48:51], v[160:163], a[112:115], v[48:51]
  v_mfma_f32_16x16x32_bf16 v[52:55], v[160:163], a[116:119], v[52:55]
  buffer_load_dwordx4 a[40:43], v224, s[20:23], s0 offen sc1
  ds_read_b128 v[160:163], v254 offset:28672
  s_waitcnt lgkmcnt(7)
  v_mfma_f32_16x16x32_bf16 v[56:59], v[164:167], a[112:115], v[56:59]
  v_mfma_f32_16x16x32_bf16 v[60:63], v[164:167], a[116:119], v[60:63]
  ds_read_b128 v[164:167], v254 offset:29696
  s_waitcnt lgkmcnt(7)
  v_mfma_f32_16x16x32_bf16 v[128:131], v[168:171], a[112:115], v[128:131]
  v_mfma_f32_16x16x32_bf16 v[132:135], v[168:171], a[116:119], v[132:135]
  buffer_load_dwordx4 a[44:47], v224, s[20:23], s0 offen offset:1024 sc1
  ds_read_b128 v[168:171], v254 offset:30720
  s_waitcnt vmcnt(18) lgkmcnt(7)
  v_mfma_f32_16x16x32_bf16 v[0:3], v[172:175], a[120:123], v[0:3]
  s_add_u32 s0, s78, 69632
  s_waitcnt vmcnt(17)
  v_mfma_f32_16x16x32_bf16 v[4:7], v[172:175], a[124:127], v[4:7]
  ds_read_b128 v[172:175], v254 offset:31744
  s_waitcnt lgkmcnt(7)
  v_mfma_f32_16x16x32_bf16 v[8:11], v[144:147], a[120:123], v[8:11]
  v_mfma_f32_16x16x32_bf16 v[12:15], v[144:147], a[124:127], v[12:15]
  buffer_load_dwordx4 a[16:19], v224, s[20:23], s0 offen sc1
  s_barrier
  ds_read_b128 v[144:147], v253 offset:24576
  s_waitcnt lgkmcnt(7)
  v_mfma_f32_16x16x32_bf16 v[16:19], v[148:151], a[120:123], v[16:19]
  v_mfma_f32_16x16x32_bf16 v[20:23], v[148:151], a[124:127], v[20:23]
  buffer_load_dwordx4 a[20:23], v224, s[20:23], s0 offen offset:1024 sc1
  ds_read_b128 v[148:151], v253 offset:25600
  s_waitcnt lgkmcnt(7)
  v_mfma_f32_16x16x32_bf16 v[24:27], v[152:155], a[120:123], v[24:27]
  s_add_u32 s0, s78, 77824
  v_mfma_f32_16x16x32_bf16 v[28:31], v[152:155], a[124:127], v[28:31]
  buffer_load_dwordx4 a[48:51], v224, s[20:23], s0 offen sc1
  ds_read_b128 v[152:155], v253 offset:26624
  s_waitcnt lgkmcnt(7)
  v_mfma_f32_16x16x32_bf16 v[32:35], v[156:159], a[120:123], v[32:35]
  v_mfma_f32_16x16x32_bf16 v[36:39], v[156:159], a[124:127], v[36:39]
  buffer_load_dwordx4 a[52:55], v224, s[20:23], s0 offen offset:1024 sc1
  ds_read_b128 v[156:159], v253 offset:27648
  s_waitcnt lgkmcnt(7)
  v_mfma_f32_16x16x32_bf16 v[40:43], v[160:163], a[120:123], v[40:43]
  s_add_u32 s0, s78, 71680
  v_mfma_f32_16x16x32_bf16 v[44:47], v[160:163], a[124:127], v[44:47]
  buffer_load_dwordx4 a[24:27], v224, s[20:23], s0 offen sc1
  ds_read_b128 v[160:163], v253 offset:28672
  s_waitcnt lgkmcnt(7)
  v_mfma_f32_16x16x32_bf16 v[48:51], v[164:167], a[120:123], v[48:51]
  v_mfma_f32_16x16x32_bf16 v[52:55], v[164:167], a[124:127], v[52:55]
  ds_read_b128 v[164:167], v253 offset:29696
  s_waitcnt lgkmcnt(7)
  v_mfma_f32_16x16x32_bf16 v[56:59], v[168:171], a[120:123], v[56:59]
  v_mfma_f32_16x16x32_bf16 v[60:63], v[168:171], a[124:127], v[60:63]
  buffer_load_dwordx4 a[28:31], v224, s[20:23], s0 offen offset:1024 sc1
  ds_read_b128 v[168:171], v253 offset:30720
  s_waitcnt lgkmcnt(7)
  v_mfma_f32_16x16x32_bf16 v[128:131], v[172:175], a[120:123], v[128:131]
  s_add_u32 s0, s78, 79872
  v_mfma_f32_16x16x32_bf16 v[132:135], v[172:175], a[124:127], v[132:135]
  ds_read_b128 v[172:175], v253 offset:31744
  s_waitcnt vmcnt(13) lgkmcnt(7)
  v_mfma_f32_16x16x32_bf16 v[0:3], v[144:147], a[0:3], v[0:3]
  s_waitcnt vmcnt(12)
  v_mfma_f32_16x16x32_bf16 v[4:7], v[144:147], a[4:7], v[4:7]
  buffer_load_dwordx4 a[56:59], v224, s[20:23], s0 offen sc1
  ds_read_b128 v[144:147], v253 offset:32768
  s_waitcnt lgkmcnt(7)
  v_mfma_f32_16x16x32_bf16 v[8:11], v[148:151], a[0:3], v[8:11]
  v_mfma_f32_16x16x32_bf16 v[12:15], v[148:151], a[4:7], v[12:15]
  ds_read_b128 v[148:151], v253 offset:33792
  s_waitcnt lgkmcnt(7)
  v_mfma_f32_16x16x32_bf16 v[16:19], v[152:155], a[0:3], v[16:19]
  v_mfma_f32_16x16x32_bf16 v[20:23], v[152:155], a[4:7], v[20:23]
  buffer_load_dwordx4 a[60:63], v224, s[20:23], s0 offen offset:1024 sc1
  ds_read_b128 v[152:155], v253 offset:34816
  s_waitcnt lgkmcnt(7)
  v_mfma_f32_16x16x32_bf16 v[24:27], v[156:159], a[0:3], v[24:27]
  s_mul_i32 s45, s3, 36864
  s_sub_u32 s45, s79, s45
  s_lshr_b32 s62, s3, 1
  s_mul_i32 s62, s62, 36864
  s_add_u32 s45, s45, s62
  v_mfma_f32_16x16x32_bf16 v[28:31], v[156:159], a[4:7], v[28:31]
  s_and_b32 s62, s3, 1
  s_lshl_b32 s62, s62, 12
  s_add_u32 s45, s45, s62
  s_add_u32 s45, s45, 1474560
  ds_read_b128 v[156:159], v253 offset:35840
  s_waitcnt lgkmcnt(7)
  v_mfma_f32_16x16x32_bf16 v[32:35], v[160:163], a[0:3], v[32:35]
  s_lshr_b32 s82, s3, 1
  s_mul_i32 s82, s82, 9216
  s_add_u32 s82, s82, s62
  s_add_u32 m0, s82, 36864
  v_mfma_f32_16x16x32_bf16 v[36:39], v[160:163], a[4:7], v[36:39]
  buffer_load_dwordx4 v224, s[20:23], s45 offen offset:0 sc1 lds
  ds_read_b128 v[160:163], v253 offset:36864
  s_waitcnt lgkmcnt(7)
  v_mfma_f32_16x16x32_bf16 v[40:43], v[164:167], a[0:3], v[40:43]
  v_mfma_f32_16x16x32_bf16 v[44:47], v[164:167], a[4:7], v[44:47]
  ds_read_b128 v[164:167], v253 offset:37888
  s_waitcnt lgkmcnt(7)
  v_mfma_f32_16x16x32_bf16 v[48:51], v[168:171], a[0:3], v[48:51]
  v_mfma_f32_16x16x32_bf16 v[52:55], v[168:171], a[4:7], v[52:55]
  buffer_load_dwordx4 v224, s[20:23], s45 offen offset:1024 sc1 lds
  ds_read_b128 v[168:171], v253 offset:38912
  s_waitcnt lgkmcnt(7)
  v_mfma_f32_16x16x32_bf16 v[56:59], v[172:175], a[0:3], v[56:59]
  v_mfma_f32_16x16x32_bf16 v[60:63], v[172:175], a[4:7], v[60:63]
  ds_read_b128 v[172:175], v253 offset:39936
  s_waitcnt lgkmcnt(7)
  v_mfma_f32_16x16x32_bf16 v[128:131], v[144:147], a[0:3], v[128:131]
  v_mfma_f32_16x16x32_bf16 v[132:135], v[144:147], a[4:7], v[132:135]
  buffer_load_dwordx4 v224, s[20:23], s45 offen offset:2048 sc1 lds
  ds_read_b128 v[144:147], v253 offset:40960
  s_waitcnt vmcnt(14) lgkmcnt(7)
  v_mfma_f32_16x16x32_bf16 v[0:3], v[148:151], a[8:11], v[0:3]
  s_waitcnt vmcnt(13)
  v_mfma_f32_16x16x32_bf16 v[4:7], v[148:151], a[12:15], v[4:7]
  ds_read_b128 v[148:151], v253 offset:41984
  s_waitcnt lgkmcnt(7)
  v_mfma_f32_16x16x32_bf16 v[8:11], v[152:155], a[8:11], v[8:11]
  v_mfma_f32_16x16x32_bf16 v[12:15], v[152:155], a[12:15], v[12:15]
  buffer_load_dwordx4 v224, s[20:23], s45 offen offset:3072 sc1 lds
  ds_read_b128 v[152:155], v253 offset:43008
  s_waitcnt lgkmcnt(7)
  v_mfma_f32_16x16x32_bf16 v[16:19], v[156:159], a[8:11], v[16:19]
  s_add_u32 m0, s82, 40960
  s_add_u32 s62, s45, 4096
  buffer_load_dwordx4 v224, s[20:23], s62 offen sc1 lds
  v_mfma_f32_16x16x32_bf16 v[20:23], v[156:159], a[12:15], v[20:23]
  s_add_u32 s0, s78, 81920
  ds_read_b128 v[156:159], v253 offset:44032
  s_waitcnt lgkmcnt(7)
  v_mfma_f32_16x16x32_bf16 v[24:27], v[160:163], a[8:11], v[24:27]
  v_mfma_f32_16x16x32_bf16 v[28:31], v[160:163], a[12:15], v[28:31]
  buffer_load_dwordx4 a[64:67], v224, s[20:23], s0 offen sc1
  ds_read_b128 v[160:163], v253 offset:45056
  s_waitcnt lgkmcnt(7)
  v_mfma_f32_16x16x32_bf16 v[32:35], v[164:167], a[8:11], v[32:35]
  v_mfma_f32_16x16x32_bf16 v[36:39], v[164:167], a[12:15], v[36:39]
  ds_read_b128 v[164:167], v253 offset:46080
  s_waitcnt lgkmcnt(7)
  v_mfma_f32_16x16x32_bf16 v[40:43], v[168:171], a[8:11], v[40:43]
  v_mfma_f32_16x16x32_bf16 v[44:47], v[168:171], a[12:15], v[44:47]
  buffer_load_dwordx4 a[68:71], v224, s[20:23], s0 offen offset:1024 sc1
  ds_read_b128 v[168:171], v253 offset:47104
  s_waitcnt lgkmcnt(7)
  v_mfma_f32_16x16x32_bf16 v[48:51], v[172:175], a[8:11], v[48:51]
  s_add_u32 s0, s78, 83968
  v_mfma_f32_16x16x32_bf16 v[52:55], v[172:175], a[12:15], v[52:55]
  ds_read_b128 v[172:175], v253 offset:48128
  s_waitcnt lgkmcnt(7)
  v_mfma_f32_16x16x32_bf16 v[56:59], v[144:147], a[8:11], v[56:59]
  v_mfma_f32_16x16x32_bf16 v[60:63], v[144:147], a[12:15], v[60:63]
  buffer_load_dwordx4 a[72:75], v224, s[20:23], s0 offen sc1
  ds_read_b128 v[144:147], v253 offset:49152
  s_waitcnt lgkmcnt(7)
  v_mfma_f32_16x16x32_bf16 v[128:131], v[148:151], a[8:11], v[128:131]
  v_mfma_f32_16x16x32_bf16 v[132:135], v[148:151], a[12:15], v[132:135]
  ds_read_b128 v[148:151], v253 offset:50176
  s_waitcnt vmcnt(15) lgkmcnt(7)
  v_mfma_f32_16x16x32_bf16 v[0:3], v[152:155], a[16:19], v[0:3]
  s_waitcnt vmcnt(14)
  v_mfma_f32_16x16x32_bf16 v[4:7], v[152:155], a[20:23], v[4:7]
  buffer_load_dwordx4 a[76:79], v224, s[20:23], s0 offen offset:1024 sc1
  ds_read_b128 v[152:155], v253 offset:51200
  s_waitcnt lgkmcnt(7)
  v_mfma_f32_16x16x32_bf16 v[8:11], v[156:159], a[16:19], v[8:11]
  v_mfma_f32_16x16x32_bf16 v[12:15], v[156:159], a[20:23], v[12:15]
  ds_read_b128 v[156:159], v253 offset:52224
  s_waitcnt lgkmcnt(7)
  v_mfma_f32_16x16x32_bf16 v[16:19], v[160:163], a[16:19], v[16:19]
  v_mfma_f32_16x16x32_bf16 v[20:23], v[160:163], a[20:23], v[20:23]
  ds_read_b128 v[160:163], v253 offset:53248
  s_waitcnt lgkmcnt(7)
  v_mfma_f32_16x16x32_bf16 v[24:27], v[164:167], a[16:19], v[24:27]
  v_mfma_f32_16x16x32_bf16 v[28:31], v[164:167], a[20:23], v[28:31]
  ds_read_b128 v[164:167], v253 offset:54272
  s_waitcnt lgkmcnt(7)
  v_mfma_f32_16x16x32_bf16 v[32:35], v[168:171], a[16:19], v[32:35]
  v_mfma_f32_16x16x32_bf16 v[36:39], v[168:171], a[20:23], v[36:39]
  ds_read_b128 v[168:171], v253 offset:55296
  s_waitcnt lgkmcnt(7)
  v_mfma_f32_16x16x32_bf16 v[40:43], v[172:175], a[16:19], v[40:43]
  v_mfma_f32_16x16x32_bf16 v[44:47], v[172:175], a[20:23], v[44:47]
  ds_read_b128 v[172:175], v253 offset:56320
  s_waitcnt lgkmcnt(7)
  v_mfma_f32_16x16x32_bf16 v[48:51], v[144:147], a[16:19], v[48:51]
  v_mfma_f32_16x16x32_bf16 v[52:55], v[144:147], a[20:23], v[52:55]
  ds_read_b128 v[144:147], v253 offset:57344
  s_waitcnt lgkmcnt(7)
  v_mfma_f32_16x16x32_bf16 v[56:59], v[148:151], a[16:19], v[56:59]
  v_mfma_f32_16x16x32_bf16 v[60:63], v[148:151], a[20:23], v[60:63]
  ds_read_b128 v[148:151], v253 offset:58368
  s_waitcnt lgkmcnt(7)
  v_mfma_f32_16x16x32_bf16 v[128:131], v[152:155], a[16:19], v[128:131]
  v_mfma_f32_16x16x32_bf16 v[132:135], v[152:155], a[20:23], v[132:135]
  ds_read_b128 v[152:155], v253 offset:59392
  s_waitcnt vmcnt(12) lgkmcnt(7)
  v_mfma_f32_16x16x32_bf16 v[0:3], v[156:159], a[24:27], v[0:3]
  s_waitcnt vmcnt(11)
  v_mfma_f32_16x16x32_bf16 v[4:7], v[156:159], a[28:31], v[4:7]
  ds_read_b128 v[156:159], v253 offset:60416
  s_waitcnt lgkmcnt(7)
  v_mfma_f32_16x16x32_bf16 v[8:11], v[160:163], a[24:27], v[8:11]
  v_mfma_f32_16x16x32_bf16 v[12:15], v[160:163], a[28:31], v[12:15]
  s_waitcnt vmcnt(4)
  s_barrier
  ds_read_b128 v[160:163], v224 offset:0
  s_waitcnt lgkmcnt(7)
  v_mfma_f32_16x16x32_bf16 v[16:19], v[164:167], a[24:27], v[16:19]
  v_mfma_f32_16x16x32_bf16 v[20:23], v[164:167], a[28:31], v[20:23]
  ds_read_b128 v[164:167], v224 offset:9216
  s_waitcnt lgkmcnt(7)
  v_mfma_f32_16x16x32_bf16 v[24:27], v[168:171], a[24:27], v[24:27]
  v_mfma_f32_16x16x32_bf16 v[28:31], v[168:171], a[28:31], v[28:31]
  ds_read_b128 v[168:171], v224 offset:18432
  s_waitcnt lgkmcnt(7)
  v_mfma_f32_16x16x32_bf16 v[32:35], v[172:175], a[24:27], v[32:35]
  v_mfma_f32_16x16x32_bf16 v[36:39], v[172:175], a[28:31], v[36:39]
  ds_read_b128 v[172:175], v224 offset:27648
  s_waitcnt lgkmcnt(7)
  v_mfma_f32_16x16x32_bf16 v[40:43], v[144:147], a[24:27], v[40:43]
  v_mfma_f32_16x16x32_bf16 v[44:47], v[144:147], a[28:31], v[44:47]
  ds_read_b128 v[144:147], v224 offset:36864
  s_waitcnt lgkmcnt(7)
  v_mfma_f32_16x16x32_bf16 v[48:51], v[148:151], a[24:27], v[48:51]
  v_mfma_f32_16x16x32_bf16 v[52:55], v[148:151], a[28:31], v[52:55]
  ds_read_b128 v[148:151], v224 offset:46080
  s_waitcnt lgkmcnt(7)
  v_mfma_f32_16x16x32_bf16 v[56:59], v[152:155], a[24:27], v[56:59]
  v_mfma_f32_16x16x32_bf16 v[60:63], v[152:155], a[28:31], v[60:63]
  ds_read_b128 v[152:155], v224 offset:1024
  s_waitcnt lgkmcnt(7)
  v_mfma_f32_16x16x32_bf16 v[128:131], v[156:159], a[24:27], v[128:131]
  v_mfma_f32_16x16x32_bf16 v[132:135], v[156:159], a[28:31], v[132:135]
  ds_read_b128 v[156:159], v224 offset:10240
  s_waitcnt lgkmcnt(7)
  v_mfma_f32_16x16x32_bf16 v[64:67], v[160:163], a[32:35], 0
  v_mfma_f32_16x16x32_bf16 v[68:71], v[160:163], a[36:39], 0
  ds_read_b128 v[160:163], v224 offset:19456
  s_waitcnt lgkmcnt(7)
  v_mfma_f32_16x16x32_bf16 v[64:67], v[164:167], a[40:43], v[64:67]
  v_mfma_f32_16x16x32_bf16 v[68:71], v[164:167], a[44:47], v[68:71]
  ds_read_b128 v[164:167], v224 offset:28672
  s_waitcnt lgkmcnt(7)
  v_mfma_f32_16x16x32_bf16 v[64:67], v[168:171], a[48:51], v[64:67]
  v_mfma_f32_16x16x32_bf16 v[68:71], v[168:171], a[52:55], v[68:71]
  ds_read_b128 v[168:171], v224 offset:37888
  s_waitcnt lgkmcnt(7)
  v_mfma_f32_16x16x32_bf16 v[64:67], v[172:175], a[56:59], v[64:67]
  v_mfma_f32_16x16x32_bf16 v[68:71], v[172:175], a[60:63], v[68:71]
  ds_read_b128 v[172:175], v224 offset:47104
  s_waitcnt vmcnt(3) lgkmcnt(7)
  v_mfma_f32_16x16x32_bf16 v[64:67], v[144:147], a[64:67], v[64:67]
  s_waitcnt vmcnt(2)
  v_mfma_f32_16x16x32_bf16 v[68:71], v[144:147], a[68:71], v[68:71]
  ds_read_b128 v[144:147], v224 offset:2048
  s_waitcnt vmcnt(1) lgkmcnt(7)
  v_mfma_f32_16x16x32_bf16 v[64:67], v[148:151], a[72:75], v[64:67]
  s_waitcnt vmcnt(0)
  v_mfma_f32_16x16x32_bf16 v[68:71], v[148:151], a[76:79], v[68:71]
  ds_read_b128 v[148:151], v224 offset:11264
  s_waitcnt lgkmcnt(7)
  v_mfma_f32_16x16x32_bf16 v[72:75], v[152:155], a[32:35], 0
  v_mfma_f32_16x16x32_bf16 v[76:79], v[152:155], a[36:39], 0
  ds_read_b128 v[152:155], v224 offset:20480
  s_waitcnt lgkmcnt(7)
  v_mfma_f32_16x16x32_bf16 v[72:75], v[156:159], a[40:43], v[72:75]
  v_fma_f32 v0, v0, v203, v64
  v_mfma_f32_16x16x32_bf16 v[76:79], v[156:159], a[44:47], v[76:79]
  ds_read_b128 v[156:159], v224 offset:29696
  v_fma_f32 v1, v1, v203, v65
  s_waitcnt lgkmcnt(7)
  v_mfma_f32_16x16x32_bf16 v[72:75], v[160:163], a[48:51], v[72:75]
  v_fma_f32 v2, v2, v203, v66
  v_fma_f32 v3, v3, v203, v67
  v_mfma_f32_16x16x32_bf16 v[76:79], v[160:163], a[52:55], v[76:79]
  ds_read_b128 v[160:163], v224 offset:38912
  v_fma_f32 v4, v4, v204, v68
  s_waitcnt lgkmcnt(7)
  v_mfma_f32_16x16x32_bf16 v[72:75], v[164:167], a[56:59], v[72:75]
  v_fma_f32 v5, v5, v204, v69
  v_fma_f32 v6, v6, v204, v70
  v_mfma_f32_16x16x32_bf16 v[76:79], v[164:167], a[60:63], v[76:79]
  ds_read_b128 v[164:167], v224 offset:48128
  v_fma_f32 v7, v7, v204, v71
  s_waitcnt lgkmcnt(7)
  v_mfma_f32_16x16x32_bf16 v[72:75], v[168:171], a[64:67], v[72:75]
  v_cvt_pk_bf16_f32 v176, v0, v1
  v_cvt_pk_bf16_f32 v177, v2, v3
  v_mfma_f32_16x16x32_bf16 v[76:79], v[168:171], a[68:71], v[76:79]
  ds_read_b128 v[168:171], v224 offset:3072
  v_cvt_pk_bf16_f32 v178, v4, v5
  s_waitcnt lgkmcnt(7)
  v_mfma_f32_16x16x32_bf16 v[72:75], v[172:175], a[72:75], v[72:75]
  v_cvt_pk_bf16_f32 v179, v6, v7
  s_add_u32 s63, s80, 0
  buffer_store_dwordx4 v[176:179], v224, s[20:23], s63 offen sc1
  v_mfma_f32_16x16x32_bf16 v[76:79], v[172:175], a[76:79], v[76:79]
  ds_read_b128 v[172:175], v224 offset:12288
  s_waitcnt lgkmcnt(7)
  v_mfma_f32_16x16x32_bf16 v[80:83], v[144:147], a[32:35], 0
  v_mfma_f32_16x16x32_bf16 v[84:87], v[144:147], a[36:39], 0
  ds_read_b128 v[144:147], v224 offset:21504
  s_waitcnt lgkmcnt(7)
  v_mfma_f32_16x16x32_bf16 v[80:83], v[148:151], a[40:43], v[80:83]
  v_fma_f32 v8, v8, v203, v72
  v_mfma_f32_16x16x32_bf16 v[84:87], v[148:151], a[44:47], v[84:87]
  ds_read_b128 v[148:151], v224 offset:30720
  v_fma_f32 v9, v9, v203, v73
  s_waitcnt lgkmcnt(7)
  v_mfma_f32_16x16x32_bf16 v[80:83], v[152:155], a[48:51], v[80:83]
  v_fma_f32 v10, v10, v203, v74
  v_fma_f32 v11, v11, v203, v75
  v_mfma_f32_16x16x32_bf16 v[84:87], v[152:155], a[52:55], v[84:87]
  ds_read_b128 v[152:155], v224 offset:39936
  v_fma_f32 v12, v12, v204, v76
  s_waitcnt lgkmcnt(7)
  v_mfma_f32_16x16x32_bf16 v[80:83], v[156:159], a[56:59], v[80:83]
  v_fma_f32 v13, v13, v204, v77
  v_fma_f32 v14, v14, v204, v78
  v_mfma_f32_16x16x32_bf16 v[84:87], v[156:159], a[60:63], v[84:87]
  ds_read_b128 v[156:159], v224 offset:49152
  v_fma_f32 v15, v15, v204, v79
  s_waitcnt lgkmcnt(7)
  v_mfma_f32_16x16x32_bf16 v[80:83], v[160:163], a[64:67], v[80:83]
  v_cvt_pk_bf16_f32 v180, v8, v9
  v_cvt_pk_bf16_f32 v181, v10, v11
  v_mfma_f32_16x16x32_bf16 v[84:87], v[160:163], a[68:71], v[84:87]
  ds_read_b128 v[160:163], v224 offset:4096
  v_cvt_pk_bf16_f32 v182, v12, v13
  s_waitcnt lgkmcnt(7)
  v_mfma_f32_16x16x32_bf16 v[80:83], v[164:167], a[72:75], v[80:83]
  v_cvt_pk_bf16_f32 v183, v14, v15
  s_add_u32 s63, s80, 1024
  buffer_store_dwordx4 v[180:183], v224, s[20:23], s63 offen sc1
  v_mfma_f32_16x16x32_bf16 v[84:87], v[164:167], a[76:79], v[84:87]
  ds_read_b128 v[164:167], v224 offset:13312
  s_waitcnt lgkmcnt(7)
  v_mfma_f32_16x16x32_bf16 v[88:91], v[168:171], a[32:35], 0
  v_mfma_f32_16x16x32_bf16 v[92:95], v[168:171], a[36:39], 0
  ds_read_b128 v[168:171], v224 offset:22528
  s_waitcnt lgkmcnt(7)
  v_mfma_f32_16x16x32_bf16 v[88:91], v[172:175], a[40:43], v[88:91]
  v_fma_f32 v16, v16, v203, v80
  v_mfma_f32_16x16x32_bf16 v[92:95], v[172:175], a[44:47], v[92:95]
  ds_read_b128 v[172:175], v224 offset:31744
  v_fma_f32 v17, v17, v203, v81
  s_waitcnt lgkmcnt(7)
  v_mfma_f32_16x16x32_bf16 v[88:91], v[144:147], a[48:51], v[88:91]
  v_fma_f32 v18, v18, v203, v82
  v_fma_f32 v19, v19, v203, v83
  v_mfma_f32_16x16x32_bf16 v[92:95], v[144:147], a[52:55], v[92:95]
  ds_read_b128 v[144:147], v224 offset:40960
  v_fma_f32 v20, v20, v204, v84
  s_waitcnt lgkmcnt(7)
  v_mfma_f32_16x16x32_bf16 v[88:91], v[148:151], a[56:59], v[88:91]
  v_fma_f32 v21, v21, v204, v85
  v_fma_f32 v22, v22, v204, v86
  v_mfma_f32_16x16x32_bf16 v[92:95], v[148:151], a[60:63], v[92:95]
  ds_read_b128 v[148:151], v224 offset:50176
  v_fma_f32 v23, v23, v204, v87
  s_waitcnt lgkmcnt(7)
  v_mfma_f32_16x16x32_bf16 v[88:91], v[152:155], a[64:67], v[88:91]
  v_cvt_pk_bf16_f32 v176, v16, v17
  v_cvt_pk_bf16_f32 v177, v18, v19
  v_mfma_f32_16x16x32_bf16 v[92:95], v[152:155], a[68:71], v[92:95]
  ds_read_b128 v[152:155], v224 offset:5120
  v_cvt_pk_bf16_f32 v178, v20, v21
  s_waitcnt lgkmcnt(7)
  v_mfma_f32_16x16x32_bf16 v[88:91], v[156:159], a[72:75], v[88:91]
  v_cvt_pk_bf16_f32 v179, v22, v23
  s_add_u32 s63, s80, 2048
  buffer_store_dwordx4 v[176:179], v224, s[20:23], s63 offen sc1
  v_mfma_f32_16x16x32_bf16 v[92:95], v[156:159], a[76:79], v[92:95]
  ds_read_b128 v[156:159], v224 offset:14336
  s_waitcnt lgkmcnt(7)
  v_mfma_f32_16x16x32_bf16 v[96:99], v[160:163], a[32:35], 0
  v_mfma_f32_16x16x32_bf16 v[100:103], v[160:163], a[36:39], 0
  ds_read_b128 v[160:163], v224 offset:23552
  s_waitcnt lgkmcnt(7)
  v_mfma_f32_16x16x32_bf16 v[96:99], v[164:167], a[40:43], v[96:99]
  v_fma_f32 v24, v24, v203, v88
  v_mfma_f32_16x16x32_bf16 v[100:103], v[164:167], a[44:47], v[100:103]
  ds_read_b128 v[164:167], v224 offset:32768
  v_fma_f32 v25, v25, v203, v89
  s_waitcnt lgkmcnt(7)
  v_mfma_f32_16x16x32_bf16 v[96:99], v[168:171], a[48:51], v[96:99]
  v_fma_f32 v26, v26, v203, v90
  v_fma_f32 v27, v27, v203, v91
  v_mfma_f32_16x16x32_bf16 v[100:103], v[168:171], a[52:55], v[100:103]
  ds_read_b128 v[168:171], v224 offset:41984
  v_fma_f32 v28, v28, v204, v92
  s_waitcnt lgkmcnt(7)
  v_mfma_f32_16x16x32_bf16 v[96:99], v[172:175], a[56:59], v[96:99]
  v_fma_f32 v29, v29, v204, v93
  v_fma_f32 v30, v30, v204, v94
  v_mfma_f32_16x16x32_bf16 v[100:103], v[172:175], a[60:63], v[100:103]
  ds_read_b128 v[172:175], v224 offset:51200
  v_fma_f32 v31, v31, v204, v95
  s_waitcnt lgkmcnt(7)
  v_mfma_f32_16x16x32_bf16 v[96:99], v[144:147], a[64:67], v[96:99]
  v_cvt_pk_bf16_f32 v180, v24, v25
  v_cvt_pk_bf16_f32 v181, v26, v27
  v_mfma_f32_16x16x32_bf16 v[100:103], v[144:147], a[68:71], v[100:103]
  ds_read_b128 v[144:147], v224 offset:6144
  v_cvt_pk_bf16_f32 v182, v28, v29
  s_waitcnt lgkmcnt(7)
  v_mfma_f32_16x16x32_bf16 v[96:99], v[148:151], a[72:75], v[96:99]
  v_cvt_pk_bf16_f32 v183, v30, v31
  s_add_u32 s63, s80, 3072
  buffer_store_dwordx4 v[180:183], v224, s[20:23], s63 offen sc1
  v_mfma_f32_16x16x32_bf16 v[100:103], v[148:151], a[76:79], v[100:103]
  ds_read_b128 v[148:151], v224 offset:15360
  s_waitcnt lgkmcnt(7)
  v_mfma_f32_16x16x32_bf16 v[104:107], v[152:155], a[32:35], 0
  v_mfma_f32_16x16x32_bf16 v[108:111], v[152:155], a[36:39], 0
  ds_read_b128 v[152:155], v224 offset:24576
  s_waitcnt lgkmcnt(7)
  v_mfma_f32_16x16x32_bf16 v[104:107], v[156:159], a[40:43], v[104:107]
  v_fma_f32 v32, v32, v203, v96
  v_mfma_f32_16x16x32_bf16 v[108:111], v[156:159], a[44:47], v[108:111]
  ds_read_b128 v[156:159], v224 offset:33792
  v_fma_f32 v33, v33, v203, v97
  s_waitcnt lgkmcnt(7)
  v_mfma_f32_16x16x32_bf16 v[104:107], v[160:163], a[48:51], v[104:107]
  v_fma_f32 v34, v34, v203, v98
  v_fma_f32 v35, v35, v203, v99
  v_mfma_f32_16x16x32_bf16 v[108:111], v[160:163], a[52:55], v[108:111]
  ds_read_b128 v[160:163], v224 offset:43008
  v_fma_f32 v36, v36, v204, v100
  s_waitcnt lgkmcnt(7)
  v_mfma_f32_16x16x32_bf16 v[104:107], v[164:167], a[56:59], v[104:107]
  v_fma_f32 v37, v37, v204, v101
  v_fma_f32 v38, v38, v204, v102
  v_mfma_f32_16x16x32_bf16 v[108:111], v[164:167], a[60:63], v[108:111]
  ds_read_b128 v[164:167], v224 offset:52224
  v_fma_f32 v39, v39, v204, v103
  s_waitcnt lgkmcnt(7)
  v_mfma_f32_16x16x32_bf16 v[104:107], v[168:171], a[64:67], v[104:107]
  v_cvt_pk_bf16_f32 v176, v32, v33
  v_cvt_pk_bf16_f32 v177, v34, v35
  v_mfma_f32_16x16x32_bf16 v[108:111], v[168:171], a[68:71], v[108:111]
  ds_read_b128 v[168:171], v224 offset:7168
  v_cvt_pk_bf16_f32 v178, v36, v37
  s_waitcnt lgkmcnt(7)
  v_mfma_f32_16x16x32_bf16 v[104:107], v[172:175], a[72:75], v[104:107]
  v_cvt_pk_bf16_f32 v179, v38, v39
  s_add_u32 s63, s80, 4096
  buffer_store_dwordx4 v[176:179], v224, s[20:23], s63 offen sc1
  v_mfma_f32_16x16x32_bf16 v[108:111], v[172:175], a[76:79], v[108:111]
  ds_read_b128 v[172:175], v224 offset:16384
  s_waitcnt lgkmcnt(7)
  v_mfma_f32_16x16x32_bf16 v[112:115], v[144:147], a[32:35], 0
  v_mfma_f32_16x16x32_bf16 v[116:119], v[144:147], a[36:39], 0
  ds_read_b128 v[144:147], v224 offset:25600
  s_waitcnt lgkmcnt(7)
  v_mfma_f32_16x16x32_bf16 v[112:115], v[148:151], a[40:43], v[112:115]
  v_fma_f32 v40, v40, v203, v104
  v_mfma_f32_16x16x32_bf16 v[116:119], v[148:151], a[44:47], v[116:119]
  ds_read_b128 v[148:151], v224 offset:34816
  v_fma_f32 v41, v41, v203, v105
  s_waitcnt lgkmcnt(7)
  v_mfma_f32_16x16x32_bf16 v[112:115], v[152:155], a[48:51], v[112:115]
  v_fma_f32 v42, v42, v203, v106
  v_fma_f32 v43, v43, v203, v107
  v_mfma_f32_16x16x32_bf16 v[116:119], v[152:155], a[52:55], v[116:119]
  ds_read_b128 v[152:155], v224 offset:44032
  v_fma_f32 v44, v44, v204, v108
  s_waitcnt lgkmcnt(7)
  v_mfma_f32_16x16x32_bf16 v[112:115], v[156:159], a[56:59], v[112:115]
  v_fma_f32 v45, v45, v204, v109
  v_fma_f32 v46, v46, v204, v110
  v_mfma_f32_16x16x32_bf16 v[116:119], v[156:159], a[60:63], v[116:119]
  ds_read_b128 v[156:159], v224 offset:53248
  v_fma_f32 v47, v47, v204, v111
  s_waitcnt lgkmcnt(7)
  v_mfma_f32_16x16x32_bf16 v[112:115], v[160:163], a[64:67], v[112:115]
  v_cvt_pk_bf16_f32 v180, v40, v41
  v_cvt_pk_bf16_f32 v181, v42, v43
  v_mfma_f32_16x16x32_bf16 v[116:119], v[160:163], a[68:71], v[116:119]
  ds_read_b128 v[160:163], v224 offset:8192
  v_cvt_pk_bf16_f32 v182, v44, v45
  s_waitcnt lgkmcnt(7)
  v_mfma_f32_16x16x32_bf16 v[112:115], v[164:167], a[72:75], v[112:115]
  v_cvt_pk_bf16_f32 v183, v46, v47
  s_add_u32 s63, s80, 5120
  buffer_store_dwordx4 v[180:183], v224, s[20:23], s63 offen sc1
  v_mfma_f32_16x16x32_bf16 v[116:119], v[164:167], a[76:79], v[116:119]
  ds_read_b128 v[164:167], v224 offset:17408
  s_waitcnt lgkmcnt(7)
  v_mfma_f32_16x16x32_bf16 v[120:123], v[168:171], a[32:35], 0
  v_mfma_f32_16x16x32_bf16 v[124:127], v[168:171], a[36:39], 0
  ds_read_b128 v[168:171], v224 offset:26624
  s_waitcnt lgkmcnt(7)
  v_mfma_f32_16x16x32_bf16 v[120:123], v[172:175], a[40:43], v[120:123]
  v_fma_f32 v48, v48, v203, v112
  v_mfma_f32_16x16x32_bf16 v[124:127], v[172:175], a[44:47], v[124:127]
  ds_read_b128 v[172:175], v224 offset:35840
  v_fma_f32 v49, v49, v203, v113
  s_waitcnt lgkmcnt(7)
  v_mfma_f32_16x16x32_bf16 v[120:123], v[144:147], a[48:51], v[120:123]
  v_fma_f32 v50, v50, v203, v114
  v_fma_f32 v51, v51, v203, v115
  v_mfma_f32_16x16x32_bf16 v[124:127], v[144:147], a[52:55], v[124:127]
  ds_read_b128 v[144:147], v224 offset:45056
  v_fma_f32 v52, v52, v204, v116
  s_waitcnt lgkmcnt(7)
  v_mfma_f32_16x16x32_bf16 v[120:123], v[148:151], a[56:59], v[120:123]
  v_fma_f32 v53, v53, v204, v117
  v_fma_f32 v54, v54, v204, v118
  v_mfma_f32_16x16x32_bf16 v[124:127], v[148:151], a[60:63], v[124:127]
  ds_read_b128 v[148:151], v224 offset:54272
  v_fma_f32 v55, v55, v204, v119
  s_waitcnt lgkmcnt(7)
  v_mfma_f32_16x16x32_bf16 v[120:123], v[152:155], a[64:67], v[120:123]
  v_cvt_pk_bf16_f32 v176, v48, v49
  v_cvt_pk_bf16_f32 v177, v50, v51
  v_mfma_f32_16x16x32_bf16 v[124:127], v[152:155], a[68:71], v[124:127]
  v_cvt_pk_bf16_f32 v178, v52, v53
  s_waitcnt lgkmcnt(6)
  v_mfma_f32_16x16x32_bf16 v[120:123], v[156:159], a[72:75], v[120:123]
  v_cvt_pk_bf16_f32 v179, v54, v55
  s_add_u32 s63, s80, 6144
  buffer_store_dwordx4 v[176:179], v224, s[20:23], s63 offen sc1
  v_mfma_f32_16x16x32_bf16 v[124:127], v[156:159], a[76:79], v[124:127]
  s_waitcnt lgkmcnt(5)
  v_mfma_f32_16x16x32_bf16 v[136:139], v[160:163], a[32:35], 0
  v_mfma_f32_16x16x32_bf16 v[140:143], v[160:163], a[36:39], 0
  s_waitcnt lgkmcnt(4)
  v_mfma_f32_16x16x32_bf16 v[136:139], v[164:167], a[40:43], v[136:139]
  v_fma_f32 v56, v56, v203, v120
  v_mfma_f32_16x16x32_bf16 v[140:143], v[164:167], a[44:47], v[140:143]
  v_fma_f32 v57, v57, v203, v121
  s_waitcnt lgkmcnt(3)
  v_mfma_f32_16x16x32_bf16 v[136:139], v[168:171], a[48:51], v[136:139]
  v_fma_f32 v58, v58, v203, v122
  v_fma_f32 v59, v59, v203, v123
  v_mfma_f32_16x16x32_bf16 v[140:143], v[168:171], a[52:55], v[140:143]
  v_fma_f32 v60, v60, v204, v124
  s_waitcnt lgkmcnt(2)
  v_mfma_f32_16x16x32_bf16 v[136:139], v[172:175], a[56:59], v[136:139]
  v_fma_f32 v61, v61, v204, v125
  v_fma_f32 v62, v62, v204, v126
  v_mfma_f32_16x16x32_bf16 v[140:143], v[172:175], a[60:63], v[140:143]
  v_fma_f32 v63, v63, v204, v127
  s_waitcnt lgkmcnt(1)
  v_mfma_f32_16x16x32_bf16 v[136:139], v[144:147], a[64:67], v[136:139]
  v_cvt_pk_bf16_f32 v180, v56, v57
  v_cvt_pk_bf16_f32 v181, v58, v59
  v_mfma_f32_16x16x32_bf16 v[140:143], v[144:147], a[68:71], v[140:143]
  v_cvt_pk_bf16_f32 v182, v60, v61
  s_waitcnt lgkmcnt(0)
  v_mfma_f32_16x16x32_bf16 v[136:139], v[148:151], a[72:75], v[136:139]
  v_cvt_pk_bf16_f32 v183, v62, v63
  s_add_u32 s63, s80, 7168
  buffer_store_dwordx4 v[180:183], v224, s[20:23], s63 offen sc1
  v_mfma_f32_16x16x32_bf16 v[140:143], v[148:151], a[76:79], v[140:143]
  s_nop 7
  v_fma_f32 v128, v128, v203, v136
  v_fma_f32 v129, v129, v203, v137
  v_fma_f32 v130, v130, v203, v138
  v_fma_f32 v131, v131, v203, v139
  v_fma_f32 v132, v132, v204, v140
  v_fma_f32 v133, v133, v204, v141
  v_fma_f32 v134, v134, v204, v142
  v_fma_f32 v135, v135, v204, v143
  v_cvt_pk_bf16_f32 v176, v128, v129
  v_cvt_pk_bf16_f32 v177, v130, v131
  v_cvt_pk_bf16_f32 v178, v132, v133
  v_cvt_pk_bf16_f32 v179, v134, v135
  s_add_u32 s63, s80, 8192
  buffer_store_dwordx4 v[176:179], v224, s[20:23], s63 offen sc1
L_p2_join:
  s_lshl_b32 s45, s48, 9
  s_add_u32 s45, s45, s73
  v_and_b32 v241, 3, v249
  v_lshlrev_b32 v241, 2, v241
  v_and_b32 v210, 15, v249
  v_mul_u32_u24 v213, 1152, v210
  v_lshrrev_b32 v214, 4, v249
  v_lshl_add_u32 v213, v214, 3, v213
  s_lshl_b32 s62, s3, 5
  s_add_u32 s100, s85, s62
  s_add_u32 s4, s81, s59
  s_lshl_b32 s63, s3, 9
  s_lshl_b32 s62, s48, 2
  s_add_u32 s62, s62, s63
  s_add_u32 s62, s62, s73
  s_waitcnt vmcnt(0)
  s_mov_b64 exec, 1
  buffer_store_dword v251, off, s[20:23], s62 sc1
  s_mov_b64 exec, -1
  buffer_load_dword v252, v241, s[20:23], s45 offen sc1
  s_waitcnt vmcnt(0)
  v_cmp_eq_u32 vcc, 1, v252
  s_nop 1
  s_cmp_eq_u64 vcc, exec
  s_cbranch_scc1 L_ok_13
  s_mov_b32 s82, 0
L_spin_14:
  buffer_load_dword v252, v241, s[20:23], s45 offen sc1
  s_add_u32 s82, s82, 1
  s_waitcnt vmcnt(0)
  v_cmp_eq_u32 vcc, 1, v252
  s_nop 4
  s_cmp_ge_u32 s82, 0x40000
  s_cbranch_scc1 L_ok_13
  s_cmp_eq_u64 vcc, exec
  s_cbranch_scc0 L_spin_14
L_ok_13:
  s_cmp_eq_u32 s3, 0
  s_cbranch_scc1 L_three_15
  s_add_u32 s62, s4, 0
  buffer_load_dwordx4 v[0:3], v224, s[20:23], s62 offen sc1
  s_add_u32 s62, s4, 9216
  buffer_load_dwordx4 v[4:7], v224, s[20:23], s62 offen sc1
  s_add_u32 s62, s4, 18432
  buffer_load_dwordx4 v[8:11], v224, s[20:23], s62 offen sc1
  s_add_u32 s62, s4, 27648
  buffer_load_dwordx4 v[12:15], v224, s[20:23], s62 offen sc1
  s_add_u32 s62, s4, 4096
  buffer_load_dwordx4 v[24:27], v224, s[20:23], s62 offen sc1
  s_add_u32 s62, s4, 13312
  buffer_load_dwordx4 v[28:31], v224, s[20:23], s62 offen sc1
  s_add_u32 s62, s4, 22528
  buffer_load_dwordx4 v[32:35], v224, s[20:23], s62 offen sc1
  s_add_u32 s62, s4, 31744
  buffer_load_dwordx4 v[36:39], v224, s[20:23], s62 offen sc1
  s_waitcnt vmcnt(7)
  v_lshlrev_b32 v16, 16, v0
  v_and_b32 v17, 0xffff0000, v0
  v_lshlrev_b32 v18, 16, v1
  v_and_b32 v19, 0xffff0000, v1
  v_lshlrev_b32 v20, 16, v2
  v_and_b32 v21, 0xffff0000, v2
  v_lshlrev_b32 v22, 16, v3
  v_and_b32 v23, 0xffff0000, v3
  s_waitcnt vmcnt(6)
  v_lshlrev_b32 v216, 16, v4
  v_and_b32 v217, 0xffff0000, v4
  v_add_f32 v16, v16, v216
  v_add_f32 v17, v17, v217
  v_lshlrev_b32 v216, 16, v5
  v_and_b32 v217, 0xffff0000, v5
  v_add_f32 v18, v18, v216
  v_add_f32 v19, v19, v217
  v_lshlrev_b32 v216, 16, v6
  v_and_b32 v217, 0xffff0000, v6
  v_add_f32 v20, v20, v216
  v_add_f32 v21, v21, v217
  v_lshlrev_b32 v216, 16, v7
  v_and_b32 v217, 0xffff0000, v7
  v_add_f32 v22, v22, v216
  v_add_f32 v23, v23, v217
  s_waitcnt vmcnt(5)
  v_lshlrev_b32 v216, 16, v8
  v_and_b32 v217, 0xffff0000, v8
  v_add_f32 v16, v16, v216
  v_add_f32 v17, v17, v217
  v_lshlrev_b32 v216, 16, v9
  v_and_b32 v217, 0xffff0000, v9
  v_add_f32 v18, v18, v216
  v_add_f32 v19, v19, v217
  v_lshlrev_b32 v216, 16, v10
  v_and_b32 v217, 0xffff0000, v10
  v_add_f32 v20, v20, v216
  v_add_f32 v21, v21, v217
  v_lshlrev_b32 v216, 16, v11
  v_and_b32 v217, 0xffff0000, v11
  v_add_f32 v22, v22, v216
  v_add_f32 v23, v23, v217
  s_waitcnt vmcnt(4)
  v_lshlrev_b32 v216, 16, v12
  v_and_b32 v217, 0xffff0000, v12
  v_add_f32 v16, v16, v216
  v_add_f32 v17, v17, v217
  v_lshlrev_b32 v216, 16, v13
  v_and_b32 v217, 0xffff0000, v13
  v_add_f32 v18, v18, v216
  v_add_f32 v19, v19, v217
  v_lshlrev_b32 v216, 16, v14
  v_and_b32 v217, 0xffff0000, v14
  v_add_f32 v20, v20, v216
  v_add_f32 v21, v21, v217
  v_lshlrev_b32 v216, 16, v15
  v_and_b32 v217, 0xffff0000, v15
  v_add_f32 v22, v22, v216
  v_add_f32 v23, v23, v217
  v_cvt_pk_bf16_f32 v0, v16, v17
  v_cvt_pk_bf16_f32 v1, v18, v19
  s_add_u32 s62, s100, 0
  buffer_store_dwordx2 v[0:1], v213, s[36:39], s62 offen
  v_cvt_pk_bf16_f32 v2, v20, v21
  v_cvt_pk_bf16_f32 v3, v22, v23
  s_add_u32 s62, s100, 18432
  buffer_store_dwordx2 v[2:3], v213, s[36:39], s62 offen
  s_waitcnt vmcnt(5)
  v_lshlrev_b32 v40, 16, v24
  v_and_b32 v41, 0xffff0000, v24
  v_lshlrev_b32 v42, 16, v25
  v_and_b32 v43, 0xffff0000, v25
  v_lshlrev_b32 v44, 16, v26
  v_and_b32 v45, 0xffff0000, v26
  v_lshlrev_b32 v46, 16, v27
  v_and_b32 v47, 0xffff0000, v27
  s_waitcnt vmcnt(4)
  v_lshlrev_b32 v216, 16, v28
  v_and_b32 v217, 0xffff0000, v28
  v_add_f32 v40, v40, v216
  v_add_f32 v41, v41, v217
  v_lshlrev_b32 v216, 16, v29
  v_and_b32 v217, 0xffff0000, v29
  v_add_f32 v42, v42, v216
  v_add_f32 v43, v43, v217
  v_lshlrev_b32 v216, 16, v30
  v_and_b32 v217, 0xffff0000, v30
  v_add_f32 v44, v44, v216
  v_add_f32 v45, v45, v217
  v_lshlrev_b32 v216, 16, v31
  v_and_b32 v217, 0xffff0000, v31
  v_add_f32 v46, v46, v216
  v_add_f32 v47, v47, v217
  s_waitcnt vmcnt(3)
  v_lshlrev_b32 v216, 16, v32
  v_and_b32 v217, 0xffff0000, v32
  v_add_f32 v40, v40, v216
  v_add_f32 v41, v41, v217
  v_lshlrev_b32 v216, 16, v33
  v_and_b32 v217, 0xffff0000, v33
  v_add_f32 v42, v42, v216
  v_add_f32 v43, v43, v217
  v_lshlrev_b32 v216, 16, v34
  v_and_b32 v217, 0xffff0000, v34
  v_add_f32 v44, v44, v216
  v_add_f32 v45, v45, v217
  v_lshlrev_b32 v216, 16, v35
  v_and_b32 v217, 0xffff0000, v35
  v_add_f32 v46, v46, v216
  v_add_f32 v47, v47, v217
  s_waitcnt vmcnt(2)
  v_lshlrev_b32 v216, 16, v36
  v_and_b32 v217, 0xffff0000, v36
  v_add_f32 v40, v40, v216
  v_add_f32 v41, v41, v217
  v_lshlrev_b32 v216, 16, v37
  v_and_b32 v217, 0xffff0000, v37
  v_add_f32 v42, v42, v216
  v_add_f32 v43, v43, v217
  v_lshlrev_b32 v216, 16, v38
  v_and_b32 v217, 0xffff0000, v38
  v_add_f32 v44, v44, v216
  v_add_f32 v45, v45, v217
  v_lshlrev_b32 v216, 16, v39
  v_and_b32 v217, 0xffff0000, v39
  v_add_f32 v46, v46, v216
  v_add_f32 v47, v47, v217
  v_cvt_pk_bf16_f32 v24, v40, v41
  v_cvt_pk_bf16_f32 v25, v42, v43
  s_add_u32 s62, s100, 128
  buffer_store_dwordx2 v[24:25], v213, s[36:39], s62 offen
  v_cvt_pk_bf16_f32 v26, v44, v45
  v_cvt_pk_bf16_f32 v27, v46, v47
  s_add_u32 s62, s100, 18560
  buffer_store_dwordx2 v[26:27], v213, s[36:39], s62 offen
  s_branch L_fin_16
L_three_15:
  s_add_u32 s62, s4, 0
  buffer_load_dwordx4 v[0:3], v224, s[20:23], s62 offen sc1
  s_add_u32 s62, s4, 9216
  buffer_load_dwordx4 v[4:7], v224, s[20:23], s62 offen sc1
  s_add_u32 s62, s4, 18432
  buffer_load_dwordx4 v[8:11], v224, s[20:23], s62 offen sc1
  s_add_u32 s62, s4, 27648
  buffer_load_dwordx4 v[12:15], v224, s[20:23], s62 offen sc1
  s_add_u32 s62, s4, 4096
  buffer_load_dwordx4 v[24:27], v224, s[20:23], s62 offen sc1
  s_add_u32 s62, s4, 13312
  buffer_load_dwordx4 v[28:31], v224, s[20:23], s62 offen sc1
  s_add_u32 s62, s4, 22528
  buffer_load_dwordx4 v[32:35], v224, s[20:23], s62 offen sc1
  s_add_u32 s62, s4, 31744
  buffer_load_dwordx4 v[36:39], v224, s[20:23], s62 offen sc1
  s_add_u32 s62, s4, 8192
  buffer_load_dwordx4 v[48:51], v224, s[20:23], s62 offen sc1
  s_add_u32 s62, s4, 17408
  buffer_load_dwordx4 v[52:55], v224, s[20:23], s62 offen sc1
  s_add_u32 s62, s4, 26624
  buffer_load_dwordx4 v[56:59], v224, s[20:23], s62 offen sc1
  s_add_u32 s62, s4, 35840
  buffer_load_dwordx4 v[60:63], v224, s[20:23], s62 offen sc1
  s_waitcnt vmcnt(11)
  v_lshlrev_b32 v16, 16, v0
  v_and_b32 v17, 0xffff0000, v0
  v_lshlrev_b32 v18, 16, v1
  v_and_b32 v19, 0xffff0000, v1
  v_lshlrev_b32 v20, 16, v2
  v_and_b32 v21, 0xffff0000, v2
  v_lshlrev_b32 v22, 16, v3
  v_and_b32 v23, 0xffff0000, v3
  s_waitcnt vmcnt(10)
  v_lshlrev_b32 v216, 16, v4
  v_and_b32 v217, 0xffff0000, v4
  v_add_f32 v16, v16, v216
  v_add_f32 v17, v17, v217
  v_lshlrev_b32 v216, 16, v5
  v_and_b32 v217, 0xffff0000, v5
  v_add_f32 v18, v18, v216
  v_add_f32 v19, v19, v217
  v_lshlrev_b32 v216, 16, v6
  v_and_b32 v217, 0xffff0000, v6
  v_add_f32 v20, v20, v216
  v_add_f32 v21, v21, v217
  v_lshlrev_b32 v216, 16, v7
  v_and_b32 v217, 0xffff0000, v7
  v_add_f32 v22, v22, v216
  v_add_f32 v23, v23, v217
  s_waitcnt vmcnt(9)
  v_lshlrev_b32 v216, 16, v8
  v_and_b32 v217, 0xffff0000, v8
  v_add_f32 v16, v16, v216
  v_add_f32 v17, v17, v217
  v_lshlrev_b32 v216, 16, v9
  v_and_b32 v217, 0xffff0000, v9
  v_add_f32 v18, v18, v216
  v_add_f32 v19, v19, v217
  v_lshlrev_b32 v216, 16, v10
  v_and_b32 v217, 0xffff0000, v10
  v_add_f32 v20, v20, v216
  v_add_f32 v21, v21, v217
  v_lshlrev_b32 v216, 16, v11
  v_and_b32 v217, 0xffff0000, v11
  v_add_f32 v22, v22, v216
  v_add_f32 v23, v23, v217
  s_waitcnt vmcnt(8)
  v_lshlrev_b32 v216, 16, v12
  v_and_b32 v217, 0xffff0000, v12
  v_add_f32 v16, v16, v216
  v_add_f32 v17, v17, v217
  v_lshlrev_b32 v216, 16, v13
  v_and_b32 v217, 0xffff0000, v13
  v_add_f32 v18, v18, v216
  v_add_f32 v19, v19, v217
  v_lshlrev_b32 v216, 16, v14
  v_and_b32 v217, 0xffff0000, v14
  v_add_f32 v20, v20, v216
  v_add_f32 v21, v21, v217
  v_lshlrev_b32 v216, 16, v15
  v_and_b32 v217, 0xffff0000, v15
  v_add_f32 v22, v22, v216
  v_add_f32 v23, v23, v217
  v_cvt_pk_bf16_f32 v0, v16, v17
  v_cvt_pk_bf16_f32 v1, v18, v19
  s_add_u32 s62, s100, 0
  buffer_store_dwordx2 v[0:1], v213, s[36:39], s62 offen
  v_cvt_pk_bf16_f32 v2, v20, v21
  v_cvt_pk_bf16_f32 v3, v22, v23
  s_add_u32 s62, s100, 18432
  buffer_store_dwordx2 v[2:3], v213, s[36:39], s62 offen
  s_waitcnt vmcnt(9)
  v_lshlrev_b32 v40, 16, v24
  v_and_b32 v41, 0xffff0000, v24
  v_lshlrev_b32 v42, 16, v25
  v_and_b32 v43, 0xffff0000, v25
  v_lshlrev_b32 v44, 16, v26
  v_and_b32 v45, 0xffff0000, v26
  v_lshlrev_b32 v46, 16, v27
  v_and_b32 v47, 0xffff0000, v27
  s_waitcnt vmcnt(8)
  v_lshlrev_b32 v216, 16, v28
  v_and_b32 v217, 0xffff0000, v28
  v_add_f32 v40, v40, v216
  v_add_f32 v41, v41, v217
  v_lshlrev_b32 v216, 16, v29
  v_and_b32 v217, 0xffff0000, v29
  v_add_f32 v42, v42, v216
  v_add_f32 v43, v43, v217
  v_lshlrev_b32 v216, 16, v30
  v_and_b32 v217, 0xffff0000, v30
  v_add_f32 v44, v44, v216
  v_add_f32 v45, v45, v217
  v_lshlrev_b32 v216, 16, v31
  v_and_b32 v217, 0xffff0000, v31
  v_add_f32 v46, v46, v216
  v_add_f32 v47, v47, v217
  s_waitcnt vmcnt(7)
  v_lshlrev_b32 v216, 16, v32
  v_and_b32 v217, 0xffff0000, v32
  v_add_f32 v40, v40, v216
  v_add_f32 v41, v41, v217
  v_lshlrev_b32 v216, 16, v33
  v_and_b32 v217, 0xffff0000, v33
  v_add_f32 v42, v42, v216
  v_add_f32 v43, v43, v217
  v_lshlrev_b32 v216, 16, v34
  v_and_b32 v217, 0xffff0000, v34
  v_add_f32 v44, v44, v216
  v_add_f32 v45, v45, v217
  v_lshlrev_b32 v216, 16, v35
  v_and_b32 v217, 0xffff0000, v35
  v_add_f32 v46, v46, v216
  v_add_f32 v47, v47, v217
  s_waitcnt vmcnt(6)
  v_lshlrev_b32 v216, 16, v36
  v_and_b32 v217, 0xffff0000, v36
  v_add_f32 v40, v40, v216
  v_add_f32 v41, v41, v217
  v_lshlrev_b32 v216, 16, v37
  v_and_b32 v217, 0xffff0000, v37
  v_add_f32 v42, v42, v216
  v_add_f32 v43, v43, v217
  v_lshlrev_b32 v216, 16, v38
  v_and_b32 v217, 0xffff0000, v38
  v_add_f32 v44, v44, v216
  v_add_f32 v45, v45, v217
  v_lshlrev_b32 v216, 16, v39
  v_and_b32 v217, 0xffff0000, v39
  v_add_f32 v46, v46, v216
  v_add_f32 v47, v47, v217
  v_cvt_pk_bf16_f32 v24, v40, v41
  v_cvt_pk_bf16_f32 v25, v42, v43
  s_add_u32 s62, s100, 128
  buffer_store_dwordx2 v[24:25], v213, s[36:39], s62 offen
  v_cvt_pk_bf16_f32 v26, v44, v45
  v_cvt_pk_bf16_f32 v27, v46, v47
  s_add_u32 s62, s100, 18560
  buffer_store_dwordx2 v[26:27], v213, s[36:39], s62 offen
  s_waitcnt vmcnt(7)
  v_lshlrev_b32 v64, 16, v48
  v_and_b32 v65, 0xffff0000, v48
  v_lshlrev_b32 v66, 16, v49
  v_and_b32 v67, 0xffff0000, v49
  v_lshlrev_b32 v68, 16, v50
  v_and_b32 v69, 0xffff0000, v50
  v_lshlrev_b32 v70, 16, v51
  v_and_b32 v71, 0xffff0000, v51
  s_waitcnt vmcnt(6)
  v_lshlrev_b32 v216, 16, v52
  v_and_b32 v217, 0xffff0000, v52
  v_add_f32 v64, v64, v216
  v_add_f32 v65, v65, v217
  v_lshlrev_b32 v216, 16, v53
  v_and_b32 v217, 0xffff0000, v53
  v_add_f32 v66, v66, v216
  v_add_f32 v67, v67, v217
  v_lshlrev_b32 v216, 16, v54
  v_and_b32 v217, 0xffff0000, v54
  v_add_f32 v68, v68, v216
  v_add_f32 v69, v69, v217
  v_lshlrev_b32 v216, 16, v55
  v_and_b32 v217, 0xffff0000, v55
  v_add_f32 v70, v70, v216
  v_add_f32 v71, v71, v217
  s_waitcnt vmcnt(5)
  v_lshlrev_b32 v216, 16, v56
  v_and_b32 v217, 0xffff0000, v56
  v_add_f32 v64, v64, v216
  v_add_f32 v65, v65, v217
  v_lshlrev_b32 v216, 16, v57
  v_and_b32 v217, 0xffff0000, v57
  v_add_f32 v66, v66, v216
  v_add_f32 v67, v67, v217
  v_lshlrev_b32 v216, 16, v58
  v_and_b32 v217, 0xffff0000, v58
  v_add_f32 v68, v68, v216
  v_add_f32 v69, v69, v217
  v_lshlrev_b32 v216, 16, v59
  v_and_b32 v217, 0xffff0000, v59
  v_add_f32 v70, v70, v216
  v_add_f32 v71, v71, v217
  s_waitcnt vmcnt(4)
  v_lshlrev_b32 v216, 16, v60
  v_and_b32 v217, 0xffff0000, v60
  v_add_f32 v64, v64, v216
  v_add_f32 v65, v65, v217
  v_lshlrev_b32 v216, 16, v61
  v_and_b32 v217, 0xffff0000, v61
  v_add_f32 v66, v66, v216
  v_add_f32 v67, v67, v217
  v_lshlrev_b32 v216, 16, v62
  v_and_b32 v217, 0xffff0000, v62
  v_add_f32 v68, v68, v216
  v_add_f32 v69, v69, v217
  v_lshlrev_b32 v216, 16, v63
  v_and_b32 v217, 0xffff0000, v63
  v_add_f32 v70, v70, v216
  v_add_f32 v71, v71, v217
  v_cvt_pk_bf16_f32 v48, v64, v65
  v_cvt_pk_bf16_f32 v49, v66, v67
  s_add_u32 s62, s100, 256
  buffer_store_dwordx2 v[48:49], v213, s[36:39], s62 offen
  v_cvt_pk_bf16_f32 v50, v68, v69
  v_cvt_pk_bf16_f32 v51, v70, v71
  s_add_u32 s62, s100, 18688
  buffer_store_dwordx2 v[50:51], v213, s[36:39], s62 offen
L_fin_16:
  s_waitcnt vmcnt(0) lgkmcnt(0)
L_end:
  s_endpgm
.section .rodata,"a"
.p2align 6
.amdhsa_kernel gated_mix__linear_attn_block__swiglu_ffn__prompt_kernel
  .amdhsa_next_free_vgpr 512
  .amdhsa_next_free_sgpr 102
  .amdhsa_accum_offset 256
  .amdhsa_group_segment_fixed_size 0
  .amdhsa_kernarg_size 88
  .amdhsa_user_sgpr_count 2
  .amdhsa_user_sgpr_kernarg_segment_ptr 1
  .amdhsa_system_sgpr_workgroup_id_x 1
  .amdhsa_float_denorm_mode_32 3
.end_amdhsa_kernel
```
